```python
import torch

def _softmax(x, axis=-1):
    return torch.softmax(x, dim=axis)
def _gelu(x):
    return torch.nn.functional.gelu(x, approximate="tanh")
def _silu(x):
    return torch.nn.functional.silu(x)
def _sigmoid(x):
    return torch.sigmoid(x)
def _layernorm(x, axis=-1, eps=1e-5):
    m = x.mean(dim=axis, keepdim=True)
    v = x.var(dim=axis, keepdim=True, unbiased=False)
    return (x - m) / torch.sqrt(v + eps)
def _scatter_add(tgt, idx, src, axis=0):
    return tgt.clone().index_add_(axis, idx, src)
def _segment_sum(src, seg, n):
    out = torch.zeros((n,) + src.shape[1:], dtype=src.dtype)
    return out.index_add_(0, seg, src)
def _pad(x, pw):
    flat = tuple(v for pair in reversed(pw) for v in pair)
    return torch.nn.functional.pad(x, flat)

kernel_name = 'interleave_layers__sliding_local_dilated__ssm_conv_s4d__prompt'

def setup_inputs():

    _w = (lambda a: (lambda t: t.to(torch.bfloat16) if t.is_floating_point() else t)(torch.as_tensor(a)))
    def _A_setup():
        B, S, D = 1, 2048, 512
        return {
            "x": _w((lambda *s: torch.randn(*s, dtype=torch.bfloat16) * 0.05)(B, S, D)),
            "wqkv": _w((lambda *s: torch.randn(*s, dtype=torch.bfloat16) * 0.05)(D, 3 * D)),
            "wo": _w((lambda *s: torch.randn(*s, dtype=torch.bfloat16) * 0.05)(D, D)),
        }
    _A_in = _A_setup()

    def _B_setup():
        Bsz, L, D, N = 1, 2048, 512, 128
        return {
            "u": _w((lambda *s: torch.randn(*s, dtype=torch.bfloat16) * 0.05)(Bsz, L, D)),
            "log_A_real": _w((lambda *s: torch.randn(*s, dtype=torch.bfloat16) * 6.4)(D, N) * 0.5),
            "A_imag": _w((lambda *s: torch.randn(*s, dtype=torch.bfloat16) * 0.1)(D, N) * 3.14),
            "C_real": _w((lambda *s: torch.randn(*s, dtype=torch.bfloat16) * 0.1)(D, N) / N ** 0.5),
            "C_imag": _w((lambda *s: torch.randn(*s, dtype=torch.bfloat16) * 0.1)(D, N) / N ** 0.5),
            "log_dt": _w((lambda *s: torch.randn(*s, dtype=torch.bfloat16) * 0.1)(D) * 0.5 - 4.0),
            "D_skip": _w((lambda *s: torch.randn(*s, dtype=torch.bfloat16) * 0.1)(D)),
        }
    _B_in = _B_setup()

    return {
        "A_x": _A_in["x"],
        "A_wqkv": _A_in["wqkv"],
        "A_wo": _A_in["wo"],
        "B_u": _B_in["u"],
        "B_log_A_real": _B_in["log_A_real"],
        "B_A_imag": _B_in["A_imag"],
        "B_C_real": _B_in["C_real"],
        "B_C_imag": _B_in["C_imag"],
        "B_log_dt": _B_in["log_dt"],
        "B_D_skip": _B_in["D_skip"],
    }

def reference(A_x, A_wqkv, A_wo, B_u, B_log_A_real, B_A_imag, B_C_real, B_C_imag, B_log_dt, B_D_skip):
    def _A_ref(x, wqkv, wo):
        B, S, D = x.shape
        H = 32; Dh = D // H
        W, dil = 8, 2
        qkv = (lambda x, *d: x.permute(*d))((x @ wqkv).reshape(B, S, 3, H, Dh), 2, 0, 3, 1, 4)
        q, k, v = qkv[0], qkv[1], qkv[2]
        scale = Dh ** -0.5
        pos = torch.arange(S)
        off = torch.arange(W) * dil
        idx = pos[:, None] - off[None, :]
        mask = idx >= 0
        idx_c = torch.where(mask, idx, 0).reshape(-1)
        kg = k[:, :, idx_c, :].reshape(B, H, S, W, Dh)
        vg = v[:, :, idx_c, :].reshape(B, H, S, W, Dh)
        logits = torch.einsum("bhsd,bhswd->bhsw", q, kg) * scale
        logits = torch.where(mask[None, None, :, :], logits, -1e9)
        attn = _softmax(logits, axis=-1)
        o = torch.einsum("bhsw,bhswd->bhsd", attn, vg)
        return (lambda x, *d: x.permute(*d))(o, 0, 2, 1, 3).reshape(B, S, D) @ wo

    def _B_ref(u, log_A_real, A_imag, C_real, C_imag, log_dt, D_skip):
        L = u.shape[1]
        dt = torch.exp(log_dt)
        A = -torch.exp(log_A_real) + 1j * A_imag
        C = (C_real + 1j * C_imag) * dt[:, None]
        pos = (lambda x, dt: x.to(dt))(torch.arange(L), log_dt.dtype)
        P = torch.exp((A * dt[:, None])[:, :, None] * pos[None, None, :])
        K = 2.0 * torch.einsum("dn,dnl->dl", C, P).real
        L2 = 2 * L
        u_t = (lambda x, *d: x.permute(*d))(u, 0, 2, 1)
        Kf = (lambda x, *a, **k: torch.fft.rfft(x.float(), *a, **k))(K, L2)
        Uf = (lambda x, *a, **k: torch.fft.rfft(x.float(), *a, **k))(u_t, L2)
        y = (lambda x, *a, **k: torch.fft.irfft(x, *a, **k).to(torch.bfloat16))(Uf * Kf[None, :, :], L2)[:, :, :L]
        y = (lambda x, *d: x.permute(*d))(y, 0, 2, 1)
        return y + u * D_skip[None, None, :]

    x = A_x
    x = x + _A_ref(_layernorm(x, axis=-1), A_wqkv, A_wo)
    x = x + _B_ref(_layernorm(x, axis=-1), B_log_A_real, B_A_imag, B_C_real, B_C_imag, B_log_dt, B_D_skip)
    x = x + _A_ref(_layernorm(x, axis=-1), A_wqkv, A_wo)
    x = x + _B_ref(_layernorm(x, axis=-1), B_log_A_real, B_A_imag, B_C_real, B_C_imag, B_log_dt, B_D_skip)
    return x
```

```asm
; @launch grid=(256,1,1) block=(256,1,1) lds=163840
.amdgcn_target "amdgcn-amd-amdhsa--gfx950"
.text
.globl interleave_layers__sliding_local_dilated__ssm_conv_s4d__prompt_kernel
.p2align 8
.type interleave_layers__sliding_local_dilated__ssm_conv_s4d__prompt_kernel,@function
interleave_layers__sliding_local_dilated__ssm_conv_s4d__prompt_kernel:
  s_cmp_ge_u32 s2, 256
  s_cbranch_scc1 L_exit
  s_load_dwordx4 s[52:55], s[0:1], 0
  s_getpc_b64 s[60:61]
  s_lshr_b32 s62, s2, 3
  s_mul_i32 s62, s62, 1664
  v_subrev_u32 v5, 192, v0
  v_cmp_gt_u32 vcc, 13, v5
  v_lshlrev_b32 v5, 7, v5
  v_add_u32 v5, s62, v5
  s_and_saveexec_b64 s[64:65], vcc
  s_cbranch_execz L_cp_1
  global_load_dword v255, v5, s[60:61]
L_cp_1:
  s_mov_b64 exec, s[64:65]
  s_load_dwordx8 s[32:39], s[0:1], 32
  s_load_dwordx4 s[40:43], s[0:1], 64
  s_load_dwordx2 s[56:57], s[0:1], 16
  s_load_dwordx4 s[28:31], s[0:1], 80
  s_load_dwordx2 s[80:81], s[0:1], 96
  v_and_b32 v1, 63, v0
  v_lshrrev_b32 v4, 6, v0
  v_and_b32 v2, 15, v0
  v_lshrrev_b32 v3, 4, v1
  v_readfirstlane_b32 s44, v4
  s_and_b32 s3, s2, 7
  s_lshr_b32 s59, s2, 3
  s_and_b32 s45, s59, 7
  s_lshr_b32 s58, s59, 3
  s_lshl_b32 s46, s3, 2
  s_add_u32 s46, s46, s58
  s_mov_b32 s47, s3
  s_lshl_b32 s48, s3, 6
  s_add_u32 s48, s48, s59
  s_lshl_b32 s49, s46, 6
  s_mul_i32 s50, s44, 20
  v_lshrrev_b32 v180, 3, v1
  v_and_b32 v181, 7, v1
  v_add_u32 v182, s50, v180
  v_lshrrev_b32 v183, 1, v182
  v_and_b32 v183, 7, v183
  v_xor_b32 v183, v183, v181
  v_lshlrev_b32 v183, 4, v183
  v_add_u32 v182, s49, v182
  v_subrev_u32 v182, 16, v182
  v_max_i32 v182, 0, v182
  v_lshl_add_u32 v175, v182, 10, v183
  v_add_u32 v182, s50, v180
  v_add_u32 v182, 8, v182
  v_lshrrev_b32 v183, 1, v182
  v_and_b32 v183, 7, v183
  v_xor_b32 v183, v183, v181
  v_lshlrev_b32 v183, 4, v183
  v_add_u32 v182, s49, v182
  v_subrev_u32 v182, 16, v182
  v_max_i32 v182, 0, v182
  v_lshl_add_u32 v176, v182, 10, v183
  v_add_u32 v182, s50, v180
  v_add_u32 v182, 16, v182
  v_lshrrev_b32 v183, 1, v182
  v_and_b32 v183, 7, v183
  v_xor_b32 v183, v183, v181
  v_lshlrev_b32 v183, 4, v183
  v_add_u32 v182, s49, v182
  v_subrev_u32 v182, 16, v182
  v_max_i32 v182, 0, v182
  v_lshl_add_u32 v177, v182, 10, v183
  s_mul_i32 s71, s44, 2560
  v_lshrrev_b32 v183, 4, v1
  v_and_b32 v183, 1, v183
  v_lshrrev_b32 v182, 1, v181
  v_xor_b32 v183, v183, v182
  v_lshlrev_b32 v183, 5, v183
  v_and_b32 v182, 1, v1
  v_lshl_add_u32 v183, v182, 4, v183
  s_lshl_b32 s51, s45, 7
  v_add_u32 v183, s51, v183
  s_lshl_b32 s50, s44, 4
  v_add_u32 v182, s50, v180
  v_mul_u32_u24 v182, 3072, v182
  v_add_u32 v178, v182, v183
  v_xor_b32 v183, 64, v183
  v_add_u32 v182, 24576, v182
  v_add_u32 v179, v182, v183
  s_lshl_b32 s72, s44, 11
  s_add_u32 s72, s72, 81920
  s_waitcnt lgkmcnt(0)
  s_mov_b32 s4, s52
  s_mov_b32 s5, s53
  s_mov_b32 s6, 2097152
  s_mov_b32 s7, 0x20000
  s_mov_b32 s8, s54
  s_mov_b32 s9, s55
  s_mov_b32 s10, 1572864
  s_mov_b32 s11, 0x20000
  s_add_u32 s75, s47, 0
  s_and_b32 s75, s75, 7
  s_lshl_b32 s76, s75, 7
  s_mul_i32 s77, s75, 196608
  s_add_u32 m0, s72, 0
  s_nop 0
  buffer_load_dwordx4 v178, s[8:11], s77 offen lds
  s_add_u32 m0, s72, 1024
  s_nop 0
  buffer_load_dwordx4 v179, s[8:11], s77 offen lds
  s_add_u32 m0, s72, 8192
  s_add_u32 s77, s77, 1024
  buffer_load_dwordx4 v178, s[8:11], s77 offen lds
  s_add_u32 m0, s72, 9216
  s_nop 0
  buffer_load_dwordx4 v179, s[8:11], s77 offen lds
  s_add_u32 m0, s72, 16384
  s_add_u32 s77, s77, 1024
  buffer_load_dwordx4 v178, s[8:11], s77 offen lds
  s_add_u32 m0, s72, 17408
  s_nop 0
  buffer_load_dwordx4 v179, s[8:11], s77 offen lds
  s_add_u32 m0, s71, 0
  s_nop 0
  buffer_load_dwordx4 v175, s[4:7], s76 offen lds
  s_add_u32 m0, s71, 1024
  s_nop 0
  buffer_load_dwordx4 v176, s[4:7], s76 offen lds
  s_add_u32 m0, s71, 2048
  s_mov_b32 exec_hi, 0
  buffer_load_dwordx4 v177, s[4:7], s76 offen lds
  s_mov_b32 exec_hi, -1
  s_mov_b32 s16, s80
  s_mov_b32 s17, s81
  s_mov_b32 s18, 268435456
  s_mov_b32 s19, 0x20000
  s_mov_b32 s12, s56
  s_mov_b32 s13, s57
  s_mov_b32 s14, 524288
  s_mov_b32 s15, 0x20000
  s_mov_b32 s20, s28
  s_mov_b32 s21, s29
  s_mov_b32 s22, 2097152
  s_mov_b32 s23, 0x20000
  s_mov_b32 s24, s30
  s_mov_b32 s25, s31
  s_mov_b32 s26, 256
  s_mov_b32 s27, 0x20000
  s_getreg_b32 s79, hwreg(HW_REG_XCC_ID, 0, 4)
  s_mov_b32 s78, 0
  s_mov_b32 s59, 0
  s_mov_b32 s70, 0xffff0000
  v_lshrrev_b32 v23, 7, v0
  v_and_b32 v22, 127, v0
  v_lshlrev_b32 v22, 1, v22
  v_lshl_add_u32 v22, v23, 13, v22
  s_lshl_b32 s50, s48, 8
  v_add_u32 v22, s50, v22
  global_load_ushort v188, v22, s[32:33]
  global_load_ushort v189, v22, s[34:35]
  global_load_ushort v190, v22, s[36:37]
  global_load_ushort v191, v22, s[38:39]
  v_lshlrev_b32 v23, 6, v23
  s_lshl_b32 s50, s48, 1
  v_add_u32 v23, s50, v23
  global_load_ushort v192, v23, s[40:41]
  v_mov_b32 v193, 0
  s_cmp_lg_u32 s44, 0
  s_cbranch_scc1 L_zf_2
  v_mov_b32 v6, 0
  s_add_u32 s51, s79, 1
  v_writelane_b32 v6, s51, 5
  v_lshlrev_b32 v5, 14, v1
  s_lshl_b32 s50, s2, 6
  v_add_u32 v5, s50, v5
  s_mov_b64 exec, 0xff
  buffer_store_dword v6, v5, s[16:19], 0 offen sc1
  v_mov_b32 v6, 0
  s_mov_b32 exec_lo, -1
  v_and_b32 v5, 7, v1
  s_lshl_b32 s50, s45, 3
  s_add_u32 s50, s50, s49
  v_add_u32 v5, s50, v5
  v_lshlrev_b32 v5, 2, v5
  v_lshrrev_b32 v7, 3, v1
  v_lshlrev_b32 v7, 13, v7
  v_add_u32 v5, v5, v7
  s_mov_b32 s50, 131072
  buffer_store_dword v6, v5, s[16:19], s50 offen sc1
  s_mov_b64 exec, -1
L_zf_2:
  s_add_u32 s75, s47, 1
  s_and_b32 s75, s75, 7
  s_lshl_b32 s76, s75, 7
  s_mul_i32 s77, s75, 196608
  s_add_u32 m0, s72, 24576
  s_nop 0
  buffer_load_dwordx4 v178, s[8:11], s77 offen lds
  s_add_u32 m0, s72, 25600
  s_nop 0
  buffer_load_dwordx4 v179, s[8:11], s77 offen lds
  s_add_u32 m0, s72, 32768
  s_add_u32 s77, s77, 1024
  buffer_load_dwordx4 v178, s[8:11], s77 offen lds
  s_add_u32 m0, s72, 33792
  s_nop 0
  buffer_load_dwordx4 v179, s[8:11], s77 offen lds
  s_add_u32 m0, s72, 40960
  s_add_u32 s77, s77, 1024
  buffer_load_dwordx4 v178, s[8:11], s77 offen lds
  s_add_u32 m0, s72, 41984
  s_nop 0
  buffer_load_dwordx4 v179, s[8:11], s77 offen lds
  s_add_u32 m0, s71, 10240
  s_nop 0
  buffer_load_dwordx4 v175, s[4:7], s76 offen lds
  s_add_u32 m0, s71, 11264
  s_nop 0
  buffer_load_dwordx4 v176, s[4:7], s76 offen lds
  s_add_u32 m0, s71, 12288
  s_mov_b32 exec_hi, 0
  buffer_load_dwordx4 v177, s[4:7], s76 offen lds
  s_mov_b32 exec_hi, -1
  v_lshlrev_b32 v254, 20, v1
  s_mov_b64 exec, 0x3fff
  buffer_load_dword v255, v254, s[16:19], 0 offen sc1
  s_mov_b64 exec, 0x3
  buffer_load_dword v255, v254, s[20:23], 0 offen sc1
  s_mov_b64 exec, -1
  v_mov_b32 v248, 0x3f803f80
  v_mov_b32 v249, 0x3f803f80
  v_mov_b32 v250, 0x3f803f80
  v_mov_b32 v251, 0x3f803f80
  v_lshrrev_b32 v182, 1, v2
  v_add_u32 v183, 0, v3
  v_xor_b32 v182, v182, v183
  v_lshlrev_b32 v182, 4, v182
  v_lshl_add_u32 v168, v2, 7, v182
  v_add_u32 v170, 40960, v168
  v_lshrrev_b32 v182, 1, v2
  v_add_u32 v183, 4, v3
  v_xor_b32 v182, v182, v183
  v_lshlrev_b32 v182, 4, v182
  v_lshl_add_u32 v169, v2, 7, v182
  v_add_u32 v171, 40960, v169
  v_lshrrev_b32 v182, 2, v2
  v_lshl_add_u32 v182, v3, 3, v182
  v_lshlrev_b32 v182, 7, v182
  v_lshrrev_b32 v183, 3, v2
  v_and_b32 v180, 1, v3
  v_lshl_or_b32 v183, v180, 1, v183
  v_xor_b32 v183, s44, v183
  v_lshl_add_u32 v182, v183, 5, v182
  v_and_b32 v183, 3, v2
  v_lshl_add_u32 v172, v183, 3, v182
  v_add_u32 v172, 81920, v172
  v_add_u32 v173, 24576, v172
  v_add_u32 v174, 49152, v172
  v_mov_b64 v[16:17], 0
  v_mov_b64 v[18:19], 0
  v_mov_b64 v[20:21], 0
  v_mov_b64 v[22:23], 0
  v_mov_b64 v[24:25], 0
  v_mov_b64 v[26:27], 0
  v_mov_b64 v[28:29], 0
  v_mov_b64 v[30:31], 0
  v_mov_b64 v[32:33], 0
  v_mov_b64 v[34:35], 0
  v_mov_b64 v[36:37], 0
  v_mov_b64 v[38:39], 0
  v_mov_b64 v[40:41], 0
  v_mov_b64 v[42:43], 0
  v_mov_b64 v[44:45], 0
  v_mov_b64 v[46:47], 0
  v_mov_b64 v[48:49], 0
  v_mov_b64 v[50:51], 0
  v_mov_b64 v[52:53], 0
  v_mov_b64 v[54:55], 0
  v_mov_b64 v[56:57], 0
  v_mov_b64 v[58:59], 0
  v_mov_b64 v[60:61], 0
  v_mov_b64 v[62:63], 0
  v_mov_b64 v[64:65], 0
  v_mov_b64 v[66:67], 0
  v_mov_b64 v[68:69], 0
  v_mov_b64 v[70:71], 0
  v_mov_b64 v[72:73], 0
  v_mov_b64 v[74:75], 0
  v_mov_b64 v[76:77], 0
  v_mov_b64 v[78:79], 0
  v_mov_b64 v[80:81], 0
  v_mov_b64 v[82:83], 0
  v_mov_b64 v[84:85], 0
  v_mov_b64 v[86:87], 0
  v_mov_b64 v[88:89], 0
  v_mov_b64 v[90:91], 0
  v_mov_b64 v[92:93], 0
  v_mov_b64 v[94:95], 0
  v_mov_b64 v[96:97], 0
  v_mov_b64 v[98:99], 0
  v_mov_b64 v[100:101], 0
  v_mov_b64 v[102:103], 0
  v_mov_b64 v[104:105], 0
  v_mov_b64 v[106:107], 0
  v_mov_b64 v[108:109], 0
  v_mov_b64 v[110:111], 0
  v_mov_b64 v[112:113], 0
  v_mov_b64 v[114:115], 0
  v_mov_b64 v[116:117], 0
  v_mov_b64 v[118:119], 0
  v_mov_b64 v[120:121], 0
  v_mov_b64 v[122:123], 0
  s_and_b32 s50, s44, 1
  s_lshl_b32 s50, s50, 2
  v_lshrrev_b32 v182, 1, v2
  v_add_u32 v183, s50, v3
  v_xor_b32 v182, v182, v183
  v_lshlrev_b32 v182, 4, v182
  v_lshl_add_u32 v182, v2, 7, v182
  s_lshr_b32 s50, s44, 1
  s_mul_i32 s50, s50, 10240
  v_add_u32 v184, s50, v182
  v_add_u32 v185, 40960, v184
  s_waitcnt vmcnt(11)
  s_barrier
  s_cmp_lg_u32 s44, 0
  s_cbranch_scc1 L_sa_3
  s_mov_b64 exec, 1
  s_and_b32 s57, s2, 3
  s_lshl_b32 s57, s57, 6
  v_mov_b32 v252, s57
  v_mov_b32 v253, 1
  buffer_atomic_add v253, v252, s[24:27], 0 offen sc1
  s_mov_b64 exec, -1
L_sa_3:
  ds_read_b128 v[128:131], v168 offset:0
  ds_read_b128 v[132:135], v168 offset:2048
  ds_read_b128 v[136:139], v168 offset:4096
  ds_read_b128 v[140:143], v168 offset:6144
  ds_read_b128 v[144:147], v168 offset:8192
  ds_read_b64_tr_b16 a[0:1], v172 offset:0
  ds_read_b64_tr_b16 a[2:3], v172 offset:512
  ds_read_b64_tr_b16 a[4:5], v172 offset:8192
  ds_read_b64_tr_b16 a[6:7], v172 offset:8704
  ds_read_b64_tr_b16 a[8:9], v172 offset:16384
  ds_read_b64_tr_b16 a[10:11], v172 offset:16896
  s_add_u32 s75, s47, 2
  s_and_b32 s75, s75, 7
  s_lshl_b32 s76, s75, 7
  s_mul_i32 s77, s75, 196608
  s_add_u32 m0, s72, 49152
  s_nop 0
  buffer_load_dwordx4 v178, s[8:11], s77 offen lds
  s_add_u32 m0, s72, 50176
  s_nop 0
  buffer_load_dwordx4 v179, s[8:11], s77 offen lds
  s_add_u32 m0, s72, 57344
  s_add_u32 s77, s77, 1024
  buffer_load_dwordx4 v178, s[8:11], s77 offen lds
  s_waitcnt lgkmcnt(0)
  v_mfma_f32_16x16x32_bf16 v[32:35], a[4:7], v[128:131], v[32:35]
  ds_read_b128 v[148:151], v169 offset:0
  v_mfma_f32_16x16x32_bf16 v[52:55], v[128:131], a[8:11], v[52:55]
  s_add_u32 m0, s72, 58368
  s_nop 0
  buffer_load_dwordx4 v179, s[8:11], s77 offen lds
  v_mfma_f32_16x16x32_bf16 v[36:39], a[4:7], v[132:135], v[36:39]
  ds_read_b128 v[152:155], v169 offset:2048
  v_mfma_f32_16x16x32_bf16 v[56:59], v[132:135], a[8:11], v[56:59]
  ds_read_b128 v[156:159], v169 offset:4096
  v_mfma_f32_16x16x32_bf16 v[16:19], a[0:3], v[132:135], v[16:19]
  ds_read_b128 v[160:163], v169 offset:6144
  v_mfma_f32_16x16x32_bf16 v[40:43], a[4:7], v[136:139], v[40:43]
  s_add_u32 m0, s72, 65536
  s_add_u32 s77, s77, 1024
  buffer_load_dwordx4 v178, s[8:11], s77 offen lds
  v_mfma_f32_16x16x32_bf16 v[60:63], v[136:139], a[8:11], v[60:63]
  ds_read_b128 v[164:167], v169 offset:8192
  v_mfma_f32_16x16x32_bf16 v[20:23], a[0:3], v[136:139], v[20:23]
  ds_read_b64_tr_b16 a[12:13], v172 offset:4096
  v_mfma_f32_16x16x32_bf16 v[44:47], a[4:7], v[140:143], v[44:47]
  ds_read_b64_tr_b16 a[14:15], v172 offset:4608
  v_mfma_f32_16x16x32_bf16 v[64:67], v[140:143], a[8:11], v[64:67]
  s_add_u32 m0, s72, 66560
  s_nop 0
  buffer_load_dwordx4 v179, s[8:11], s77 offen lds
  v_mfma_f32_16x16x32_bf16 v[24:27], a[0:3], v[140:143], v[24:27]
  ds_read_b64_tr_b16 a[16:17], v172 offset:12288
  v_mfma_f32_16x16x32_bf16 v[48:51], a[4:7], v[144:147], v[48:51]
  ds_read_b64_tr_b16 a[18:19], v172 offset:12800
  v_mfma_f32_16x16x32_bf16 v[68:71], v[144:147], a[8:11], v[68:71]
  ds_read_b64_tr_b16 a[20:21], v172 offset:20480
  v_mfma_f32_16x16x32_bf16 v[28:31], a[0:3], v[144:147], v[28:31]
  s_add_u32 m0, s71, 20480
  s_nop 0
  buffer_load_dwordx4 v175, s[4:7], s76 offen lds
  v_mfma_f32_16x16x32_bf16 v[112:115], a[0:3], v[248:251], v[112:115]
  ds_read_b64_tr_b16 a[22:23], v172 offset:20992
  v_mfma_f32_16x16x32_bf16 v[116:119], a[4:7], v[248:251], v[116:119]
  v_mfma_f32_16x16x32_bf16 v[120:123], v[248:251], a[8:11], v[120:123]
  s_add_u32 m0, s71, 21504
  s_nop 0
  buffer_load_dwordx4 v176, s[4:7], s76 offen lds
  s_add_u32 m0, s71, 22528
  s_mov_b32 exec_hi, 0
  buffer_load_dwordx4 v177, s[4:7], s76 offen lds
  s_mov_b32 exec_hi, -1
  s_waitcnt lgkmcnt(0)
  s_and_b32 s50, s48, 0x1fe
  s_lshl_b32 s50, s50, 1
  s_load_dword s80, s[42:43], s50
  s_add_u32 s51, s50, 64
  s_load_dword s81, s[42:43], s51
  v_and_b32 v208, 3, v2
  v_cmp_eq_u32 s[60:61], 1, v208
  v_cmp_eq_u32 s[62:63], 2, v208
  v_cmp_eq_u32 s[64:65], 3, v208
  v_lshrrev_b32 v208, 2, v2
  v_cmp_eq_u32 s[66:67], v208, v3
  v_and_b32 v208, 1, v2
  v_cmp_eq_u32 s[68:69], 1, v208
  v_lshl_add_u32 v209, v3, 2, v208
  v_add_u32 v210, 2, v209
  v_add_u32 v211, 2, v2
  v_mov_b32 v212, 0xf149f2ca
  v_mov_b32 v213, 0
  v_cmp_ge_u32 vcc, v209, v211
  s_nop 1
  v_cndmask_b32 v240, v212, v213, vcc
  v_cmp_ge_u32 vcc, v210, v211
  s_nop 1
  v_cndmask_b32 v241, v212, v213, vcc
  v_cmp_le_u32 vcc, v209, v2
  s_nop 1
  v_cndmask_b32 v242, v212, v213, vcc
  v_cmp_le_u32 vcc, v210, v2
  s_nop 1
  v_cndmask_b32 v243, v212, v213, vcc
  s_cmp_eq_u32 s46, 0
  s_cselect_b32 s51, -1, 0
  v_mov_b32 v211, s51
  v_cmp_ne_u32 vcc, 0, v211
  s_nop 1
  v_cndmask_b32 v244, v240, v212, vcc
  v_cndmask_b32 v245, v241, v212, vcc
  v_mov_b32 v211, 1.0
  v_cndmask_b32 v246, v211, v213, s[68:69]
  v_cndmask_b32 v247, v213, v211, s[68:69]
  s_waitcnt lgkmcnt(0)
  s_and_b32 s50, s48, 1
  s_xor_b32 s50, s50, 1
  s_lshl_b32 s50, s50, 4
  s_lshl_b32 s80, s80, s50
  s_lshl_b32 s81, s81, s50
  s_and_b32 s80, s80, 0xffff0000
  s_and_b32 s81, s81, 0xffff0000
  s_waitcnt vmcnt(11)
  s_barrier
  v_mfma_f32_16x16x32_bf16 v[32:35], a[16:19], v[148:151], v[32:35]
  ds_read_b128 v[128:131], v168 offset:10240
  v_mfma_f32_16x16x32_bf16 v[52:55], v[148:151], a[20:23], v[52:55]
  s_add_u32 s75, s47, 3
  s_and_b32 s75, s75, 7
  s_lshl_b32 s76, s75, 7
  s_mul_i32 s77, s75, 196608
  s_add_u32 m0, s72, 0
  s_nop 0
  buffer_load_dwordx4 v178, s[8:11], s77 offen lds
  v_mfma_f32_16x16x32_bf16 v[36:39], a[16:19], v[152:155], v[36:39]
  ds_read_b128 v[132:135], v168 offset:12288
  v_mfma_f32_16x16x32_bf16 v[56:59], v[152:155], a[20:23], v[56:59]
  ds_read_b128 v[136:139], v168 offset:14336
  v_mfma_f32_16x16x32_bf16 v[16:19], a[12:15], v[152:155], v[16:19]
  ds_read_b128 v[140:143], v168 offset:16384
  v_mfma_f32_16x16x32_bf16 v[40:43], a[16:19], v[156:159], v[40:43]
  s_add_u32 m0, s72, 1024
  s_nop 0
  buffer_load_dwordx4 v179, s[8:11], s77 offen lds
  v_mfma_f32_16x16x32_bf16 v[60:63], v[156:159], a[20:23], v[60:63]
  ds_read_b128 v[144:147], v168 offset:18432
  v_mfma_f32_16x16x32_bf16 v[20:23], a[12:15], v[156:159], v[20:23]
  ds_read_b64_tr_b16 a[24:25], v173 offset:0
  v_mfma_f32_16x16x32_bf16 v[44:47], a[16:19], v[160:163], v[44:47]
  ds_read_b64_tr_b16 a[26:27], v173 offset:512
  v_mfma_f32_16x16x32_bf16 v[64:67], v[160:163], a[20:23], v[64:67]
  s_add_u32 m0, s72, 8192
  s_add_u32 s77, s77, 1024
  buffer_load_dwordx4 v178, s[8:11], s77 offen lds
  v_mfma_f32_16x16x32_bf16 v[24:27], a[12:15], v[160:163], v[24:27]
  ds_read_b64_tr_b16 a[28:29], v173 offset:8192
  v_mfma_f32_16x16x32_bf16 v[48:51], a[16:19], v[164:167], v[48:51]
  ds_read_b64_tr_b16 a[30:31], v173 offset:8704
  v_mfma_f32_16x16x32_bf16 v[68:71], v[164:167], a[20:23], v[68:71]
  ds_read_b64_tr_b16 a[32:33], v173 offset:16384
  v_mfma_f32_16x16x32_bf16 v[28:31], a[12:15], v[164:167], v[28:31]
  s_add_u32 m0, s72, 9216
  s_nop 0
  buffer_load_dwordx4 v179, s[8:11], s77 offen lds
  v_mfma_f32_16x16x32_bf16 v[112:115], a[12:15], v[248:251], v[112:115]
  ds_read_b64_tr_b16 a[34:35], v173 offset:16896
  v_mfma_f32_16x16x32_bf16 v[116:119], a[16:19], v[248:251], v[116:119]
  ds_read_b128 v[196:199], v184 offset:0
  v_mfma_f32_16x16x32_bf16 v[120:123], v[248:251], a[20:23], v[120:123]
  s_add_u32 m0, s72, 16384
  s_add_u32 s77, s77, 1024
  buffer_load_dwordx4 v178, s[8:11], s77 offen lds
  s_waitcnt lgkmcnt(0)
  v_mfma_f32_16x16x32_bf16 v[72:75], v[248:251], v[196:199], v[72:75]
  ds_read_b128 v[148:151], v169 offset:10240
  v_mfma_f32_16x16x32_bf16 v[92:95], v[196:199], v[196:199], v[92:95]
  s_add_u32 m0, s72, 17408
  s_nop 0
  buffer_load_dwordx4 v179, s[8:11], s77 offen lds
  v_mfma_f32_16x16x32_bf16 v[32:35], a[28:31], v[128:131], v[32:35]
  ds_read_b128 v[152:155], v169 offset:12288
  v_mfma_f32_16x16x32_bf16 v[52:55], v[128:131], a[32:35], v[52:55]
  ds_read_b128 v[156:159], v169 offset:14336
  v_mfma_f32_16x16x32_bf16 v[36:39], a[28:31], v[132:135], v[36:39]
  ds_read_b128 v[160:163], v169 offset:16384
  v_mfma_f32_16x16x32_bf16 v[56:59], v[132:135], a[32:35], v[56:59]
  s_add_u32 m0, s71, 30720
  s_nop 0
  buffer_load_dwordx4 v175, s[4:7], s76 offen lds
  v_mfma_f32_16x16x32_bf16 v[16:19], a[24:27], v[132:135], v[16:19]
  ds_read_b128 v[164:167], v169 offset:18432
  v_mfma_f32_16x16x32_bf16 v[40:43], a[28:31], v[136:139], v[40:43]
  ds_read_b64_tr_b16 a[36:37], v173 offset:4096
  v_mfma_f32_16x16x32_bf16 v[60:63], v[136:139], a[32:35], v[60:63]
  ds_read_b64_tr_b16 a[38:39], v173 offset:4608
  v_mfma_f32_16x16x32_bf16 v[20:23], a[24:27], v[136:139], v[20:23]
  s_add_u32 m0, s71, 31744
  s_nop 0
  buffer_load_dwordx4 v176, s[4:7], s76 offen lds
  v_mfma_f32_16x16x32_bf16 v[44:47], a[28:31], v[140:143], v[44:47]
  ds_read_b64_tr_b16 a[40:41], v173 offset:12288
  v_mfma_f32_16x16x32_bf16 v[64:67], v[140:143], a[32:35], v[64:67]
  ds_read_b64_tr_b16 a[42:43], v173 offset:12800
  v_mfma_f32_16x16x32_bf16 v[24:27], a[24:27], v[140:143], v[24:27]
  ds_read_b64_tr_b16 a[44:45], v173 offset:20480
  v_mfma_f32_16x16x32_bf16 v[48:51], a[28:31], v[144:147], v[48:51]
  s_add_u32 m0, s71, 32768
  s_mov_b32 exec_hi, 0
  buffer_load_dwordx4 v177, s[4:7], s76 offen lds
  s_mov_b32 exec_hi, -1
  v_mfma_f32_16x16x32_bf16 v[68:71], v[144:147], a[32:35], v[68:71]
  ds_read_b64_tr_b16 a[46:47], v173 offset:20992
  v_mfma_f32_16x16x32_bf16 v[28:31], a[24:27], v[144:147], v[28:31]
  ds_read_b128 v[200:203], v184 offset:2048
  v_mfma_f32_16x16x32_bf16 v[112:115], a[24:27], v[248:251], v[112:115]
  ds_read_b128 v[204:207], v184 offset:4096
  v_mfma_f32_16x16x32_bf16 v[116:119], a[28:31], v[248:251], v[116:119]
  v_mfma_f32_16x16x32_bf16 v[120:123], v[248:251], a[32:35], v[120:123]
  s_waitcnt lgkmcnt(0)
  v_lshrrev_b32 v180, 3, v1
  v_and_b32 v181, 7, v1
  v_lshrrev_b32 v183, 4, v1
  v_and_b32 v183, 1, v183
  v_lshrrev_b32 v182, 1, v181
  v_xor_b32 v183, v183, v182
  v_lshlrev_b32 v183, 5, v183
  v_and_b32 v182, 1, v1
  v_lshl_add_u32 v183, v182, 4, v183
  s_lshl_b32 s51, s45, 7
  v_add_u32 v183, s51, v183
  v_lshl_add_u32 v186, v180, 10, v183
  v_xor_b32 v187, 64, v186
  s_lshl_b32 s28, s44, 14
  s_lshl_b32 s29, s44, 11
  s_waitcnt vmcnt(9)
  s_barrier
  v_mfma_f32_16x16x32_bf16 v[76:79], v[248:251], v[200:203], v[76:79]
  ds_read_b128 v[128:131], v168 offset:20480
  v_mfma_f32_16x16x32_bf16 v[96:99], v[200:203], v[200:203], v[96:99]
  s_add_u32 s75, s47, 4
  s_and_b32 s75, s75, 7
  s_lshl_b32 s76, s75, 7
  s_mul_i32 s77, s75, 196608
  s_add_u32 m0, s72, 24576
  s_nop 0
  buffer_load_dwordx4 v178, s[8:11], s77 offen lds
  v_mfma_f32_16x16x32_bf16 v[80:83], v[248:251], v[204:207], v[80:83]
  ds_read_b128 v[132:135], v168 offset:22528
  v_mfma_f32_16x16x32_bf16 v[100:103], v[204:207], v[204:207], v[100:103]
  ds_read_b128 v[136:139], v168 offset:24576
  v_mfma_f32_16x16x32_bf16 v[32:35], a[40:43], v[148:151], v[32:35]
  ds_read_b128 v[140:143], v168 offset:26624
  v_mfma_f32_16x16x32_bf16 v[52:55], v[148:151], a[44:47], v[52:55]
  s_add_u32 m0, s72, 25600
  s_nop 0
  buffer_load_dwordx4 v179, s[8:11], s77 offen lds
  v_mfma_f32_16x16x32_bf16 v[36:39], a[40:43], v[152:155], v[36:39]
  ds_read_b128 v[144:147], v168 offset:28672
  v_mfma_f32_16x16x32_bf16 v[56:59], v[152:155], a[44:47], v[56:59]
  ds_read_b64_tr_b16 a[48:49], v174 offset:0
  v_mfma_f32_16x16x32_bf16 v[16:19], a[36:39], v[152:155], v[16:19]
  ds_read_b64_tr_b16 a[50:51], v174 offset:512
  v_mfma_f32_16x16x32_bf16 v[40:43], a[40:43], v[156:159], v[40:43]
  s_add_u32 m0, s72, 32768
  s_add_u32 s77, s77, 1024
  buffer_load_dwordx4 v178, s[8:11], s77 offen lds
  v_mfma_f32_16x16x32_bf16 v[60:63], v[156:159], a[44:47], v[60:63]
  ds_read_b64_tr_b16 a[52:53], v174 offset:8192
  v_mfma_f32_16x16x32_bf16 v[20:23], a[36:39], v[156:159], v[20:23]
  ds_read_b64_tr_b16 a[54:55], v174 offset:8704
  v_mfma_f32_16x16x32_bf16 v[44:47], a[40:43], v[160:163], v[44:47]
  ds_read_b64_tr_b16 a[56:57], v174 offset:16384
  v_mfma_f32_16x16x32_bf16 v[64:67], v[160:163], a[44:47], v[64:67]
  s_add_u32 m0, s72, 33792
  s_nop 0
  buffer_load_dwordx4 v179, s[8:11], s77 offen lds
  v_mfma_f32_16x16x32_bf16 v[24:27], a[36:39], v[160:163], v[24:27]
  ds_read_b64_tr_b16 a[58:59], v174 offset:16896
  v_mfma_f32_16x16x32_bf16 v[48:51], a[40:43], v[164:167], v[48:51]
  ds_read_b128 v[208:211], v184 offset:6144
  v_mfma_f32_16x16x32_bf16 v[68:71], v[164:167], a[44:47], v[68:71]
  v_mfma_f32_16x16x32_bf16 v[28:31], a[36:39], v[164:167], v[28:31]
  s_add_u32 m0, s72, 40960
  s_add_u32 s77, s77, 1024
  buffer_load_dwordx4 v178, s[8:11], s77 offen lds
  v_mfma_f32_16x16x32_bf16 v[112:115], a[36:39], v[248:251], v[112:115]
  v_mfma_f32_16x16x32_bf16 v[116:119], a[40:43], v[248:251], v[116:119]
  v_mfma_f32_16x16x32_bf16 v[120:123], v[248:251], a[44:47], v[120:123]
  s_waitcnt lgkmcnt(0)
  v_mfma_f32_16x16x32_bf16 v[84:87], v[248:251], v[208:211], v[84:87]
  ds_read_b128 v[148:151], v169 offset:20480
  v_mfma_f32_16x16x32_bf16 v[104:107], v[208:211], v[208:211], v[104:107]
  s_add_u32 m0, s72, 41984
  s_nop 0
  buffer_load_dwordx4 v179, s[8:11], s77 offen lds
  v_mfma_f32_16x16x32_bf16 v[32:35], a[52:55], v[128:131], v[32:35]
  ds_read_b128 v[152:155], v169 offset:22528
  v_mfma_f32_16x16x32_bf16 v[52:55], v[128:131], a[56:59], v[52:55]
  ds_read_b128 v[156:159], v169 offset:24576
  v_mfma_f32_16x16x32_bf16 v[36:39], a[52:55], v[132:135], v[36:39]
  ds_read_b128 v[160:163], v169 offset:26624
  v_mfma_f32_16x16x32_bf16 v[56:59], v[132:135], a[56:59], v[56:59]
  s_add_u32 m0, s71, 40960
  s_nop 0
  buffer_load_dwordx4 v175, s[4:7], s76 offen lds
  v_mfma_f32_16x16x32_bf16 v[16:19], a[48:51], v[132:135], v[16:19]
  ds_read_b128 v[164:167], v169 offset:28672
  v_mfma_f32_16x16x32_bf16 v[40:43], a[52:55], v[136:139], v[40:43]
  ds_read_b64_tr_b16 a[60:61], v174 offset:4096
  v_mfma_f32_16x16x32_bf16 v[60:63], v[136:139], a[56:59], v[60:63]
  ds_read_b64_tr_b16 a[62:63], v174 offset:4608
  v_mfma_f32_16x16x32_bf16 v[20:23], a[48:51], v[136:139], v[20:23]
  s_add_u32 m0, s71, 41984
  s_nop 0
  buffer_load_dwordx4 v176, s[4:7], s76 offen lds
  v_mfma_f32_16x16x32_bf16 v[44:47], a[52:55], v[140:143], v[44:47]
  ds_read_b64_tr_b16 a[64:65], v174 offset:12288
  v_mfma_f32_16x16x32_bf16 v[64:67], v[140:143], a[56:59], v[64:67]
  ds_read_b64_tr_b16 a[66:67], v174 offset:12800
  v_mfma_f32_16x16x32_bf16 v[24:27], a[48:51], v[140:143], v[24:27]
  ds_read_b64_tr_b16 a[68:69], v174 offset:20480
  v_mfma_f32_16x16x32_bf16 v[48:51], a[52:55], v[144:147], v[48:51]
  s_add_u32 m0, s71, 43008
  s_mov_b32 exec_hi, 0
  buffer_load_dwordx4 v177, s[4:7], s76 offen lds
  s_mov_b32 exec_hi, -1
  v_mfma_f32_16x16x32_bf16 v[68:71], v[144:147], a[56:59], v[68:71]
  ds_read_b64_tr_b16 a[70:71], v174 offset:20992
  v_mfma_f32_16x16x32_bf16 v[28:31], a[48:51], v[144:147], v[28:31]
  ds_read_b128 v[212:215], v184 offset:8192
  v_mfma_f32_16x16x32_bf16 v[112:115], a[48:51], v[248:251], v[112:115]
  v_mfma_f32_16x16x32_bf16 v[116:119], a[52:55], v[248:251], v[116:119]
  v_mfma_f32_16x16x32_bf16 v[120:123], v[248:251], a[56:59], v[120:123]
  s_waitcnt lgkmcnt(0)
  s_waitcnt vmcnt(9)
  s_barrier
  v_mfma_f32_16x16x32_bf16 v[88:91], v[248:251], v[212:215], v[88:91]
  ds_read_b128 v[128:131], v168 offset:30720
  v_mfma_f32_16x16x32_bf16 v[108:111], v[212:215], v[212:215], v[108:111]
  s_add_u32 s75, s47, 5
  s_and_b32 s75, s75, 7
  s_lshl_b32 s76, s75, 7
  s_mul_i32 s77, s75, 196608
  s_add_u32 m0, s72, 49152
  s_nop 0
  buffer_load_dwordx4 v178, s[8:11], s77 offen lds
  v_mfma_f32_16x16x32_bf16 v[32:35], a[64:67], v[148:151], v[32:35]
  ds_read_b128 v[132:135], v168 offset:32768
  v_mfma_f32_16x16x32_bf16 v[52:55], v[148:151], a[68:71], v[52:55]
  ds_read_b128 v[136:139], v168 offset:34816
  v_mfma_f32_16x16x32_bf16 v[36:39], a[64:67], v[152:155], v[36:39]
  ds_read_b128 v[140:143], v168 offset:36864
  v_mfma_f32_16x16x32_bf16 v[56:59], v[152:155], a[68:71], v[56:59]
  s_add_u32 m0, s72, 50176
  s_nop 0
  buffer_load_dwordx4 v179, s[8:11], s77 offen lds
  v_mfma_f32_16x16x32_bf16 v[16:19], a[60:63], v[152:155], v[16:19]
  ds_read_b128 v[144:147], v168 offset:38912
  v_mfma_f32_16x16x32_bf16 v[40:43], a[64:67], v[156:159], v[40:43]
  ds_read_b64_tr_b16 a[72:73], v172 offset:0
  v_mfma_f32_16x16x32_bf16 v[60:63], v[156:159], a[68:71], v[60:63]
  ds_read_b64_tr_b16 a[74:75], v172 offset:512
  v_mfma_f32_16x16x32_bf16 v[20:23], a[60:63], v[156:159], v[20:23]
  s_add_u32 m0, s72, 57344
  s_add_u32 s77, s77, 1024
  buffer_load_dwordx4 v178, s[8:11], s77 offen lds
  v_mfma_f32_16x16x32_bf16 v[44:47], a[64:67], v[160:163], v[44:47]
  ds_read_b64_tr_b16 a[76:77], v172 offset:8192
  v_mfma_f32_16x16x32_bf16 v[64:67], v[160:163], a[68:71], v[64:67]
  ds_read_b64_tr_b16 a[78:79], v172 offset:8704
  v_mfma_f32_16x16x32_bf16 v[24:27], a[60:63], v[160:163], v[24:27]
  ds_read_b64_tr_b16 a[80:81], v172 offset:16384
  v_mfma_f32_16x16x32_bf16 v[48:51], a[64:67], v[164:167], v[48:51]
  s_add_u32 m0, s72, 58368
  s_nop 0
  buffer_load_dwordx4 v179, s[8:11], s77 offen lds
  v_mfma_f32_16x16x32_bf16 v[68:71], v[164:167], a[68:71], v[68:71]
  ds_read_b64_tr_b16 a[82:83], v172 offset:16896
  v_mfma_f32_16x16x32_bf16 v[28:31], a[60:63], v[164:167], v[28:31]
  ds_read_b128 v[196:199], v184 offset:20480
  v_mfma_f32_16x16x32_bf16 v[112:115], a[60:63], v[248:251], v[112:115]
  v_mfma_f32_16x16x32_bf16 v[116:119], a[64:67], v[248:251], v[116:119]
  s_add_u32 m0, s72, 65536
  s_add_u32 s77, s77, 1024
  buffer_load_dwordx4 v178, s[8:11], s77 offen lds
  v_mfma_f32_16x16x32_bf16 v[120:123], v[248:251], a[68:71], v[120:123]
  s_waitcnt lgkmcnt(0)
  v_mfma_f32_16x16x32_bf16 v[72:75], v[248:251], v[196:199], v[72:75]
  ds_read_b128 v[148:151], v169 offset:30720
  v_mfma_f32_16x16x32_bf16 v[92:95], v[196:199], v[196:199], v[92:95]
  s_add_u32 m0, s72, 66560
  s_nop 0
  buffer_load_dwordx4 v179, s[8:11], s77 offen lds
  v_mfma_f32_16x16x32_bf16 v[32:35], a[76:79], v[128:131], v[32:35]
  ds_read_b128 v[152:155], v169 offset:32768
  v_mfma_f32_16x16x32_bf16 v[52:55], v[128:131], a[80:83], v[52:55]
  ds_read_b128 v[156:159], v169 offset:34816
  v_mfma_f32_16x16x32_bf16 v[36:39], a[76:79], v[132:135], v[36:39]
  ds_read_b128 v[160:163], v169 offset:36864
  v_mfma_f32_16x16x32_bf16 v[56:59], v[132:135], a[80:83], v[56:59]
  s_add_u32 m0, s71, 51200
  s_nop 0
  buffer_load_dwordx4 v175, s[4:7], s76 offen lds
  v_mfma_f32_16x16x32_bf16 v[16:19], a[72:75], v[132:135], v[16:19]
  ds_read_b128 v[164:167], v169 offset:38912
  v_mfma_f32_16x16x32_bf16 v[40:43], a[76:79], v[136:139], v[40:43]
  ds_read_b64_tr_b16 a[84:85], v172 offset:4096
  v_mfma_f32_16x16x32_bf16 v[60:63], v[136:139], a[80:83], v[60:63]
  ds_read_b64_tr_b16 a[86:87], v172 offset:4608
  v_mfma_f32_16x16x32_bf16 v[20:23], a[72:75], v[136:139], v[20:23]
  s_add_u32 m0, s71, 52224
  s_nop 0
  buffer_load_dwordx4 v176, s[4:7], s76 offen lds
  v_mfma_f32_16x16x32_bf16 v[44:47], a[76:79], v[140:143], v[44:47]
  ds_read_b64_tr_b16 a[88:89], v172 offset:12288
  v_mfma_f32_16x16x32_bf16 v[64:67], v[140:143], a[80:83], v[64:67]
  ds_read_b64_tr_b16 a[90:91], v172 offset:12800
  v_mfma_f32_16x16x32_bf16 v[24:27], a[72:75], v[140:143], v[24:27]
  ds_read_b64_tr_b16 a[92:93], v172 offset:20480
  v_mfma_f32_16x16x32_bf16 v[48:51], a[76:79], v[144:147], v[48:51]
  s_add_u32 m0, s71, 53248
  s_mov_b32 exec_hi, 0
  buffer_load_dwordx4 v177, s[4:7], s76 offen lds
  s_mov_b32 exec_hi, -1
  v_mfma_f32_16x16x32_bf16 v[68:71], v[144:147], a[80:83], v[68:71]
  ds_read_b64_tr_b16 a[94:95], v172 offset:20992
  v_mfma_f32_16x16x32_bf16 v[28:31], a[72:75], v[144:147], v[28:31]
  ds_read_b128 v[200:203], v184 offset:22528
  v_mfma_f32_16x16x32_bf16 v[112:115], a[72:75], v[248:251], v[112:115]
  ds_read_b128 v[204:207], v184 offset:24576
  v_mfma_f32_16x16x32_bf16 v[116:119], a[76:79], v[248:251], v[116:119]
  v_mfma_f32_16x16x32_bf16 v[120:123], v[248:251], a[80:83], v[120:123]
  s_waitcnt lgkmcnt(0)
  s_waitcnt vmcnt(9)
  s_barrier
  v_mfma_f32_16x16x32_bf16 v[76:79], v[248:251], v[200:203], v[76:79]
  ds_read_b128 v[128:131], v170 offset:0
  v_mfma_f32_16x16x32_bf16 v[96:99], v[200:203], v[200:203], v[96:99]
  s_add_u32 s75, s47, 6
  s_and_b32 s75, s75, 7
  s_lshl_b32 s76, s75, 7
  s_mul_i32 s77, s75, 196608
  s_add_u32 m0, s72, 0
  s_nop 0
  buffer_load_dwordx4 v178, s[8:11], s77 offen lds
  v_mfma_f32_16x16x32_bf16 v[80:83], v[248:251], v[204:207], v[80:83]
  ds_read_b128 v[132:135], v170 offset:2048
  v_mfma_f32_16x16x32_bf16 v[100:103], v[204:207], v[204:207], v[100:103]
  ds_read_b128 v[136:139], v170 offset:4096
  v_mfma_f32_16x16x32_bf16 v[32:35], a[88:91], v[148:151], v[32:35]
  ds_read_b128 v[140:143], v170 offset:6144
  v_mfma_f32_16x16x32_bf16 v[52:55], v[148:151], a[92:95], v[52:55]
  s_add_u32 m0, s72, 1024
  s_nop 0
  buffer_load_dwordx4 v179, s[8:11], s77 offen lds
  v_mfma_f32_16x16x32_bf16 v[36:39], a[88:91], v[152:155], v[36:39]
  ds_read_b128 v[144:147], v170 offset:8192
  v_mfma_f32_16x16x32_bf16 v[56:59], v[152:155], a[92:95], v[56:59]
  ds_read_b64_tr_b16 a[96:97], v173 offset:0
  v_mfma_f32_16x16x32_bf16 v[16:19], a[84:87], v[152:155], v[16:19]
  ds_read_b64_tr_b16 a[98:99], v173 offset:512
  v_mfma_f32_16x16x32_bf16 v[40:43], a[88:91], v[156:159], v[40:43]
  s_add_u32 m0, s72, 8192
  s_add_u32 s77, s77, 1024
  buffer_load_dwordx4 v178, s[8:11], s77 offen lds
  v_mfma_f32_16x16x32_bf16 v[60:63], v[156:159], a[92:95], v[60:63]
  ds_read_b64_tr_b16 a[100:101], v173 offset:8192
  v_mfma_f32_16x16x32_bf16 v[20:23], a[84:87], v[156:159], v[20:23]
  ds_read_b64_tr_b16 a[102:103], v173 offset:8704
  v_mfma_f32_16x16x32_bf16 v[44:47], a[88:91], v[160:163], v[44:47]
  ds_read_b64_tr_b16 a[104:105], v173 offset:16384
  v_mfma_f32_16x16x32_bf16 v[64:67], v[160:163], a[92:95], v[64:67]
  s_add_u32 m0, s72, 9216
  s_nop 0
  buffer_load_dwordx4 v179, s[8:11], s77 offen lds
  v_mfma_f32_16x16x32_bf16 v[24:27], a[84:87], v[160:163], v[24:27]
  ds_read_b64_tr_b16 a[106:107], v173 offset:16896
  v_mfma_f32_16x16x32_bf16 v[48:51], a[88:91], v[164:167], v[48:51]
  ds_read_b128 v[208:211], v184 offset:26624
  v_mfma_f32_16x16x32_bf16 v[68:71], v[164:167], a[92:95], v[68:71]
  v_mfma_f32_16x16x32_bf16 v[28:31], a[84:87], v[164:167], v[28:31]
  s_add_u32 m0, s72, 16384
  s_add_u32 s77, s77, 1024
  buffer_load_dwordx4 v178, s[8:11], s77 offen lds
  v_mfma_f32_16x16x32_bf16 v[112:115], a[84:87], v[248:251], v[112:115]
  v_mfma_f32_16x16x32_bf16 v[116:119], a[88:91], v[248:251], v[116:119]
  v_mfma_f32_16x16x32_bf16 v[120:123], v[248:251], a[92:95], v[120:123]
  s_waitcnt lgkmcnt(0)
  v_mfma_f32_16x16x32_bf16 v[84:87], v[248:251], v[208:211], v[84:87]
  ds_read_b128 v[148:151], v171 offset:0
  v_mfma_f32_16x16x32_bf16 v[104:107], v[208:211], v[208:211], v[104:107]
  s_add_u32 m0, s72, 17408
  s_nop 0
  buffer_load_dwordx4 v179, s[8:11], s77 offen lds
  v_mfma_f32_16x16x32_bf16 v[32:35], a[100:103], v[128:131], v[32:35]
  ds_read_b128 v[152:155], v171 offset:2048
  v_mfma_f32_16x16x32_bf16 v[52:55], v[128:131], a[104:107], v[52:55]
  ds_read_b128 v[156:159], v171 offset:4096
  v_mfma_f32_16x16x32_bf16 v[36:39], a[100:103], v[132:135], v[36:39]
  ds_read_b128 v[160:163], v171 offset:6144
  v_mfma_f32_16x16x32_bf16 v[56:59], v[132:135], a[104:107], v[56:59]
  s_add_u32 m0, s71, 61440
  s_nop 0
  buffer_load_dwordx4 v175, s[4:7], s76 offen lds
  v_mfma_f32_16x16x32_bf16 v[16:19], a[96:99], v[132:135], v[16:19]
  ds_read_b128 v[164:167], v171 offset:8192
  v_mfma_f32_16x16x32_bf16 v[40:43], a[100:103], v[136:139], v[40:43]
  ds_read_b64_tr_b16 a[108:109], v173 offset:4096
  v_mfma_f32_16x16x32_bf16 v[60:63], v[136:139], a[104:107], v[60:63]
  ds_read_b64_tr_b16 a[110:111], v173 offset:4608
  v_mfma_f32_16x16x32_bf16 v[20:23], a[96:99], v[136:139], v[20:23]
  s_add_u32 m0, s71, 62464
  s_nop 0
  buffer_load_dwordx4 v176, s[4:7], s76 offen lds
  v_mfma_f32_16x16x32_bf16 v[44:47], a[100:103], v[140:143], v[44:47]
  ds_read_b64_tr_b16 a[112:113], v173 offset:12288
  v_mfma_f32_16x16x32_bf16 v[64:67], v[140:143], a[104:107], v[64:67]
  ds_read_b64_tr_b16 a[114:115], v173 offset:12800
  v_mfma_f32_16x16x32_bf16 v[24:27], a[96:99], v[140:143], v[24:27]
  ds_read_b64_tr_b16 a[116:117], v173 offset:20480
  v_mfma_f32_16x16x32_bf16 v[48:51], a[100:103], v[144:147], v[48:51]
  s_add_u32 m0, s71, 63488
  s_mov_b32 exec_hi, 0
  buffer_load_dwordx4 v177, s[4:7], s76 offen lds
  s_mov_b32 exec_hi, -1
  v_mfma_f32_16x16x32_bf16 v[68:71], v[144:147], a[104:107], v[68:71]
  ds_read_b64_tr_b16 a[118:119], v173 offset:20992
  v_mfma_f32_16x16x32_bf16 v[28:31], a[96:99], v[144:147], v[28:31]
  ds_read_b128 v[212:215], v184 offset:28672
  v_mfma_f32_16x16x32_bf16 v[112:115], a[96:99], v[248:251], v[112:115]
  v_mfma_f32_16x16x32_bf16 v[116:119], a[100:103], v[248:251], v[116:119]
  v_mfma_f32_16x16x32_bf16 v[120:123], v[248:251], a[104:107], v[120:123]
  s_waitcnt lgkmcnt(0)
  s_waitcnt vmcnt(9)
  s_barrier
  v_mfma_f32_16x16x32_bf16 v[88:91], v[248:251], v[212:215], v[88:91]
  ds_read_b128 v[128:131], v170 offset:10240
  v_mfma_f32_16x16x32_bf16 v[108:111], v[212:215], v[212:215], v[108:111]
  s_add_u32 s75, s47, 7
  s_and_b32 s75, s75, 7
  s_lshl_b32 s76, s75, 7
  s_mul_i32 s77, s75, 196608
  s_add_u32 m0, s72, 24576
  s_nop 0
  buffer_load_dwordx4 v178, s[8:11], s77 offen lds
  v_mfma_f32_16x16x32_bf16 v[32:35], a[112:115], v[148:151], v[32:35]
  ds_read_b128 v[132:135], v170 offset:12288
  v_mfma_f32_16x16x32_bf16 v[52:55], v[148:151], a[116:119], v[52:55]
  ds_read_b128 v[136:139], v170 offset:14336
  v_mfma_f32_16x16x32_bf16 v[36:39], a[112:115], v[152:155], v[36:39]
  ds_read_b128 v[140:143], v170 offset:16384
  v_mfma_f32_16x16x32_bf16 v[56:59], v[152:155], a[116:119], v[56:59]
  s_add_u32 m0, s72, 25600
  s_nop 0
  buffer_load_dwordx4 v179, s[8:11], s77 offen lds
  v_mfma_f32_16x16x32_bf16 v[16:19], a[108:111], v[152:155], v[16:19]
  ds_read_b128 v[144:147], v170 offset:18432
  v_mfma_f32_16x16x32_bf16 v[40:43], a[112:115], v[156:159], v[40:43]
  ds_read_b64_tr_b16 a[120:121], v174 offset:0
  v_mfma_f32_16x16x32_bf16 v[60:63], v[156:159], a[116:119], v[60:63]
  ds_read_b64_tr_b16 a[122:123], v174 offset:512
  v_mfma_f32_16x16x32_bf16 v[20:23], a[108:111], v[156:159], v[20:23]
  s_add_u32 m0, s72, 32768
  s_add_u32 s77, s77, 1024
  buffer_load_dwordx4 v178, s[8:11], s77 offen lds
  v_mfma_f32_16x16x32_bf16 v[44:47], a[112:115], v[160:163], v[44:47]
  ds_read_b64_tr_b16 a[124:125], v174 offset:8192
  v_mfma_f32_16x16x32_bf16 v[64:67], v[160:163], a[116:119], v[64:67]
  ds_read_b64_tr_b16 a[126:127], v174 offset:8704
  v_mfma_f32_16x16x32_bf16 v[24:27], a[108:111], v[160:163], v[24:27]
  ds_read_b64_tr_b16 a[128:129], v174 offset:16384
  v_mfma_f32_16x16x32_bf16 v[48:51], a[112:115], v[164:167], v[48:51]
  s_add_u32 m0, s72, 33792
  s_nop 0
  buffer_load_dwordx4 v179, s[8:11], s77 offen lds
  v_mfma_f32_16x16x32_bf16 v[68:71], v[164:167], a[116:119], v[68:71]
  ds_read_b64_tr_b16 a[130:131], v174 offset:16896
  v_mfma_f32_16x16x32_bf16 v[28:31], a[108:111], v[164:167], v[28:31]
  ds_read_b128 v[196:199], v185 offset:0
  v_mfma_f32_16x16x32_bf16 v[112:115], a[108:111], v[248:251], v[112:115]
  v_mfma_f32_16x16x32_bf16 v[116:119], a[112:115], v[248:251], v[116:119]
  s_add_u32 m0, s72, 40960
  s_add_u32 s77, s77, 1024
  buffer_load_dwordx4 v178, s[8:11], s77 offen lds
  v_mfma_f32_16x16x32_bf16 v[120:123], v[248:251], a[116:119], v[120:123]
  s_waitcnt lgkmcnt(0)
  v_mfma_f32_16x16x32_bf16 v[72:75], v[248:251], v[196:199], v[72:75]
  ds_read_b128 v[148:151], v171 offset:10240
  v_mfma_f32_16x16x32_bf16 v[92:95], v[196:199], v[196:199], v[92:95]
  s_add_u32 m0, s72, 41984
  s_nop 0
  buffer_load_dwordx4 v179, s[8:11], s77 offen lds
  v_mfma_f32_16x16x32_bf16 v[32:35], a[124:127], v[128:131], v[32:35]
  ds_read_b128 v[152:155], v171 offset:12288
  v_mfma_f32_16x16x32_bf16 v[52:55], v[128:131], a[128:131], v[52:55]
  ds_read_b128 v[156:159], v171 offset:14336
  v_mfma_f32_16x16x32_bf16 v[36:39], a[124:127], v[132:135], v[36:39]
  ds_read_b128 v[160:163], v171 offset:16384
  v_mfma_f32_16x16x32_bf16 v[56:59], v[132:135], a[128:131], v[56:59]
  s_add_u32 m0, s71, 71680
  s_nop 0
  buffer_load_dwordx4 v175, s[4:7], s76 offen lds
  v_mfma_f32_16x16x32_bf16 v[16:19], a[120:123], v[132:135], v[16:19]
  ds_read_b128 v[164:167], v171 offset:18432
  v_mfma_f32_16x16x32_bf16 v[40:43], a[124:127], v[136:139], v[40:43]
  ds_read_b64_tr_b16 a[132:133], v174 offset:4096
  v_mfma_f32_16x16x32_bf16 v[60:63], v[136:139], a[128:131], v[60:63]
  ds_read_b64_tr_b16 a[134:135], v174 offset:4608
  v_mfma_f32_16x16x32_bf16 v[20:23], a[120:123], v[136:139], v[20:23]
  s_add_u32 m0, s71, 72704
  s_nop 0
  buffer_load_dwordx4 v176, s[4:7], s76 offen lds
  v_mfma_f32_16x16x32_bf16 v[44:47], a[124:127], v[140:143], v[44:47]
  ds_read_b64_tr_b16 a[136:137], v174 offset:12288
  v_mfma_f32_16x16x32_bf16 v[64:67], v[140:143], a[128:131], v[64:67]
  ds_read_b64_tr_b16 a[138:139], v174 offset:12800
  v_mfma_f32_16x16x32_bf16 v[24:27], a[120:123], v[140:143], v[24:27]
  ds_read_b64_tr_b16 a[140:141], v174 offset:20480
  v_mfma_f32_16x16x32_bf16 v[48:51], a[124:127], v[144:147], v[48:51]
  s_add_u32 m0, s71, 73728
  s_mov_b32 exec_hi, 0
  buffer_load_dwordx4 v177, s[4:7], s76 offen lds
  s_mov_b32 exec_hi, -1
  v_mfma_f32_16x16x32_bf16 v[68:71], v[144:147], a[128:131], v[68:71]
  ds_read_b64_tr_b16 a[142:143], v174 offset:20992
  v_mfma_f32_16x16x32_bf16 v[28:31], a[120:123], v[144:147], v[28:31]
  ds_read_b128 v[200:203], v185 offset:2048
  v_mfma_f32_16x16x32_bf16 v[112:115], a[120:123], v[248:251], v[112:115]
  ds_read_b128 v[204:207], v185 offset:4096
  v_mfma_f32_16x16x32_bf16 v[116:119], a[124:127], v[248:251], v[116:119]
  v_mfma_f32_16x16x32_bf16 v[120:123], v[248:251], a[128:131], v[120:123]
  s_waitcnt lgkmcnt(0)
  s_waitcnt vmcnt(9)
  s_barrier
  v_mfma_f32_16x16x32_bf16 v[76:79], v[248:251], v[200:203], v[76:79]
  ds_read_b128 v[128:131], v170 offset:20480
  v_mfma_f32_16x16x32_bf16 v[96:99], v[200:203], v[200:203], v[96:99]
  s_add_u32 s76, s45, 0
  s_and_b32 s76, s76, 7
  s_lshl_b32 s76, s76, 16
  s_add_u32 s76, s76, s28
  s_add_u32 m0, s29, 131072
  s_nop 0
  buffer_load_dwordx4 v186, s[12:15], s76 offen lds
  v_mfma_f32_16x16x32_bf16 v[80:83], v[248:251], v[204:207], v[80:83]
  ds_read_b128 v[132:135], v170 offset:22528
  v_mfma_f32_16x16x32_bf16 v[100:103], v[204:207], v[204:207], v[100:103]
  ds_read_b128 v[136:139], v170 offset:24576
  v_mfma_f32_16x16x32_bf16 v[32:35], a[136:139], v[148:151], v[32:35]
  ds_read_b128 v[140:143], v170 offset:26624
  v_mfma_f32_16x16x32_bf16 v[52:55], v[148:151], a[140:143], v[52:55]
  s_add_u32 m0, s29, 132096
  s_add_u32 s76, s76, 8192
  buffer_load_dwordx4 v187, s[12:15], s76 offen lds
  v_mfma_f32_16x16x32_bf16 v[36:39], a[136:139], v[152:155], v[36:39]
  ds_read_b128 v[144:147], v170 offset:28672
  v_mfma_f32_16x16x32_bf16 v[56:59], v[152:155], a[140:143], v[56:59]
  ds_read_b64_tr_b16 a[144:145], v172 offset:0
  v_mfma_f32_16x16x32_bf16 v[16:19], a[132:135], v[152:155], v[16:19]
  ds_read_b64_tr_b16 a[146:147], v172 offset:512
  v_mfma_f32_16x16x32_bf16 v[40:43], a[136:139], v[156:159], v[40:43]
  s_add_u32 s76, s45, 1
  s_and_b32 s76, s76, 7
  s_lshl_b32 s76, s76, 16
  s_add_u32 s76, s76, s28
  s_add_u32 m0, s29, 139264
  s_nop 0
  buffer_load_dwordx4 v186, s[12:15], s76 offen lds
  v_mfma_f32_16x16x32_bf16 v[60:63], v[156:159], a[140:143], v[60:63]
  ds_read_b64_tr_b16 a[148:149], v172 offset:8192
  v_mfma_f32_16x16x32_bf16 v[20:23], a[132:135], v[156:159], v[20:23]
  ds_read_b64_tr_b16 a[150:151], v172 offset:8704
  v_mfma_f32_16x16x32_bf16 v[44:47], a[136:139], v[160:163], v[44:47]
  ds_read_b64_tr_b16 a[152:153], v172 offset:16384
  v_mfma_f32_16x16x32_bf16 v[64:67], v[160:163], a[140:143], v[64:67]
  ds_read_b64_tr_b16 a[154:155], v172 offset:16896
  v_mfma_f32_16x16x32_bf16 v[24:27], a[132:135], v[160:163], v[24:27]
  ds_read_b128 v[208:211], v185 offset:6144
  v_mfma_f32_16x16x32_bf16 v[48:51], a[136:139], v[164:167], v[48:51]
  v_mfma_f32_16x16x32_bf16 v[68:71], v[164:167], a[140:143], v[68:71]
  v_mfma_f32_16x16x32_bf16 v[28:31], a[132:135], v[164:167], v[28:31]
  v_mfma_f32_16x16x32_bf16 v[112:115], a[132:135], v[248:251], v[112:115]
  v_mfma_f32_16x16x32_bf16 v[116:119], a[136:139], v[248:251], v[116:119]
  v_mfma_f32_16x16x32_bf16 v[120:123], v[248:251], a[140:143], v[120:123]
  s_waitcnt lgkmcnt(0)
  v_mfma_f32_16x16x32_bf16 v[84:87], v[248:251], v[208:211], v[84:87]
  ds_read_b128 v[148:151], v171 offset:20480
  v_mfma_f32_16x16x32_bf16 v[104:107], v[208:211], v[208:211], v[104:107]
  s_add_u32 m0, s29, 140288
  s_add_u32 s76, s76, 8192
  buffer_load_dwordx4 v187, s[12:15], s76 offen lds
  v_mfma_f32_16x16x32_bf16 v[32:35], a[148:151], v[128:131], v[32:35]
  ds_read_b128 v[152:155], v171 offset:22528
  v_mfma_f32_16x16x32_bf16 v[52:55], v[128:131], a[152:155], v[52:55]
  ds_read_b128 v[156:159], v171 offset:24576
  v_mfma_f32_16x16x32_bf16 v[36:39], a[148:151], v[132:135], v[36:39]
  ds_read_b128 v[160:163], v171 offset:26624
  v_mfma_f32_16x16x32_bf16 v[56:59], v[132:135], a[152:155], v[56:59]
  s_add_u32 s76, s45, 2
  s_and_b32 s76, s76, 7
  s_lshl_b32 s76, s76, 16
  s_add_u32 s76, s76, s28
  s_add_u32 m0, s29, 147456
  s_nop 0
  buffer_load_dwordx4 v186, s[12:15], s76 offen lds
  v_mfma_f32_16x16x32_bf16 v[16:19], a[144:147], v[132:135], v[16:19]
  ds_read_b128 v[164:167], v171 offset:28672
  v_mfma_f32_16x16x32_bf16 v[40:43], a[148:151], v[136:139], v[40:43]
  ds_read_b64_tr_b16 a[156:157], v172 offset:4096
  v_mfma_f32_16x16x32_bf16 v[60:63], v[136:139], a[152:155], v[60:63]
  ds_read_b64_tr_b16 a[158:159], v172 offset:4608
  v_mfma_f32_16x16x32_bf16 v[20:23], a[144:147], v[136:139], v[20:23]
  s_add_u32 m0, s29, 148480
  s_add_u32 s76, s76, 8192
  buffer_load_dwordx4 v187, s[12:15], s76 offen lds
  v_mfma_f32_16x16x32_bf16 v[44:47], a[148:151], v[140:143], v[44:47]
  ds_read_b64_tr_b16 a[160:161], v172 offset:12288
  v_mfma_f32_16x16x32_bf16 v[64:67], v[140:143], a[152:155], v[64:67]
  ds_read_b64_tr_b16 a[162:163], v172 offset:12800
  v_mfma_f32_16x16x32_bf16 v[24:27], a[144:147], v[140:143], v[24:27]
  ds_read_b64_tr_b16 a[164:165], v172 offset:20480
  v_mfma_f32_16x16x32_bf16 v[48:51], a[148:151], v[144:147], v[48:51]
  ds_read_b64_tr_b16 a[166:167], v172 offset:20992
  v_mfma_f32_16x16x32_bf16 v[68:71], v[144:147], a[152:155], v[68:71]
  ds_read_b128 v[212:215], v185 offset:8192
  v_mfma_f32_16x16x32_bf16 v[28:31], a[144:147], v[144:147], v[28:31]
  v_mfma_f32_16x16x32_bf16 v[112:115], a[144:147], v[248:251], v[112:115]
  v_mfma_f32_16x16x32_bf16 v[116:119], a[148:151], v[248:251], v[116:119]
  v_mfma_f32_16x16x32_bf16 v[120:123], v[248:251], a[152:155], v[120:123]
  s_waitcnt lgkmcnt(0)
  s_waitcnt vmcnt(6)
  s_barrier
  v_mfma_f32_16x16x32_bf16 v[88:91], v[248:251], v[212:215], v[88:91]
  ds_read_b128 v[128:131], v170 offset:30720
  v_mfma_f32_16x16x32_bf16 v[108:111], v[212:215], v[212:215], v[108:111]
  s_add_u32 s76, s45, 3
  s_and_b32 s76, s76, 7
  s_lshl_b32 s76, s76, 16
  s_add_u32 s76, s76, s28
  s_add_u32 m0, s29, 81920
  s_nop 0
  buffer_load_dwordx4 v186, s[12:15], s76 offen lds
  v_mfma_f32_16x16x32_bf16 v[32:35], a[160:163], v[148:151], v[32:35]
  ds_read_b128 v[132:135], v170 offset:32768
  v_mfma_f32_16x16x32_bf16 v[52:55], v[148:151], a[164:167], v[52:55]
  ds_read_b128 v[136:139], v170 offset:34816
  v_mfma_f32_16x16x32_bf16 v[36:39], a[160:163], v[152:155], v[36:39]
  ds_read_b128 v[140:143], v170 offset:36864
  v_mfma_f32_16x16x32_bf16 v[56:59], v[152:155], a[164:167], v[56:59]
  s_add_u32 m0, s29, 82944
  s_add_u32 s76, s76, 8192
  buffer_load_dwordx4 v187, s[12:15], s76 offen lds
  v_mfma_f32_16x16x32_bf16 v[16:19], a[156:159], v[152:155], v[16:19]
  ds_read_b128 v[144:147], v170 offset:38912
  v_mfma_f32_16x16x32_bf16 v[40:43], a[160:163], v[156:159], v[40:43]
  ds_read_b64_tr_b16 a[168:169], v173 offset:0
  v_mfma_f32_16x16x32_bf16 v[60:63], v[156:159], a[164:167], v[60:63]
  ds_read_b64_tr_b16 a[170:171], v173 offset:512
  v_mfma_f32_16x16x32_bf16 v[20:23], a[156:159], v[156:159], v[20:23]
  s_add_u32 s76, s45, 4
  s_and_b32 s76, s76, 7
  s_lshl_b32 s76, s76, 16
  s_add_u32 s76, s76, s28
  s_add_u32 m0, s29, 90112
  s_nop 0
  buffer_load_dwordx4 v186, s[12:15], s76 offen lds
  v_mfma_f32_16x16x32_bf16 v[44:47], a[160:163], v[160:163], v[44:47]
  ds_read_b64_tr_b16 a[172:173], v173 offset:8192
  v_mfma_f32_16x16x32_bf16 v[64:67], v[160:163], a[164:167], v[64:67]
  ds_read_b64_tr_b16 a[174:175], v173 offset:8704
  v_mfma_f32_16x16x32_bf16 v[24:27], a[156:159], v[160:163], v[24:27]
  ds_read_b64_tr_b16 a[176:177], v173 offset:16384
  v_mfma_f32_16x16x32_bf16 v[48:51], a[160:163], v[164:167], v[48:51]
  s_add_u32 m0, s29, 91136
  s_add_u32 s76, s76, 8192
  buffer_load_dwordx4 v187, s[12:15], s76 offen lds
  v_mfma_f32_16x16x32_bf16 v[68:71], v[164:167], a[164:167], v[68:71]
  ds_read_b64_tr_b16 a[178:179], v173 offset:16896
  v_mfma_f32_16x16x32_bf16 v[28:31], a[156:159], v[164:167], v[28:31]
  ds_read_b128 v[196:199], v185 offset:20480
  v_mfma_f32_16x16x32_bf16 v[112:115], a[156:159], v[248:251], v[112:115]
  ds_read_b128 v[200:203], v185 offset:22528
  v_mfma_f32_16x16x32_bf16 v[116:119], a[160:163], v[248:251], v[116:119]
  v_mfma_f32_16x16x32_bf16 v[120:123], v[248:251], a[164:167], v[120:123]
  s_waitcnt lgkmcnt(0)
  v_mfma_f32_16x16x32_bf16 v[72:75], v[248:251], v[196:199], v[72:75]
  ds_read_b128 v[148:151], v171 offset:30720
  v_mfma_f32_16x16x32_bf16 v[92:95], v[196:199], v[196:199], v[92:95]
  s_add_u32 s76, s45, 5
  s_and_b32 s76, s76, 7
  s_lshl_b32 s76, s76, 16
  s_add_u32 s76, s76, s28
  s_add_u32 m0, s29, 98304
  s_nop 0
  buffer_load_dwordx4 v186, s[12:15], s76 offen lds
  v_mfma_f32_16x16x32_bf16 v[76:79], v[248:251], v[200:203], v[76:79]
  ds_read_b128 v[152:155], v171 offset:32768
  v_mfma_f32_16x16x32_bf16 v[96:99], v[200:203], v[200:203], v[96:99]
  ds_read_b128 v[156:159], v171 offset:34816
  v_mfma_f32_16x16x32_bf16 v[32:35], a[172:175], v[128:131], v[32:35]
  ds_read_b128 v[160:163], v171 offset:36864
  v_mfma_f32_16x16x32_bf16 v[52:55], v[128:131], a[176:179], v[52:55]
  s_add_u32 m0, s29, 99328
  s_add_u32 s76, s76, 8192
  buffer_load_dwordx4 v187, s[12:15], s76 offen lds
  v_mfma_f32_16x16x32_bf16 v[36:39], a[172:175], v[132:135], v[36:39]
  ds_read_b128 v[164:167], v171 offset:38912
  v_mfma_f32_16x16x32_bf16 v[56:59], v[132:135], a[176:179], v[56:59]
  ds_read_b64_tr_b16 a[180:181], v173 offset:4096
  v_mfma_f32_16x16x32_bf16 v[16:19], a[168:171], v[132:135], v[16:19]
  ds_read_b64_tr_b16 a[182:183], v173 offset:4608
  v_mfma_f32_16x16x32_bf16 v[40:43], a[172:175], v[136:139], v[40:43]
  s_cmp_lg_u32 s44, 2
  s_cbranch_scc1 L_pt_4
  v_add_u32 v252, s49, v1
  v_lshlrev_b32 v252, 10, v252
  s_lshl_b32 s57, s45, 7
  s_add_u32 s57, s57, 1048576
  buffer_load_dword v253, v252, s[16:19], s57 offen sc1
L_pt_4:
  v_mfma_f32_16x16x32_bf16 v[60:63], v[136:139], a[176:179], v[60:63]
  ds_read_b64_tr_b16 a[184:185], v173 offset:12288
  v_mfma_f32_16x16x32_bf16 v[20:23], a[168:171], v[136:139], v[20:23]
  ds_read_b64_tr_b16 a[186:187], v173 offset:12800
  v_mfma_f32_16x16x32_bf16 v[44:47], a[172:175], v[140:143], v[44:47]
  ds_read_b64_tr_b16 a[188:189], v173 offset:20480
  v_mfma_f32_16x16x32_bf16 v[64:67], v[140:143], a[176:179], v[64:67]
  ds_read_b64_tr_b16 a[190:191], v173 offset:20992
  v_mfma_f32_16x16x32_bf16 v[24:27], a[168:171], v[140:143], v[24:27]
  ds_read_b128 v[204:207], v185 offset:24576
  v_mfma_f32_16x16x32_bf16 v[48:51], a[172:175], v[144:147], v[48:51]
  ds_read_b128 v[208:211], v185 offset:26624
  v_mfma_f32_16x16x32_bf16 v[68:71], v[144:147], a[176:179], v[68:71]
  ds_read_b128 v[212:215], v185 offset:28672
  v_mfma_f32_16x16x32_bf16 v[28:31], a[168:171], v[144:147], v[28:31]
  v_mfma_f32_16x16x32_bf16 v[112:115], a[168:171], v[248:251], v[112:115]
  v_mfma_f32_16x16x32_bf16 v[116:119], a[172:175], v[248:251], v[116:119]
  v_mfma_f32_16x16x32_bf16 v[120:123], v[248:251], a[176:179], v[120:123]
  s_waitcnt lgkmcnt(0)
  v_lshlrev_b32 v226, 16, v188
  v_lshlrev_b32 v227, 16, v189
  v_lshlrev_b32 v228, 16, v190
  v_lshlrev_b32 v229, 16, v191
  v_lshlrev_b32 v230, 16, v192
  v_lshlrev_b32 v231, 16, v193
  v_mfma_f32_16x16x32_bf16 v[32:35], a[184:187], v[148:151], v[32:35]
  v_mfma_f32_16x16x32_bf16 v[52:55], v[148:151], a[188:191], v[52:55]
  v_mfma_f32_16x16x32_bf16 v[36:39], a[184:187], v[152:155], v[36:39]
  v_mfma_f32_16x16x32_bf16 v[56:59], v[152:155], a[188:191], v[56:59]
  v_mfma_f32_16x16x32_bf16 v[16:19], a[180:183], v[152:155], v[16:19]
  v_mfma_f32_16x16x32_bf16 v[40:43], a[184:187], v[156:159], v[40:43]
  v_mfma_f32_16x16x32_bf16 v[60:63], v[156:159], a[188:191], v[60:63]
  v_mfma_f32_16x16x32_bf16 v[20:23], a[180:183], v[156:159], v[20:23]
  v_mfma_f32_16x16x32_bf16 v[44:47], a[184:187], v[160:163], v[44:47]
  v_mfma_f32_16x16x32_bf16 v[64:67], v[160:163], a[188:191], v[64:67]
  v_mfma_f32_16x16x32_bf16 v[24:27], a[180:183], v[160:163], v[24:27]
  v_mfma_f32_16x16x32_bf16 v[48:51], a[184:187], v[164:167], v[48:51]
  v_mfma_f32_16x16x32_bf16 v[68:71], v[164:167], a[188:191], v[68:71]
  v_mfma_f32_16x16x32_bf16 v[28:31], a[180:183], v[164:167], v[28:31]
  v_mfma_f32_16x16x32_bf16 v[112:115], a[180:183], v[248:251], v[112:115]
  v_mfma_f32_16x16x32_bf16 v[116:119], a[184:187], v[248:251], v[116:119]
  v_mfma_f32_16x16x32_bf16 v[120:123], v[248:251], a[188:191], v[120:123]
  v_mfma_f32_16x16x32_bf16 v[80:83], v[248:251], v[204:207], v[80:83]
  v_mfma_f32_16x16x32_bf16 v[100:103], v[204:207], v[204:207], v[100:103]
  v_mfma_f32_16x16x32_bf16 v[84:87], v[248:251], v[208:211], v[84:87]
  v_mfma_f32_16x16x32_bf16 v[104:107], v[208:211], v[208:211], v[104:107]
  v_mfma_f32_16x16x32_bf16 v[88:91], v[248:251], v[212:215], v[88:91]
  v_mfma_f32_16x16x32_bf16 v[108:111], v[212:215], v[212:215], v[108:111]
  s_nop 7
  v_mov_b32 v4, v112
  v_mov_b32 v8, v116
  v_mov_b32 v5, v113
  v_mov_b32 v9, v117
  v_mov_b32 v6, v114
  v_mov_b32 v10, v118
  v_mov_b32 v7, v115
  v_mov_b32 v11, v119
  v_mov_b32 v12, v120
  v_lshlrev_b32 v178, 5, v2
  s_lshl_b32 s50, s44, 3
  s_add_u32 s50, s50, 155648
  v_add_u32 v178, s50, v178
  v_lshlrev_b32 v180, 5, v1
  v_add_u32 v180, 155648, v180
  v_lshlrev_b32 v181, 5, v2
  v_add_u32 v181, 157696, v181
  s_mul_i32 s50, s44, 640
  s_add_u32 s50, s50, 158208
  v_lshl_add_u32 v182, v1, 2, s50
  v_lshlrev_b32 v183, 2, v2
  v_add_u32 v183, s50, v183
  v_lshl_add_u32 v179, v3, 4, s50
  v_cndmask_b32 v92, v92, v93, s[60:61]
  v_cndmask_b32 v92, v92, v94, s[62:63]
  v_cndmask_b32 v73, v92, v95, s[64:65]
  v_cndmask_b32 v96, v96, v97, s[60:61]
  v_cndmask_b32 v96, v96, v98, s[62:63]
  v_cndmask_b32 v77, v96, v99, s[64:65]
  v_cndmask_b32 v100, v100, v101, s[60:61]
  v_cndmask_b32 v100, v100, v102, s[62:63]
  v_cndmask_b32 v81, v100, v103, s[64:65]
  v_cndmask_b32 v104, v104, v105, s[60:61]
  v_cndmask_b32 v104, v104, v106, s[62:63]
  v_cndmask_b32 v85, v104, v107, s[64:65]
  v_cndmask_b32 v108, v108, v109, s[60:61]
  v_cndmask_b32 v108, v108, v110, s[62:63]
  v_cndmask_b32 v89, v108, v111, s[64:65]
  s_mov_b64 exec, s[66:67]
  ds_write_b64 v178, v[72:73] offset:0
  ds_write_b64 v178, v[76:77] offset:512
  ds_write_b64 v178, v[80:81] offset:1024
  ds_write_b64 v178, v[84:85] offset:1536
  ds_write_b64 v178, v[88:89] offset:2048
  s_mov_b64 exec, -1
  s_waitcnt lgkmcnt(0)
  s_barrier
  s_add_u32 s76, s45, 6
  s_and_b32 s76, s76, 7
  s_lshl_b32 s76, s76, 16
  s_add_u32 s76, s76, s28
  s_add_u32 m0, s29, 106496
  s_nop 0
  buffer_load_dwordx4 v186, s[12:15], s76 offen lds
  s_add_u32 m0, s29, 107520
  s_add_u32 s76, s76, 8192
  buffer_load_dwordx4 v187, s[12:15], s76 offen lds
  s_add_u32 s76, s45, 7
  s_and_b32 s76, s76, 7
  s_lshl_b32 s76, s76, 16
  s_add_u32 s76, s76, s28
  s_add_u32 m0, s29, 114688
  s_nop 0
  buffer_load_dwordx4 v186, s[12:15], s76 offen lds
  s_add_u32 m0, s29, 115712
  s_add_u32 s76, s76, 8192
  buffer_load_dwordx4 v187, s[12:15], s76 offen lds
  s_lshl_b32 s76, s49, 10
  s_add_u32 s76, s76, s28
  s_add_u32 m0, s29, 122880
  s_nop 0
  buffer_load_dwordx4 v186, s[4:7], s76 offen lds
  s_add_u32 m0, s29, 123904
  s_add_u32 s76, s76, 8192
  buffer_load_dwordx4 v187, s[4:7], s76 offen lds
  v_lshlrev_b32 v220, 6, v1
  v_lshlrev_b32 v224, 9, v1
  s_mov_b64 exec, 0xf
  buffer_load_dword v221, v220, s[24:27], 0 offen sc1
  s_mov_b64 exec, 0xff
  s_lshl_b32 s56, s58, 6
  s_and_b32 s57, s2, 7
  s_add_u32 s56, s56, s57
  s_lshl_b32 s56, s56, 6
  s_add_u32 s56, s56, 81920
  buffer_load_dword v222, v224, s[16:19], s56 offen sc1
  s_mov_b64 exec, -1
  ds_read_b128 v[184:187], v180
  ds_read_b128 v[188:191], v180 offset:16
  ds_read_b128 v[192:195], v181
  ds_read_b128 v[196:199], v181 offset:16
  s_waitcnt lgkmcnt(0)
  s_mov_b32 s52, 0x3b000000
  s_mov_b32 s53, 0x3727c5ac
  v_pk_add_f32 v[184:185], v[184:185], v[186:187]
  v_pk_add_f32 v[188:189], v[188:189], v[190:191]
  v_pk_add_f32 v[192:193], v[192:193], v[194:195]
  v_pk_add_f32 v[196:197], v[196:197], v[198:199]
  v_pk_add_f32 v[184:185], v[184:185], v[188:189]
  v_pk_add_f32 v[192:193], v[192:193], v[196:197]
  v_pk_mul_f32 v[184:185], v[184:185], s[52:53] op_sel_hi:[1,0]
  v_pk_mul_f32 v[192:193], v[192:193], s[52:53] op_sel_hi:[1,0]
  v_fma_f32 v185, -v184, v184, v185
  v_fma_f32 v193, -v192, v192, v193
  v_max_f32 v185, 0, v185
  v_max_f32 v193, 0, v193
  v_add_f32 v185, s53, v185
  v_add_f32 v193, s53, v193
  v_rsq_f32 v185, v185
  v_rsq_f32 v193, v193
  s_nop 0
  v_mul_f32_e64 v184, -v184, v185
  v_mul_f32_e64 v192, -v192, v193
  ds_write_b32 v182, v185
  ds_write_b32 v182, v184 offset:320
  ds_write_b32 v183, v193 offset:256
  ds_write_b32 v183, v192 offset:576
  s_waitcnt lgkmcnt(0)
  ds_read2_b32 v[128:129], v183 offset0:0 offset1:80
  ds_read_b128 v[140:143], v179 offset:0
  ds_read_b128 v[160:163], v179 offset:320
  ds_read2_b32 v[130:131], v183 offset0:16 offset1:96
  ds_read_b128 v[144:147], v179 offset:64
  ds_read_b128 v[164:167], v179 offset:384
  ds_read2_b32 v[132:133], v183 offset0:32 offset1:112
  ds_read_b128 v[148:151], v179 offset:128
  ds_read_b128 v[168:171], v179 offset:448
  ds_read2_b32 v[134:135], v183 offset0:48 offset1:128
  ds_read_b128 v[152:155], v179 offset:192
  ds_read_b128 v[172:175], v179 offset:512
  ds_read2_b32 v[136:137], v183 offset0:64 offset1:144
  ds_read_b128 v[156:159], v179 offset:256
  ds_read_b128 v[176:179], v179 offset:576
  s_waitcnt lgkmcnt(12)
  v_pk_mul_f32 v[214:215], v[8:9], v[128:129] op_sel:[0,1] op_sel_hi:[1,1]
  v_pk_fma_f32 v[214:215], v[32:33], v[128:129], v[214:215] op_sel:[0,0,0] op_sel_hi:[1,0,1]
  v_cvt_pk_bf16_f32 v192, v214, v215
  v_pk_mul_f32 v[216:217], v[10:11], v[128:129] op_sel:[0,1] op_sel_hi:[1,1]
  v_pk_fma_f32 v[216:217], v[34:35], v[128:129], v[216:217] op_sel:[0,0,0] op_sel_hi:[1,0,1]
  v_cvt_pk_bf16_f32 v193, v216, v217
  v_pk_mul_f32 v[218:219], v[160:161], v[12:13] op_sel:[0,0] op_sel_hi:[1,0]
  v_pk_fma_f32 v[218:219], v[52:53], v[140:141], v[218:219]
  v_cvt_pk_bf16_f32 v202, v218, v219
  v_pk_mul_f32 v[212:213], v[162:163], v[12:13] op_sel:[0,0] op_sel_hi:[1,0]
  v_pk_fma_f32 v[212:213], v[54:55], v[142:143], v[212:213]
  v_cvt_pk_bf16_f32 v203, v212, v213
  s_waitcnt lgkmcnt(9)
  v_pk_mul_f32 v[214:215], v[8:9], v[130:131] op_sel:[0,1] op_sel_hi:[1,1]
  v_pk_fma_f32 v[214:215], v[36:37], v[130:131], v[214:215] op_sel:[0,0,0] op_sel_hi:[1,0,1]
  v_cvt_pk_bf16_f32 v194, v214, v215
  v_pk_mul_f32 v[216:217], v[10:11], v[130:131] op_sel:[0,1] op_sel_hi:[1,1]
  v_pk_fma_f32 v[216:217], v[38:39], v[130:131], v[216:217] op_sel:[0,0,0] op_sel_hi:[1,0,1]
  v_cvt_pk_bf16_f32 v195, v216, v217
  v_pk_mul_f32 v[218:219], v[4:5], v[130:131] op_sel:[0,1] op_sel_hi:[1,1]
  v_pk_fma_f32 v[218:219], v[16:17], v[130:131], v[218:219] op_sel:[0,0,0] op_sel_hi:[1,0,1]
  v_cvt_pk_bf16_f32 v184, v218, v219
  v_pk_mul_f32 v[212:213], v[6:7], v[130:131] op_sel:[0,1] op_sel_hi:[1,1]
  v_pk_fma_f32 v[212:213], v[18:19], v[130:131], v[212:213] op_sel:[0,0,0] op_sel_hi:[1,0,1]
  v_cvt_pk_bf16_f32 v185, v212, v213
  v_pk_mul_f32 v[214:215], v[164:165], v[12:13] op_sel:[0,0] op_sel_hi:[1,0]
  v_pk_fma_f32 v[214:215], v[56:57], v[144:145], v[214:215]
  v_cvt_pk_bf16_f32 v204, v214, v215
  v_pk_mul_f32 v[216:217], v[166:167], v[12:13] op_sel:[0,0] op_sel_hi:[1,0]
  v_pk_fma_f32 v[216:217], v[58:59], v[146:147], v[216:217]
  v_cvt_pk_bf16_f32 v205, v216, v217
  s_waitcnt lgkmcnt(6)
  v_pk_mul_f32 v[218:219], v[8:9], v[132:133] op_sel:[0,1] op_sel_hi:[1,1]
  v_pk_fma_f32 v[218:219], v[40:41], v[132:133], v[218:219] op_sel:[0,0,0] op_sel_hi:[1,0,1]
  v_cvt_pk_bf16_f32 v196, v218, v219
  v_pk_mul_f32 v[212:213], v[10:11], v[132:133] op_sel:[0,1] op_sel_hi:[1,1]
  v_pk_fma_f32 v[212:213], v[42:43], v[132:133], v[212:213] op_sel:[0,0,0] op_sel_hi:[1,0,1]
  v_cvt_pk_bf16_f32 v197, v212, v213
  v_pk_mul_f32 v[214:215], v[4:5], v[132:133] op_sel:[0,1] op_sel_hi:[1,1]
  v_pk_fma_f32 v[214:215], v[20:21], v[132:133], v[214:215] op_sel:[0,0,0] op_sel_hi:[1,0,1]
  v_cvt_pk_bf16_f32 v186, v214, v215
  v_pk_mul_f32 v[216:217], v[6:7], v[132:133] op_sel:[0,1] op_sel_hi:[1,1]
  v_pk_fma_f32 v[216:217], v[22:23], v[132:133], v[216:217] op_sel:[0,0,0] op_sel_hi:[1,0,1]
  v_cvt_pk_bf16_f32 v187, v216, v217
  v_pk_mul_f32 v[218:219], v[168:169], v[12:13] op_sel:[0,0] op_sel_hi:[1,0]
  v_pk_fma_f32 v[218:219], v[60:61], v[148:149], v[218:219]
  v_cvt_pk_bf16_f32 v206, v218, v219
  v_pk_mul_f32 v[212:213], v[170:171], v[12:13] op_sel:[0,0] op_sel_hi:[1,0]
  v_pk_fma_f32 v[212:213], v[62:63], v[150:151], v[212:213]
  v_cvt_pk_bf16_f32 v207, v212, v213
  s_waitcnt lgkmcnt(3)
  v_pk_mul_f32 v[214:215], v[8:9], v[134:135] op_sel:[0,1] op_sel_hi:[1,1]
  v_pk_fma_f32 v[214:215], v[44:45], v[134:135], v[214:215] op_sel:[0,0,0] op_sel_hi:[1,0,1]
  v_cvt_pk_bf16_f32 v198, v214, v215
  v_pk_mul_f32 v[216:217], v[10:11], v[134:135] op_sel:[0,1] op_sel_hi:[1,1]
  v_pk_fma_f32 v[216:217], v[46:47], v[134:135], v[216:217] op_sel:[0,0,0] op_sel_hi:[1,0,1]
  v_cvt_pk_bf16_f32 v199, v216, v217
  v_pk_mul_f32 v[218:219], v[4:5], v[134:135] op_sel:[0,1] op_sel_hi:[1,1]
  v_pk_fma_f32 v[218:219], v[24:25], v[134:135], v[218:219] op_sel:[0,0,0] op_sel_hi:[1,0,1]
  v_cvt_pk_bf16_f32 v188, v218, v219
  v_pk_mul_f32 v[212:213], v[6:7], v[134:135] op_sel:[0,1] op_sel_hi:[1,1]
  v_pk_fma_f32 v[212:213], v[26:27], v[134:135], v[212:213] op_sel:[0,0,0] op_sel_hi:[1,0,1]
  v_cvt_pk_bf16_f32 v189, v212, v213
  v_pk_mul_f32 v[214:215], v[172:173], v[12:13] op_sel:[0,0] op_sel_hi:[1,0]
  v_pk_fma_f32 v[214:215], v[64:65], v[152:153], v[214:215]
  v_cvt_pk_bf16_f32 v208, v214, v215
  v_pk_mul_f32 v[216:217], v[174:175], v[12:13] op_sel:[0,0] op_sel_hi:[1,0]
  v_pk_fma_f32 v[216:217], v[66:67], v[154:155], v[216:217]
  v_cvt_pk_bf16_f32 v209, v216, v217
  s_waitcnt lgkmcnt(0)
  v_pk_mul_f32 v[218:219], v[8:9], v[136:137] op_sel:[0,1] op_sel_hi:[1,1]
  v_pk_fma_f32 v[218:219], v[48:49], v[136:137], v[218:219] op_sel:[0,0,0] op_sel_hi:[1,0,1]
  v_cvt_pk_bf16_f32 v200, v218, v219
  v_pk_mul_f32 v[212:213], v[10:11], v[136:137] op_sel:[0,1] op_sel_hi:[1,1]
  v_pk_fma_f32 v[212:213], v[50:51], v[136:137], v[212:213] op_sel:[0,0,0] op_sel_hi:[1,0,1]
  v_cvt_pk_bf16_f32 v201, v212, v213
  v_pk_mul_f32 v[214:215], v[4:5], v[136:137] op_sel:[0,1] op_sel_hi:[1,1]
  v_pk_fma_f32 v[214:215], v[28:29], v[136:137], v[214:215] op_sel:[0,0,0] op_sel_hi:[1,0,1]
  v_cvt_pk_bf16_f32 v190, v214, v215
  v_pk_mul_f32 v[216:217], v[6:7], v[136:137] op_sel:[0,1] op_sel_hi:[1,1]
  v_pk_fma_f32 v[216:217], v[30:31], v[136:137], v[216:217] op_sel:[0,0,0] op_sel_hi:[1,0,1]
  v_cvt_pk_bf16_f32 v191, v216, v217
  v_pk_mul_f32 v[218:219], v[176:177], v[12:13] op_sel:[0,0] op_sel_hi:[1,0]
  v_pk_fma_f32 v[218:219], v[68:69], v[156:157], v[218:219]
  v_cvt_pk_bf16_f32 v210, v218, v219
  v_pk_mul_f32 v[212:213], v[178:179], v[12:13] op_sel:[0,0] op_sel_hi:[1,0]
  v_pk_fma_f32 v[212:213], v[70:71], v[158:159], v[212:213]
  v_cvt_pk_bf16_f32 v211, v212, v213
  v_mfma_f32_16x16x16_bf16 v[16:19], v[192:193], v[184:185], 0
  v_mfma_f32_16x16x16_bf16 v[20:23], v[194:195], v[184:185], 0
  v_mfma_f32_16x16x16_bf16 v[24:27], v[194:195], v[186:187], 0
  v_mfma_f32_16x16x16_bf16 v[28:31], v[196:197], v[186:187], 0
  v_mfma_f32_16x16x16_bf16 v[32:35], v[196:197], v[188:189], 0
  v_mfma_f32_16x16x16_bf16 v[36:39], v[198:199], v[188:189], 0
  v_mfma_f32_16x16x16_bf16 v[40:43], v[198:199], v[190:191], 0
  v_mfma_f32_16x16x16_bf16 v[44:47], v[200:201], v[190:191], 0
  s_mov_b32 s52, 0x3eb8aa3b
  v_lshrrev_b32 v180, 1, v3
  s_lshl_b32 s50, s44, 1
  v_add_u32 v180, s50, v180
  v_and_b32 v181, 7, v2
  v_xor_b32 v180, v180, v181
  v_cndmask_b32 v48, v16, v17, s[68:69]
  v_cndmask_b32 v49, v18, v19, s[68:69]
  v_cndmask_b32 v50, v20, v21, s[68:69]
  v_cndmask_b32 v51, v22, v23, s[68:69]
  v_cndmask_b32 v52, v24, v25, s[68:69]
  v_cndmask_b32 v53, v26, v27, s[68:69]
  v_cndmask_b32 v54, v28, v29, s[68:69]
  v_cndmask_b32 v55, v30, v31, s[68:69]
  v_cndmask_b32 v56, v32, v33, s[68:69]
  v_cndmask_b32 v57, v34, v35, s[68:69]
  v_cndmask_b32 v58, v36, v37, s[68:69]
  v_cndmask_b32 v59, v38, v39, s[68:69]
  s_nop 1
  v_cndmask_b32 v60, v40, v41, s[68:69]
  v_cndmask_b32 v61, v42, v43, s[68:69]
  v_cndmask_b32 v62, v44, v45, s[68:69]
  v_cndmask_b32 v63, v46, v47, s[68:69]
  v_pk_fma_f32 v[48:49], v[48:49], s[52:53], v[244:245] op_sel_hi:[1,0,1]
  v_pk_fma_f32 v[50:51], v[50:51], s[52:53], v[242:243] op_sel_hi:[1,0,1]
  v_pk_fma_f32 v[52:53], v[52:53], s[52:53], v[240:241] op_sel_hi:[1,0,1]
  v_pk_fma_f32 v[54:55], v[54:55], s[52:53], v[242:243] op_sel_hi:[1,0,1]
  v_pk_fma_f32 v[56:57], v[56:57], s[52:53], v[240:241] op_sel_hi:[1,0,1]
  v_pk_fma_f32 v[58:59], v[58:59], s[52:53], v[242:243] op_sel_hi:[1,0,1]
  v_pk_fma_f32 v[60:61], v[60:61], s[52:53], v[240:241] op_sel_hi:[1,0,1]
  v_pk_fma_f32 v[62:63], v[62:63], s[52:53], v[242:243] op_sel_hi:[1,0,1]
  v_max3_f32 v64, v48, v49, v50
  v_max3_f32 v65, v52, v53, v54
  v_max3_f32 v66, v56, v57, v58
  v_max3_f32 v67, v60, v61, v62
  v_max_f32 v64, v64, v51
  v_max_f32 v65, v65, v55
  v_max_f32 v66, v66, v59
  v_max_f32 v67, v67, v63
  v_mov_b32 v68, v64
  v_mov_b32 v69, v65
  v_mov_b32 v70, v66
  v_mov_b32 v71, v67
  v_permlane16_swap_b32 v64, v68
  v_permlane16_swap_b32 v65, v69
  v_permlane16_swap_b32 v66, v70
  v_permlane16_swap_b32 v67, v71
  v_max_f32 v64, v64, v68
  v_max_f32 v65, v65, v69
  v_max_f32 v66, v66, v70
  v_max_f32 v67, v67, v71
  v_mov_b32 v68, v64
  v_mov_b32 v69, v65
  v_mov_b32 v70, v66
  v_mov_b32 v71, v67
  v_permlane32_swap_b32 v64, v68
  v_permlane32_swap_b32 v65, v69
  v_permlane32_swap_b32 v66, v70
  v_permlane32_swap_b32 v67, v71
  v_max_f32 v64, v64, v68
  v_max_f32 v65, v65, v69
  v_max_f32 v66, v66, v70
  v_max_f32 v67, v67, v71
  v_pk_add_f32 v[48:49], v[48:49], v[64:65] op_sel:[0,0] op_sel_hi:[1,0] neg_lo:[0,1] neg_hi:[0,1]
  v_pk_add_f32 v[50:51], v[50:51], v[64:65] op_sel:[0,0] op_sel_hi:[1,0] neg_lo:[0,1] neg_hi:[0,1]
  v_pk_add_f32 v[52:53], v[52:53], v[64:65] op_sel:[0,1] op_sel_hi:[1,1] neg_lo:[0,1] neg_hi:[0,1]
  v_pk_add_f32 v[54:55], v[54:55], v[64:65] op_sel:[0,1] op_sel_hi:[1,1] neg_lo:[0,1] neg_hi:[0,1]
  v_pk_add_f32 v[56:57], v[56:57], v[66:67] op_sel:[0,0] op_sel_hi:[1,0] neg_lo:[0,1] neg_hi:[0,1]
  v_pk_add_f32 v[58:59], v[58:59], v[66:67] op_sel:[0,0] op_sel_hi:[1,0] neg_lo:[0,1] neg_hi:[0,1]
  v_pk_add_f32 v[60:61], v[60:61], v[66:67] op_sel:[0,1] op_sel_hi:[1,1] neg_lo:[0,1] neg_hi:[0,1]
  v_pk_add_f32 v[62:63], v[62:63], v[66:67] op_sel:[0,1] op_sel_hi:[1,1] neg_lo:[0,1] neg_hi:[0,1]
  v_exp_f32 v48, v48
  v_exp_f32 v49, v49
  v_exp_f32 v50, v50
  v_exp_f32 v51, v51
  v_exp_f32 v52, v52
  v_exp_f32 v53, v53
  v_exp_f32 v54, v54
  v_exp_f32 v55, v55
  v_exp_f32 v56, v56
  v_exp_f32 v57, v57
  v_exp_f32 v58, v58
  v_exp_f32 v59, v59
  v_exp_f32 v60, v60
  v_exp_f32 v61, v61
  v_exp_f32 v62, v62
  v_exp_f32 v63, v63
  v_lshlrev_b32 v180, 4, v180
  v_pk_mul_f32 v[18:19], v[246:247], v[48:49] op_sel:[0,0] op_sel_hi:[1,0]
  v_cvt_pk_bf16_f32 v72, v18, v19
  v_pk_mul_f32 v[20:21], v[246:247], v[48:49] op_sel:[0,1] op_sel_hi:[1,1]
  v_cvt_pk_bf16_f32 v73, v20, v21
  v_pk_mul_f32 v[22:23], v[246:247], v[50:51] op_sel:[0,0] op_sel_hi:[1,0]
  v_cvt_pk_bf16_f32 v74, v22, v23
  v_pk_mul_f32 v[16:17], v[246:247], v[50:51] op_sel:[0,1] op_sel_hi:[1,1]
  v_cvt_pk_bf16_f32 v75, v16, v17
  v_pk_mul_f32 v[18:19], v[246:247], v[52:53] op_sel:[0,0] op_sel_hi:[1,0]
  v_cvt_pk_bf16_f32 v76, v18, v19
  v_pk_mul_f32 v[20:21], v[246:247], v[52:53] op_sel:[0,1] op_sel_hi:[1,1]
  v_cvt_pk_bf16_f32 v77, v20, v21
  v_pk_mul_f32 v[22:23], v[246:247], v[54:55] op_sel:[0,0] op_sel_hi:[1,0]
  v_cvt_pk_bf16_f32 v78, v22, v23
  v_pk_mul_f32 v[16:17], v[246:247], v[54:55] op_sel:[0,1] op_sel_hi:[1,1]
  v_cvt_pk_bf16_f32 v79, v16, v17
  v_pk_mul_f32 v[18:19], v[246:247], v[56:57] op_sel:[0,0] op_sel_hi:[1,0]
  v_cvt_pk_bf16_f32 v80, v18, v19
  v_pk_mul_f32 v[20:21], v[246:247], v[56:57] op_sel:[0,1] op_sel_hi:[1,1]
  v_cvt_pk_bf16_f32 v81, v20, v21
  v_pk_mul_f32 v[22:23], v[246:247], v[58:59] op_sel:[0,0] op_sel_hi:[1,0]
  v_cvt_pk_bf16_f32 v82, v22, v23
  v_pk_mul_f32 v[16:17], v[246:247], v[58:59] op_sel:[0,1] op_sel_hi:[1,1]
  v_cvt_pk_bf16_f32 v83, v16, v17
  v_pk_mul_f32 v[18:19], v[246:247], v[60:61] op_sel:[0,0] op_sel_hi:[1,0]
  v_cvt_pk_bf16_f32 v84, v18, v19
  v_pk_mul_f32 v[20:21], v[246:247], v[60:61] op_sel:[0,1] op_sel_hi:[1,1]
  v_cvt_pk_bf16_f32 v85, v20, v21
  v_pk_mul_f32 v[22:23], v[246:247], v[62:63] op_sel:[0,0] op_sel_hi:[1,0]
  v_cvt_pk_bf16_f32 v86, v22, v23
  v_pk_mul_f32 v[16:17], v[246:247], v[62:63] op_sel:[0,1] op_sel_hi:[1,1]
  v_cvt_pk_bf16_f32 v87, v16, v17
  v_and_b32 v181, 1, v3
  v_lshl_add_u32 v180, v181, 3, v180
  v_mfma_f32_16x16x32_bf16 v[104:107], v[248:251], v[72:75], 0
  v_mfma_f32_16x16x32_bf16 v[88:91], v[202:205], v[72:75], 0
  v_mfma_f32_16x16x32_bf16 v[108:111], v[248:251], v[76:79], 0
  v_mfma_f32_16x16x32_bf16 v[92:95], v[204:207], v[76:79], 0
  v_mfma_f32_16x16x32_bf16 v[112:115], v[248:251], v[80:83], 0
  v_mfma_f32_16x16x32_bf16 v[96:99], v[206:209], v[80:83], 0
  v_mfma_f32_16x16x32_bf16 v[116:119], v[248:251], v[84:87], 0
  v_mfma_f32_16x16x32_bf16 v[100:103], v[208:211], v[84:87], 0
  v_lshl_add_u32 v180, v2, 7, v180
  v_add_u32 v180, 65536, v180
  s_nop 1
  v_rcp_f32 v104, v104
  v_rcp_f32 v108, v108
  v_rcp_f32 v112, v112
  v_rcp_f32 v116, v116
  s_nop 0
  v_pk_mul_f32 v[88:89], v[88:89], v[104:105] op_sel_hi:[1,0]
  v_pk_mul_f32 v[90:91], v[90:91], v[104:105] op_sel_hi:[1,0]
  v_cvt_pk_bf16_f32 v24, v88, v89
  v_cvt_pk_bf16_f32 v25, v90, v91
  ds_write_b64 v180, v[24:25] offset:0
  v_pk_mul_f32 v[92:93], v[92:93], v[108:109] op_sel_hi:[1,0]
  v_pk_mul_f32 v[94:95], v[94:95], v[108:109] op_sel_hi:[1,0]
  v_cvt_pk_bf16_f32 v26, v92, v93
  v_cvt_pk_bf16_f32 v27, v94, v95
  ds_write_b64 v180, v[26:27] offset:2048
  v_pk_mul_f32 v[96:97], v[96:97], v[112:113] op_sel_hi:[1,0]
  v_pk_mul_f32 v[98:99], v[98:99], v[112:113] op_sel_hi:[1,0]
  v_cvt_pk_bf16_f32 v28, v96, v97
  v_cvt_pk_bf16_f32 v29, v98, v99
  ds_write_b64 v180, v[28:29] offset:4096
  v_pk_mul_f32 v[100:101], v[100:101], v[116:117] op_sel_hi:[1,0]
  v_pk_mul_f32 v[102:103], v[102:103], v[116:117] op_sel_hi:[1,0]
  v_cvt_pk_bf16_f32 v30, v100, v101
  v_cvt_pk_bf16_f32 v31, v102, v103
  ds_write_b64 v180, v[30:31] offset:6144
  v_lshrrev_b32 v180, 3, v0
  v_and_b32 v181, 7, v0
  v_and_b32 v182, 7, v180
  v_xor_b32 v182, v182, v181
  v_lshlrev_b32 v182, 4, v182
  v_lshl_add_u32 v182, v180, 7, v182
  v_add_u32 v182, 65536, v182
  v_add_u32 v180, s49, v180
  v_lshlrev_b32 v180, 10, v180
  v_lshl_add_u32 v180, v181, 4, v180
  s_lshl_b32 s50, s45, 7
  s_add_u32 s50, s50, 1048576
  s_add_u32 s51, s50, 32768
  s_waitcnt vmcnt(0)
  s_mov_b64 exec, 0xf
  v_cmp_ne_u32 vcc, 64, v221
  s_mov_b64 exec, -1
  s_cbranch_vccnz L_nf_5
  s_add_u32 s56, s79, 1
  s_mov_b64 exec, 0xff
  v_cmp_ne_u32 vcc, s56, v222
  s_mov_b64 exec, -1
  s_cbranch_vccnz L_nf_5
  s_mov_b32 s78, 1
L_nf_5:
  s_waitcnt lgkmcnt(0)
  s_barrier
  ds_read_b128 v[184:187], v182
  ds_read_b128 v[188:191], v182 offset:4096
  s_cmp_eq_u32 s78, 0
  s_cbranch_scc1 L_osl_6
  s_waitcnt lgkmcnt(1)
  buffer_store_dwordx4 v[184:187], v180, s[16:19], s50 offen
  s_waitcnt lgkmcnt(0)
  buffer_store_dwordx4 v[188:191], v180, s[16:19], s51 offen
  s_branch L_osd_7
L_osl_6:
  s_waitcnt lgkmcnt(1)
  buffer_store_dwordx4 v[184:187], v180, s[16:19], s50 offen sc1
  s_waitcnt lgkmcnt(0)
  buffer_store_dwordx4 v[188:191], v180, s[16:19], s51 offen sc1
L_osd_7:
  v_lshrrev_b32 v208, 2, v2
  v_lshl_add_u32 v208, v3, 3, v208
  v_lshlrev_b32 v208, 7, v208
  v_lshrrev_b32 v209, 3, v2
  v_and_b32 v207, 1, v3
  v_lshl_or_b32 v209, v207, 1, v209
  v_xor_b32 v209, s44, v209
  v_lshl_add_u32 v208, v209, 5, v208
  v_and_b32 v209, 3, v2
  v_lshl_add_u32 v206, v209, 3, v208
  v_add_u32 v206, 81920, v206
  v_add_u32 v207, 49152, v206
  ds_read_b64_tr_b16 a[192:193], v207 offset:0
  ds_read_b64_tr_b16 a[194:195], v207 offset:512
  ds_read_b64_tr_b16 a[196:197], v207 offset:4096
  ds_read_b64_tr_b16 a[198:199], v207 offset:4608
  ds_read_b64_tr_b16 a[200:201], v207 offset:8192
  ds_read_b64_tr_b16 a[202:203], v207 offset:8704
  ds_read_b64_tr_b16 a[204:205], v207 offset:12288
  ds_read_b64_tr_b16 a[206:207], v207 offset:12800
  s_waitcnt lgkmcnt(4)
  ds_read_b64_tr_b16 a[208:209], v207 offset:16384
  ds_read_b64_tr_b16 a[210:211], v207 offset:16896
  ds_read_b64_tr_b16 a[212:213], v207 offset:20480
  ds_read_b64_tr_b16 a[214:215], v207 offset:20992
  ds_read_b64_tr_b16 a[216:217], v206 offset:0
  ds_read_b64_tr_b16 a[218:219], v206 offset:512
  ds_read_b64_tr_b16 a[220:221], v206 offset:4096
  ds_read_b64_tr_b16 a[222:223], v206 offset:4608
  s_waitcnt lgkmcnt(4)
  ds_read_b64_tr_b16 a[224:225], v206 offset:8192
  ds_read_b64_tr_b16 a[226:227], v206 offset:8704
  ds_read_b64_tr_b16 a[228:229], v206 offset:12288
  ds_read_b64_tr_b16 a[230:231], v206 offset:12800
  ds_read_b64_tr_b16 a[232:233], v206 offset:16384
  ds_read_b64_tr_b16 a[234:235], v206 offset:16896
  ds_read_b64_tr_b16 a[236:237], v206 offset:20480
  ds_read_b64_tr_b16 a[238:239], v206 offset:20992
  s_waitcnt lgkmcnt(4)
  ds_read_b64_tr_b16 a[240:241], v206 offset:24576
  ds_read_b64_tr_b16 a[242:243], v206 offset:25088
  ds_read_b64_tr_b16 a[244:245], v206 offset:28672
  ds_read_b64_tr_b16 a[246:247], v206 offset:29184
  ds_read_b64_tr_b16 a[248:249], v206 offset:32768
  ds_read_b64_tr_b16 a[250:251], v206 offset:33280
  ds_read_b64_tr_b16 a[252:253], v206 offset:36864
  ds_read_b64_tr_b16 a[254:255], v206 offset:37376
  s_waitcnt lgkmcnt(4)
  ds_read_b64_tr_b16 v[232:233], v206 offset:40960
  ds_read_b64_tr_b16 v[234:235], v206 offset:41472
  ds_read_b64_tr_b16 v[236:237], v206 offset:45056
  ds_read_b64_tr_b16 v[238:239], v206 offset:45568
  s_waitcnt lgkmcnt(0)
  s_barrier
  v_mov_b32 v144, v226
  v_mov_b32 v145, v227
  v_mov_b32 v146, v228
  v_mov_b32 v147, v229
  v_mov_b32 v148, v230
  v_mul_f32 v151, 0x3fb8aa3b, v148
  s_mov_b32 s56, 0x3fb8aa3b
  v_fma_f32 v152, v148, s56, -v151
  v_fmac_f32 v152, 0x32a57060, v148
  v_exp_f32 v150, v151
  v_mul_f32 v152, 0x3f317218, v152
  v_fma_f32 v150, v150, v152, v150
  v_cvt_pk_bf16_f32 v150, 0, v150
  v_mul_f32 v151, 0x3fb8aa3b, v144
  s_mov_b32 s56, 0x3fb8aa3b
  v_fma_f32 v152, v144, s56, -v151
  v_fmac_f32 v152, 0x32a57060, v144
  v_exp_f32 v153, v151
  v_mul_f32 v152, 0x3f317218, v152
  v_fma_f32 v153, v153, v152, v153
  v_cvt_pk_bf16_f32 v153, 0, v153
  v_mul_f32 v153, v153, v150
  v_mul_f32 v154, v145, v150
  v_mul_f32 v153, 0xbfb8aa3b, v153
  v_mul_f32 v154, 0x3e22f983, v154
  v_add_f32 v14, v150, v150
  v_mul_f32 v200, 0x3f800000, v153
  v_mul_f32 v201, 0x3f800000, v154
  v_mul_f32 v202, 0x40000000, v153
  v_mul_f32 v203, 0x40000000, v154
  v_mul_f32 v204, 0x40800000, v153
  v_mul_f32 v205, 0x40800000, v154
  v_mul_f32 v206, 0x41000000, v153
  v_mul_f32 v207, 0x41000000, v154
  v_mul_f32 v208, 0x43000000, v153
  v_mul_f32 v209, 0x43000000, v154
  v_fract_f32 v201, v201
  v_fract_f32 v203, v203
  v_fract_f32 v205, v205
  v_fract_f32 v207, v207
  v_fract_f32 v209, v209
  v_exp_f32 v200, v200
  v_exp_f32 v202, v202
  v_exp_f32 v204, v204
  v_exp_f32 v206, v206
  v_exp_f32 v208, v208
  v_cos_f32 v162, v201
  v_sin_f32 v163, v201
  v_cos_f32 v164, v203
  v_sin_f32 v165, v203
  s_waitcnt vmcnt(0) lgkmcnt(0)
  s_barrier
  s_cmp_lg_u32 s44, 0
  s_cbranch_scc1 L_fs_8
  s_mov_b64 exec, 1
  s_lshl_b32 s50, s2, 6
  s_add_u32 s50, s50, 0
  v_mov_b32 v252, 0
  v_mov_b32 v253, 1
  s_cmp_eq_u32 s78, 0
  s_cbranch_scc1 L_fsl_9
  buffer_store_dword v253, v252, s[16:19], s50 offen
  s_branch L_fsd_10
L_fsl_9:
  buffer_store_dword v253, v252, s[16:19], s50 offen sc1
L_fsd_10:
  s_mov_b64 exec, -1
L_fs_8:
  v_cos_f32 v168, v205
  v_sin_f32 v169, v205
  v_cos_f32 v176, v207
  v_sin_f32 v177, v207
  v_cos_f32 v178, v209
  v_sin_f32 v179, v209
  s_nop 0
  v_pk_mul_f32 v[162:163], v[162:163], v[200:201] op_sel:[0,0] op_sel_hi:[1,0]
  v_pk_mul_f32 v[164:165], v[164:165], v[202:203] op_sel:[0,0] op_sel_hi:[1,0]
  v_pk_mul_f32 v[168:169], v[168:169], v[204:205] op_sel:[0,0] op_sel_hi:[1,0]
  v_pk_mul_f32 v[176:177], v[176:177], v[206:207] op_sel:[0,0] op_sel_hi:[1,0]
  v_pk_mul_f32 v[178:179], v[178:179], v[208:209] op_sel:[0,0] op_sel_hi:[1,0]
  v_pk_mul_f32 v[166:167], v[162:163], v[164:165] op_sel:[0,0] op_sel_hi:[0,1]
  v_pk_fma_f32 v[166:167], v[162:163], v[164:165], v[166:167] op_sel:[1,1,0] op_sel_hi:[1,0,1] neg_lo:[1,0,0]
  v_pk_mul_f32 v[170:171], v[168:169], v[162:163] op_sel:[0,0] op_sel_hi:[0,1]
  v_pk_fma_f32 v[170:171], v[168:169], v[162:163], v[170:171] op_sel:[1,1,0] op_sel_hi:[1,0,1] neg_lo:[1,0,0]
  v_pk_mul_f32 v[172:173], v[168:169], v[164:165] op_sel:[0,0] op_sel_hi:[0,1]
  v_pk_fma_f32 v[172:173], v[168:169], v[164:165], v[172:173] op_sel:[1,1,0] op_sel_hi:[1,0,1] neg_lo:[1,0,0]
  v_pk_mul_f32 v[174:175], v[168:169], v[166:167] op_sel:[0,0] op_sel_hi:[0,1]
  v_pk_fma_f32 v[174:175], v[168:169], v[166:167], v[174:175] op_sel:[1,1,0] op_sel_hi:[1,0,1] neg_lo:[1,0,0]
  v_lshrrev_b32 v181, 7, v0
  v_mul_u32_u24 v180, 21648, v181
  v_mul_u32_u24 v181, 8448, v181
  v_and_b32 v182, 127, v0
  v_lshl_add_u32 v180, v182, 2, v180
  v_lshl_add_u32 v181, v182, 2, v181
  v_add_u32 v180, 81920, v180
  v_add_u32 v181, 125216, v181
  v_mov_b32 v192, v146
  v_mov_b32 v193, v147
  v_cvt_pk_bf16_f32 v210, v192, v193
  v_pk_mul_f32 v[196:197], v[192:193], v[162:163] op_sel:[0,0] op_sel_hi:[0,1]
  v_pk_fma_f32 v[196:197], v[192:193], v[162:163], v[196:197] op_sel:[1,1,0] op_sel_hi:[1,0,1] neg_lo:[1,0,0]
  v_cvt_pk_bf16_f32 v211, v196, v197
  v_pk_mul_f32 v[198:199], v[192:193], v[164:165] op_sel:[0,0] op_sel_hi:[0,1]
  v_pk_fma_f32 v[198:199], v[192:193], v[164:165], v[198:199] op_sel:[1,1,0] op_sel_hi:[1,0,1] neg_lo:[1,0,0]
  v_cvt_pk_bf16_f32 v212, v198, v199
  v_pk_mul_f32 v[196:197], v[192:193], v[166:167] op_sel:[0,0] op_sel_hi:[0,1]
  v_pk_fma_f32 v[196:197], v[192:193], v[166:167], v[196:197] op_sel:[1,1,0] op_sel_hi:[1,0,1] neg_lo:[1,0,0]
  v_cvt_pk_bf16_f32 v213, v196, v197
  v_pk_mul_f32 v[198:199], v[192:193], v[168:169] op_sel:[0,0] op_sel_hi:[0,1]
  v_pk_fma_f32 v[198:199], v[192:193], v[168:169], v[198:199] op_sel:[1,1,0] op_sel_hi:[1,0,1] neg_lo:[1,0,0]
  v_cvt_pk_bf16_f32 v214, v198, v199
  v_pk_mul_f32 v[196:197], v[192:193], v[170:171] op_sel:[0,0] op_sel_hi:[0,1]
  v_pk_fma_f32 v[196:197], v[192:193], v[170:171], v[196:197] op_sel:[1,1,0] op_sel_hi:[1,0,1] neg_lo:[1,0,0]
  v_cvt_pk_bf16_f32 v215, v196, v197
  v_pk_mul_f32 v[198:199], v[192:193], v[172:173] op_sel:[0,0] op_sel_hi:[0,1]
  v_pk_fma_f32 v[198:199], v[192:193], v[172:173], v[198:199] op_sel:[1,1,0] op_sel_hi:[1,0,1] neg_lo:[1,0,0]
  v_cvt_pk_bf16_f32 v216, v198, v199
  v_pk_mul_f32 v[196:197], v[192:193], v[174:175] op_sel:[0,0] op_sel_hi:[0,1]
  v_pk_fma_f32 v[196:197], v[192:193], v[174:175], v[196:197] op_sel:[1,1,0] op_sel_hi:[1,0,1] neg_lo:[1,0,0]
  v_cvt_pk_bf16_f32 v217, v196, v197
  ds_write_b32 v180, v210 offset:0
  ds_write_b32 v180, v211 offset:528
  ds_write_b32 v180, v212 offset:1056
  ds_write_b32 v180, v213 offset:1584
  ds_write_b32 v180, v214 offset:2112
  ds_write_b32 v180, v215 offset:2640
  ds_write_b32 v180, v216 offset:3168
  ds_write_b32 v180, v217 offset:3696
  v_pk_mul_f32 v[194:195], v[192:193], v[178:179] op_sel:[0,0] op_sel_hi:[0,1]
  v_pk_fma_f32 v[194:195], v[192:193], v[178:179], v[194:195] op_sel:[1,1,0] op_sel_hi:[1,0,1] neg_lo:[1,0,0]
  v_cvt_pk_bf16_f32 v218, v194, v195
  v_pk_mul_f32 v[198:199], v[194:195], v[162:163] op_sel:[0,0] op_sel_hi:[0,1]
  v_pk_fma_f32 v[198:199], v[194:195], v[162:163], v[198:199] op_sel:[1,1,0] op_sel_hi:[1,0,1] neg_lo:[1,0,0]
  v_cvt_pk_bf16_f32 v219, v198, v199
  v_pk_mul_f32 v[196:197], v[194:195], v[164:165] op_sel:[0,0] op_sel_hi:[0,1]
  v_pk_fma_f32 v[196:197], v[194:195], v[164:165], v[196:197] op_sel:[1,1,0] op_sel_hi:[1,0,1] neg_lo:[1,0,0]
  v_cvt_pk_bf16_f32 v220, v196, v197
  v_pk_mul_f32 v[198:199], v[194:195], v[166:167] op_sel:[0,0] op_sel_hi:[0,1]
  v_pk_fma_f32 v[198:199], v[194:195], v[166:167], v[198:199] op_sel:[1,1,0] op_sel_hi:[1,0,1] neg_lo:[1,0,0]
  v_cvt_pk_bf16_f32 v221, v198, v199
  v_pk_mul_f32 v[196:197], v[194:195], v[168:169] op_sel:[0,0] op_sel_hi:[0,1]
  v_pk_fma_f32 v[196:197], v[194:195], v[168:169], v[196:197] op_sel:[1,1,0] op_sel_hi:[1,0,1] neg_lo:[1,0,0]
  v_cvt_pk_bf16_f32 v222, v196, v197
  v_pk_mul_f32 v[198:199], v[194:195], v[170:171] op_sel:[0,0] op_sel_hi:[0,1]
  v_pk_fma_f32 v[198:199], v[194:195], v[170:171], v[198:199] op_sel:[1,1,0] op_sel_hi:[1,0,1] neg_lo:[1,0,0]
  v_cvt_pk_bf16_f32 v223, v198, v199
  v_pk_mul_f32 v[196:197], v[194:195], v[172:173] op_sel:[0,0] op_sel_hi:[0,1]
  v_pk_fma_f32 v[196:197], v[194:195], v[172:173], v[196:197] op_sel:[1,1,0] op_sel_hi:[1,0,1] neg_lo:[1,0,0]
  v_cvt_pk_bf16_f32 v224, v196, v197
  v_pk_mul_f32 v[198:199], v[194:195], v[174:175] op_sel:[0,0] op_sel_hi:[0,1]
  v_pk_fma_f32 v[198:199], v[194:195], v[174:175], v[198:199] op_sel:[1,1,0] op_sel_hi:[1,0,1] neg_lo:[1,0,0]
  v_cvt_pk_bf16_f32 v225, v198, v199
  ds_write_b32 v180, v218 offset:4224
  ds_write_b32 v180, v219 offset:4752
  ds_write_b32 v180, v220 offset:5280
  ds_write_b32 v180, v221 offset:5808
  ds_write_b32 v180, v222 offset:6336
  ds_write_b32 v180, v223 offset:6864
  ds_write_b32 v180, v224 offset:7392
  ds_write_b32 v180, v225 offset:7920
  v_pk_mul_f32 v[192:193], v[194:195], v[178:179] op_sel:[0,0] op_sel_hi:[0,1]
  v_pk_fma_f32 v[192:193], v[194:195], v[178:179], v[192:193] op_sel:[1,1,0] op_sel_hi:[1,0,1] neg_lo:[1,0,0]
  v_cvt_pk_bf16_f32 v210, v192, v193
  v_pk_mul_f32 v[196:197], v[192:193], v[164:165] op_sel:[0,0] op_sel_hi:[0,1]
  v_pk_fma_f32 v[196:197], v[192:193], v[164:165], v[196:197] op_sel:[1,1,0] op_sel_hi:[1,0,1] neg_lo:[1,0,0]
  v_cvt_pk_bf16_f32 v211, v196, v197
  v_pk_mul_f32 v[198:199], v[192:193], v[168:169] op_sel:[0,0] op_sel_hi:[0,1]
  v_pk_fma_f32 v[198:199], v[192:193], v[168:169], v[198:199] op_sel:[1,1,0] op_sel_hi:[1,0,1] neg_lo:[1,0,0]
  v_cvt_pk_bf16_f32 v212, v198, v199
  v_pk_mul_f32 v[196:197], v[192:193], v[172:173] op_sel:[0,0] op_sel_hi:[0,1]
  v_pk_fma_f32 v[196:197], v[192:193], v[172:173], v[196:197] op_sel:[1,1,0] op_sel_hi:[1,0,1] neg_lo:[1,0,0]
  v_cvt_pk_bf16_f32 v213, v196, v197
  v_pk_mul_f32 v[194:195], v[192:193], v[178:179] op_sel:[0,0] op_sel_hi:[0,1]
  v_pk_fma_f32 v[194:195], v[192:193], v[178:179], v[194:195] op_sel:[1,1,0] op_sel_hi:[1,0,1] neg_lo:[1,0,0]
  v_cvt_pk_bf16_f32 v214, v194, v195
  v_pk_mul_f32 v[198:199], v[194:195], v[164:165] op_sel:[0,0] op_sel_hi:[0,1]
  v_pk_fma_f32 v[198:199], v[194:195], v[164:165], v[198:199] op_sel:[1,1,0] op_sel_hi:[1,0,1] neg_lo:[1,0,0]
  v_cvt_pk_bf16_f32 v215, v198, v199
  v_pk_mul_f32 v[196:197], v[194:195], v[168:169] op_sel:[0,0] op_sel_hi:[0,1]
  v_pk_fma_f32 v[196:197], v[194:195], v[168:169], v[196:197] op_sel:[1,1,0] op_sel_hi:[1,0,1] neg_lo:[1,0,0]
  v_cvt_pk_bf16_f32 v216, v196, v197
  v_pk_mul_f32 v[198:199], v[194:195], v[172:173] op_sel:[0,0] op_sel_hi:[0,1]
  v_pk_fma_f32 v[198:199], v[194:195], v[172:173], v[198:199] op_sel:[1,1,0] op_sel_hi:[1,0,1] neg_lo:[1,0,0]
  v_cvt_pk_bf16_f32 v217, v198, v199
  ds_write_b32 v180, v210 offset:8448
  ds_write_b32 v180, v211 offset:8976
  ds_write_b32 v180, v212 offset:9504
  ds_write_b32 v180, v213 offset:10032
  ds_write_b32 v180, v214 offset:10560
  ds_write_b32 v180, v215 offset:11088
  ds_write_b32 v180, v216 offset:11616
  ds_write_b32 v180, v217 offset:12144
  s_cmp_lg_u32 s44, 0
  s_cbranch_scc1 L_ws_11
  s_mov_b64 exec, 0xf
  v_lshlrev_b32 v252, 6, v1
  s_mov_b32 s74, 0
L_poll_12:
  buffer_load_dword v253, v252, s[24:27], 0 offen sc1
  s_waitcnt vmcnt(0)
  v_cmp_gt_u32 vcc, 64, v253
  s_cbranch_vccz L_pdone_13
  s_add_u32 s74, s74, 1
  s_cmp_lt_u32 s74, 1048576
  s_cbranch_scc1 L_poll_12
L_pdone_13:
  s_mov_b64 exec, -1
L_ws_11:
  v_lshrrev_b32 v70, 3, v1
  v_and_b32 v71, 7, v1
  s_lshl_b32 s50, s44, 4
  v_add_u32 v72, s50, v70
  v_lshrrev_b32 v73, 1, v72
  v_and_b32 v73, 1, v73
  v_lshrrev_b32 v66, 3, v72
  v_and_b32 v66, 3, v66
  v_lshl_or_b32 v73, v66, 1, v73
  v_xor_b32 v73, v73, v71
  v_lshlrev_b32 v73, 4, v73
  v_add_u32 v72, s49, v72
  v_lshl_add_u32 v66, v72, 10, v73
  s_lshl_b32 s50, s44, 4
  s_add_u32 s50, s50, 8
  v_add_u32 v72, s50, v70
  v_lshrrev_b32 v73, 1, v72
  v_and_b32 v73, 1, v73
  v_lshrrev_b32 v67, 3, v72
  v_and_b32 v67, 3, v67
  v_lshl_or_b32 v73, v67, 1, v73
  v_xor_b32 v73, v73, v71
  v_lshlrev_b32 v73, 4, v73
  v_add_u32 v72, s49, v72
  v_lshl_add_u32 v67, v72, 10, v73
  v_lshrrev_b32 v72, 2, v2
  v_lshrrev_b32 v73, 1, v2
  v_and_b32 v73, 1, v73
  v_lshl_or_b32 v73, v72, 1, v73
  v_add_u32 v70, 0, v3
  v_xor_b32 v73, v73, v70
  v_lshlrev_b32 v73, 4, v73
  v_and_b32 v70, 3, v2
  v_lshl_add_u32 v72, v72, 3, v70
  v_lshl_add_u32 v64, v72, 7, v73
  v_lshrrev_b32 v72, 2, v2
  v_lshrrev_b32 v73, 1, v2
  v_and_b32 v73, 1, v73
  v_lshl_or_b32 v73, v72, 1, v73
  v_add_u32 v70, 4, v3
  v_xor_b32 v73, v73, v70
  v_lshlrev_b32 v73, 4, v73
  v_and_b32 v70, 3, v2
  v_lshl_add_u32 v72, v72, 3, v70
  v_lshl_add_u32 v65, v72, 7, v73
  v_mov_b64 v[16:17], 0
  v_mov_b64 v[18:19], 0
  v_mov_b64 v[20:21], 0
  v_mov_b64 v[22:23], 0
  v_mov_b64 v[24:25], 0
  v_mov_b64 v[26:27], 0
  v_mov_b64 v[28:29], 0
  v_mov_b64 v[30:31], 0
  s_lshl_b32 s50, s45, 6
  s_lshl_b32 s51, s44, 4
  s_add_u32 s50, s50, s51
  v_add_u32 v68, s50, v2
  v_lshlrev_b32 v68, 12, v68
  v_lshl_add_u32 v68, v3, 4, v68
  v_lshrrev_b32 v72, 3, v2
  v_lshlrev_b32 v72, 5, v72
  v_lshl_add_u32 v72, v3, 3, v72
  v_and_b32 v73, 7, v2
  v_add3_u32 v72, v72, v73, s49
  v_lshlrev_b32 v69, 2, v72
  s_cmp_lg_u32 s44, 0
  s_cbranch_scc1 L_wc_14
  s_mov_b64 exec, 0xff
  s_lshl_b32 s50, s58, 6
  s_and_b32 s51, s2, 7
  s_add_u32 s50, s50, s51
  s_lshl_b32 s50, s50, 6
  s_add_u32 s50, s50, 0
  v_lshlrev_b32 v252, 9, v1
  s_mov_b32 s74, 0
L_poll_15:
  buffer_load_dword v253, v252, s[16:19], s50 offen sc1
  s_waitcnt vmcnt(0)
  v_cmp_gt_u32 vcc, 1, v253
  s_cbranch_vccz L_pdone_16
  s_add_u32 s74, s74, 1
  s_cmp_lt_u32 s74, 1048576
  s_cbranch_scc1 L_poll_15
L_pdone_16:
  s_mov_b64 exec, -1
L_wc_14:
  s_barrier
  v_lshlrev_b32 v156, 9, v1
  s_and_b32 s56, s2, 7
  s_lshl_b32 s56, s56, 6
  s_add_u32 s56, s56, 81920
  s_mov_b32 exec_hi, 0
  buffer_load_dword v157, v156, s[16:19], s56 offen sc1
  s_mov_b32 exec_hi, -1
  s_lshl_b32 s71, s44, 11
  s_add_u32 s75, s45, 0
  s_and_b32 s75, s75, 7
  s_lshl_b32 s75, s75, 7
  s_add_u32 s75, s75, 1048576
  s_add_u32 m0, s71, 0
  s_nop 0
  buffer_load_dwordx4 v66, s[16:19], s75 offen sc1 lds
  s_add_u32 m0, s71, 1024
  s_nop 0
  buffer_load_dwordx4 v67, s[16:19], s75 offen sc1 lds
  s_add_u32 s75, s45, 1
  s_and_b32 s75, s75, 7
  s_lshl_b32 s75, s75, 7
  s_add_u32 s75, s75, 1048576
  s_add_u32 m0, s71, 8192
  s_nop 0
  buffer_load_dwordx4 v66, s[16:19], s75 offen sc1 lds
  s_add_u32 m0, s71, 9216
  s_nop 0
  buffer_load_dwordx4 v67, s[16:19], s75 offen sc1 lds
  s_add_u32 s75, s45, 2
  s_and_b32 s75, s75, 7
  s_lshl_b32 s75, s75, 7
  s_add_u32 s75, s75, 1048576
  s_add_u32 m0, s71, 16384
  s_nop 0
  buffer_load_dwordx4 v66, s[16:19], s75 offen sc1 lds
  s_add_u32 m0, s71, 17408
  s_nop 0
  buffer_load_dwordx4 v67, s[16:19], s75 offen sc1 lds
  s_add_u32 s75, s45, 3
  s_and_b32 s75, s75, 7
  s_lshl_b32 s75, s75, 7
  s_add_u32 s75, s75, 1048576
  s_add_u32 m0, s71, 24576
  s_nop 0
  buffer_load_dwordx4 v66, s[16:19], s75 offen sc1 lds
  s_add_u32 m0, s71, 25600
  s_nop 0
  buffer_load_dwordx4 v67, s[16:19], s75 offen sc1 lds
  s_waitcnt vmcnt(6)
  s_barrier
  ds_read_b128 v[32:35], v64 offset:0
  ds_read_b128 v[36:39], v64 offset:512
  ds_read_b128 v[40:43], v64 offset:4096
  ds_read_b128 v[44:47], v64 offset:4608
  s_waitcnt lgkmcnt(3)
  v_mfma_f32_16x16x32_bf16 v[16:19], v[32:35], a[192:195], v[16:19]
  ds_read_b128 v[48:51], v65 offset:0
  s_waitcnt lgkmcnt(3)
  v_mfma_f32_16x16x32_bf16 v[20:23], v[36:39], a[192:195], v[20:23]
  ds_read_b128 v[52:55], v65 offset:512
  s_add_u32 s75, s45, 4
  s_and_b32 s75, s75, 7
  s_lshl_b32 s75, s75, 7
  s_add_u32 s75, s75, 1048576
  s_add_u32 m0, s71, 32768
  s_nop 0
  buffer_load_dwordx4 v66, s[16:19], s75 offen sc1 lds
  s_waitcnt lgkmcnt(3)
  v_mfma_f32_16x16x32_bf16 v[24:27], v[40:43], a[192:195], v[24:27]
  ds_read_b128 v[56:59], v65 offset:4096
  s_waitcnt lgkmcnt(3)
  v_mfma_f32_16x16x32_bf16 v[28:31], v[44:47], a[192:195], v[28:31]
  ds_read_b128 v[60:63], v65 offset:4608
  s_add_u32 m0, s71, 33792
  s_nop 0
  buffer_load_dwordx4 v67, s[16:19], s75 offen sc1 lds
  s_waitcnt vmcnt(4)
  s_barrier
  s_waitcnt lgkmcnt(3)
  v_mfma_f32_16x16x32_bf16 v[16:19], v[48:51], a[196:199], v[16:19]
  ds_read_b128 v[32:35], v64 offset:8192
  s_waitcnt lgkmcnt(3)
  v_mfma_f32_16x16x32_bf16 v[20:23], v[52:55], a[196:199], v[20:23]
  ds_read_b128 v[36:39], v64 offset:8704
  s_add_u32 s75, s45, 5
  s_and_b32 s75, s75, 7
  s_lshl_b32 s75, s75, 7
  s_add_u32 s75, s75, 1048576
  s_add_u32 m0, s71, 40960
  s_nop 0
  buffer_load_dwordx4 v66, s[16:19], s75 offen sc1 lds
  s_waitcnt lgkmcnt(3)
  v_mfma_f32_16x16x32_bf16 v[24:27], v[56:59], a[196:199], v[24:27]
  ds_read_b128 v[40:43], v64 offset:12288
  s_waitcnt lgkmcnt(3)
  v_mfma_f32_16x16x32_bf16 v[28:31], v[60:63], a[196:199], v[28:31]
  ds_read_b128 v[44:47], v64 offset:12800
  s_add_u32 m0, s71, 41984
  s_nop 0
  buffer_load_dwordx4 v67, s[16:19], s75 offen sc1 lds
  s_waitcnt lgkmcnt(3)
  v_mfma_f32_16x16x32_bf16 v[16:19], v[32:35], a[200:203], v[16:19]
  ds_read_b128 v[48:51], v65 offset:8192
  s_waitcnt lgkmcnt(3)
  v_mfma_f32_16x16x32_bf16 v[20:23], v[36:39], a[200:203], v[20:23]
  ds_read_b128 v[52:55], v65 offset:8704
  s_add_u32 s75, s45, 6
  s_and_b32 s75, s75, 7
  s_lshl_b32 s75, s75, 7
  s_add_u32 s75, s75, 1048576
  s_add_u32 m0, s71, 49152
  s_nop 0
  buffer_load_dwordx4 v66, s[16:19], s75 offen sc1 lds
  s_waitcnt lgkmcnt(3)
  v_mfma_f32_16x16x32_bf16 v[24:27], v[40:43], a[200:203], v[24:27]
  ds_read_b128 v[56:59], v65 offset:12288
  s_waitcnt lgkmcnt(3)
  v_mfma_f32_16x16x32_bf16 v[28:31], v[44:47], a[200:203], v[28:31]
  ds_read_b128 v[60:63], v65 offset:12800
  s_add_u32 m0, s71, 50176
  s_nop 0
  buffer_load_dwordx4 v67, s[16:19], s75 offen sc1 lds
  s_waitcnt lgkmcnt(3)
  v_mfma_f32_16x16x32_bf16 v[16:19], v[48:51], a[204:207], v[16:19]
  ds_read_b128 v[32:35], v64 offset:16384
  s_waitcnt lgkmcnt(3)
  v_mfma_f32_16x16x32_bf16 v[20:23], v[52:55], a[204:207], v[20:23]
  ds_read_b128 v[36:39], v64 offset:16896
  s_add_u32 s75, s45, 7
  s_and_b32 s75, s75, 7
  s_lshl_b32 s75, s75, 7
  s_add_u32 s75, s75, 1048576
  s_add_u32 m0, s71, 57344
  s_nop 0
  buffer_load_dwordx4 v66, s[16:19], s75 offen sc1 lds
  s_waitcnt lgkmcnt(3)
  v_mfma_f32_16x16x32_bf16 v[24:27], v[56:59], a[204:207], v[24:27]
  ds_read_b128 v[40:43], v64 offset:20480
  s_waitcnt lgkmcnt(3)
  v_mfma_f32_16x16x32_bf16 v[28:31], v[60:63], a[204:207], v[28:31]
  ds_read_b128 v[44:47], v64 offset:20992
  s_add_u32 m0, s71, 58368
  s_nop 0
  buffer_load_dwordx4 v67, s[16:19], s75 offen sc1 lds
  s_waitcnt lgkmcnt(3)
  v_mfma_f32_16x16x32_bf16 v[16:19], v[32:35], a[208:211], v[16:19]
  ds_read_b128 v[48:51], v65 offset:16384
  s_waitcnt lgkmcnt(3)
  v_mfma_f32_16x16x32_bf16 v[20:23], v[36:39], a[208:211], v[20:23]
  ds_read_b128 v[52:55], v65 offset:16896
  s_waitcnt lgkmcnt(3)
  v_mfma_f32_16x16x32_bf16 v[24:27], v[40:43], a[208:211], v[24:27]
  ds_read_b128 v[56:59], v65 offset:20480
  s_waitcnt lgkmcnt(3)
  v_mfma_f32_16x16x32_bf16 v[28:31], v[44:47], a[208:211], v[28:31]
  ds_read_b128 v[60:63], v65 offset:20992
  s_waitcnt vmcnt(6)
  s_barrier
  s_waitcnt lgkmcnt(3)
  v_mfma_f32_16x16x32_bf16 v[16:19], v[48:51], a[212:215], v[16:19]
  ds_read_b128 v[32:35], v64 offset:24576
  s_waitcnt lgkmcnt(3)
  v_mfma_f32_16x16x32_bf16 v[20:23], v[52:55], a[212:215], v[20:23]
  ds_read_b128 v[36:39], v64 offset:25088
  s_waitcnt lgkmcnt(3)
  v_mfma_f32_16x16x32_bf16 v[24:27], v[56:59], a[212:215], v[24:27]
  ds_read_b128 v[40:43], v64 offset:28672
  s_waitcnt lgkmcnt(3)
  v_mfma_f32_16x16x32_bf16 v[28:31], v[60:63], a[212:215], v[28:31]
  ds_read_b128 v[44:47], v64 offset:29184
  s_waitcnt lgkmcnt(3)
  v_mfma_f32_16x16x32_bf16 v[16:19], v[32:35], a[216:219], v[16:19]
  ds_read_b128 v[48:51], v65 offset:24576
  s_waitcnt lgkmcnt(3)
  v_mfma_f32_16x16x32_bf16 v[20:23], v[36:39], a[216:219], v[20:23]
  ds_read_b128 v[52:55], v65 offset:25088
  s_waitcnt lgkmcnt(3)
  v_mfma_f32_16x16x32_bf16 v[24:27], v[40:43], a[216:219], v[24:27]
  ds_read_b128 v[56:59], v65 offset:28672
  s_waitcnt lgkmcnt(3)
  v_mfma_f32_16x16x32_bf16 v[28:31], v[44:47], a[216:219], v[28:31]
  ds_read_b128 v[60:63], v65 offset:29184
  s_waitcnt lgkmcnt(3)
  v_mfma_f32_16x16x32_bf16 v[16:19], v[48:51], a[220:223], v[16:19]
  ds_read_b128 v[32:35], v64 offset:32768
  s_waitcnt lgkmcnt(3)
  v_mfma_f32_16x16x32_bf16 v[20:23], v[52:55], a[220:223], v[20:23]
  ds_read_b128 v[36:39], v64 offset:33280
  s_waitcnt lgkmcnt(3)
  v_mfma_f32_16x16x32_bf16 v[24:27], v[56:59], a[220:223], v[24:27]
  ds_read_b128 v[40:43], v64 offset:36864
  s_waitcnt lgkmcnt(3)
  v_mfma_f32_16x16x32_bf16 v[28:31], v[60:63], a[220:223], v[28:31]
  ds_read_b128 v[44:47], v64 offset:37376
  s_waitcnt lgkmcnt(3)
  v_mfma_f32_16x16x32_bf16 v[16:19], v[32:35], a[224:227], v[16:19]
  ds_read_b128 v[48:51], v65 offset:32768
  s_waitcnt lgkmcnt(3)
  v_mfma_f32_16x16x32_bf16 v[20:23], v[36:39], a[224:227], v[20:23]
  ds_read_b128 v[52:55], v65 offset:33280
  s_waitcnt lgkmcnt(3)
  v_mfma_f32_16x16x32_bf16 v[24:27], v[40:43], a[224:227], v[24:27]
  ds_read_b128 v[56:59], v65 offset:36864
  s_waitcnt lgkmcnt(3)
  v_mfma_f32_16x16x32_bf16 v[28:31], v[44:47], a[224:227], v[28:31]
  ds_read_b128 v[60:63], v65 offset:37376
  s_waitcnt vmcnt(0)
  s_barrier
  s_waitcnt lgkmcnt(3)
  v_mfma_f32_16x16x32_bf16 v[16:19], v[48:51], a[228:231], v[16:19]
  ds_read_b128 v[32:35], v64 offset:40960
  s_waitcnt lgkmcnt(3)
  v_mfma_f32_16x16x32_bf16 v[20:23], v[52:55], a[228:231], v[20:23]
  ds_read_b128 v[36:39], v64 offset:41472
  s_waitcnt lgkmcnt(3)
  v_mfma_f32_16x16x32_bf16 v[24:27], v[56:59], a[228:231], v[24:27]
  ds_read_b128 v[40:43], v64 offset:45056
  s_waitcnt lgkmcnt(3)
  v_mfma_f32_16x16x32_bf16 v[28:31], v[60:63], a[228:231], v[28:31]
  ds_read_b128 v[44:47], v64 offset:45568
  s_waitcnt lgkmcnt(3)
  v_mfma_f32_16x16x32_bf16 v[16:19], v[32:35], a[232:235], v[16:19]
  ds_read_b128 v[48:51], v65 offset:40960
  s_waitcnt lgkmcnt(3)
  v_mfma_f32_16x16x32_bf16 v[20:23], v[36:39], a[232:235], v[20:23]
  ds_read_b128 v[52:55], v65 offset:41472
  s_waitcnt lgkmcnt(3)
  v_mfma_f32_16x16x32_bf16 v[24:27], v[40:43], a[232:235], v[24:27]
  ds_read_b128 v[56:59], v65 offset:45056
  s_waitcnt lgkmcnt(3)
  v_mfma_f32_16x16x32_bf16 v[28:31], v[44:47], a[232:235], v[28:31]
  ds_read_b128 v[60:63], v65 offset:45568
  s_waitcnt lgkmcnt(3)
  v_mfma_f32_16x16x32_bf16 v[16:19], v[48:51], a[236:239], v[16:19]
  ds_read_b128 v[32:35], v64 offset:49152
  s_waitcnt lgkmcnt(3)
  v_mfma_f32_16x16x32_bf16 v[20:23], v[52:55], a[236:239], v[20:23]
  ds_read_b128 v[36:39], v64 offset:49664
  s_waitcnt lgkmcnt(3)
  v_mfma_f32_16x16x32_bf16 v[24:27], v[56:59], a[236:239], v[24:27]
  ds_read_b128 v[40:43], v64 offset:53248
  s_waitcnt lgkmcnt(3)
  v_mfma_f32_16x16x32_bf16 v[28:31], v[60:63], a[236:239], v[28:31]
  ds_read_b128 v[44:47], v64 offset:53760
  s_waitcnt lgkmcnt(3)
  v_mfma_f32_16x16x32_bf16 v[16:19], v[32:35], a[240:243], v[16:19]
  ds_read_b128 v[48:51], v65 offset:49152
  s_waitcnt lgkmcnt(3)
  v_mfma_f32_16x16x32_bf16 v[20:23], v[36:39], a[240:243], v[20:23]
  ds_read_b128 v[52:55], v65 offset:49664
  s_waitcnt lgkmcnt(3)
  v_mfma_f32_16x16x32_bf16 v[24:27], v[40:43], a[240:243], v[24:27]
  ds_read_b128 v[56:59], v65 offset:53248
  s_waitcnt lgkmcnt(3)
  v_mfma_f32_16x16x32_bf16 v[28:31], v[44:47], a[240:243], v[28:31]
  ds_read_b128 v[60:63], v65 offset:53760
  s_waitcnt lgkmcnt(3)
  v_mfma_f32_16x16x32_bf16 v[16:19], v[48:51], a[244:247], v[16:19]
  ds_read_b128 v[32:35], v64 offset:57344
  s_waitcnt lgkmcnt(3)
  v_mfma_f32_16x16x32_bf16 v[20:23], v[52:55], a[244:247], v[20:23]
  ds_read_b128 v[36:39], v64 offset:57856
  s_waitcnt lgkmcnt(3)
  v_mfma_f32_16x16x32_bf16 v[24:27], v[56:59], a[244:247], v[24:27]
  ds_read_b128 v[40:43], v64 offset:61440
  s_waitcnt lgkmcnt(3)
  v_mfma_f32_16x16x32_bf16 v[28:31], v[60:63], a[244:247], v[28:31]
  ds_read_b128 v[44:47], v64 offset:61952
  s_waitcnt lgkmcnt(3)
  v_mfma_f32_16x16x32_bf16 v[16:19], v[32:35], a[248:251], v[16:19]
  ds_read_b128 v[48:51], v65 offset:57344
  s_waitcnt lgkmcnt(3)
  v_mfma_f32_16x16x32_bf16 v[20:23], v[36:39], a[248:251], v[20:23]
  ds_read_b128 v[52:55], v65 offset:57856
  s_waitcnt lgkmcnt(3)
  v_mfma_f32_16x16x32_bf16 v[24:27], v[40:43], a[248:251], v[24:27]
  ds_read_b128 v[56:59], v65 offset:61440
  s_waitcnt lgkmcnt(3)
  v_mfma_f32_16x16x32_bf16 v[28:31], v[44:47], a[248:251], v[28:31]
  ds_read_b128 v[60:63], v65 offset:61952
  s_waitcnt lgkmcnt(3)
  v_mfma_f32_16x16x32_bf16 v[16:19], v[48:51], a[252:255], v[16:19]
  s_waitcnt lgkmcnt(2)
  v_mfma_f32_16x16x32_bf16 v[20:23], v[52:55], a[252:255], v[20:23]
  s_waitcnt lgkmcnt(1)
  v_mfma_f32_16x16x32_bf16 v[24:27], v[56:59], a[252:255], v[24:27]
  s_waitcnt lgkmcnt(0)
  v_mfma_f32_16x16x32_bf16 v[28:31], v[60:63], a[252:255], v[28:31]
  v_lshlrev_b32 v80, 16, v232
  v_and_b32 v81, s70, v232
  v_lshlrev_b32 v82, 16, v233
  v_and_b32 v83, s70, v233
  v_lshlrev_b32 v84, 16, v234
  v_and_b32 v85, s70, v234
  v_lshlrev_b32 v86, 16, v235
  v_and_b32 v87, s70, v235
  v_lshlrev_b32 v88, 16, v236
  v_and_b32 v89, s70, v236
  v_lshlrev_b32 v90, 16, v237
  v_and_b32 v91, s70, v237
  v_lshlrev_b32 v92, 16, v238
  v_and_b32 v93, s70, v238
  v_lshlrev_b32 v94, 16, v239
  v_and_b32 v95, s70, v239
  v_pk_add_f32 v[80:81], v[80:81], v[16:17]
  v_pk_add_f32 v[82:83], v[82:83], v[18:19]
  v_pk_add_f32 v[84:85], v[84:85], v[20:21]
  v_pk_add_f32 v[86:87], v[86:87], v[22:23]
  v_pk_add_f32 v[88:89], v[88:89], v[24:25]
  v_pk_add_f32 v[90:91], v[90:91], v[26:27]
  v_pk_add_f32 v[92:93], v[92:93], v[28:29]
  v_pk_add_f32 v[94:95], v[94:95], v[30:31]
  v_cvt_pk_bf16_f32 v100, v80, v81
  v_cvt_pk_bf16_f32 v101, v82, v83
  v_cvt_pk_bf16_f32 v102, v84, v85
  v_cvt_pk_bf16_f32 v103, v86, v87
  v_cvt_pk_bf16_f32 v104, v88, v89
  v_cvt_pk_bf16_f32 v105, v90, v91
  v_cvt_pk_bf16_f32 v106, v92, v93
  v_cvt_pk_bf16_f32 v107, v94, v95
  s_lshl_b32 s50, s49, 1
  s_add_u32 s50, s50, 3145728
  buffer_store_dwordx4 v[100:103], v68, s[16:19], s50 offen sc1
  buffer_store_dwordx4 v[104:107], v68, s[16:19], s50 offen offset:64 sc1
  v_pk_mul_f32 v[112:113], v[80:81], v[80:81]
  v_pk_mul_f32 v[114:115], v[82:83], v[82:83]
  v_pk_mul_f32 v[116:117], v[84:85], v[84:85]
  v_pk_mul_f32 v[118:119], v[86:87], v[86:87]
  v_pk_mul_f32 v[120:121], v[88:89], v[88:89]
  v_pk_mul_f32 v[122:123], v[90:91], v[90:91]
  v_pk_mul_f32 v[124:125], v[92:93], v[92:93]
  v_pk_mul_f32 v[126:127], v[94:95], v[94:95]
  v_add_f32_dpp v128, v80, v80 row_ror:8 row_mask:0xf bank_mask:0x3
  v_add_f32_dpp v129, v81, v81 row_ror:8 row_mask:0xf bank_mask:0x3
  v_add_f32_dpp v130, v82, v82 row_ror:8 row_mask:0xf bank_mask:0x3
  v_add_f32_dpp v131, v83, v83 row_ror:8 row_mask:0xf bank_mask:0x3
  v_add_f32_dpp v132, v84, v84 row_ror:8 row_mask:0xf bank_mask:0x3
  v_add_f32_dpp v133, v85, v85 row_ror:8 row_mask:0xf bank_mask:0x3
  v_add_f32_dpp v134, v86, v86 row_ror:8 row_mask:0xf bank_mask:0x3
  v_add_f32_dpp v135, v87, v87 row_ror:8 row_mask:0xf bank_mask:0x3
  v_add_f32_dpp v128, v88, v88 row_ror:8 row_mask:0xf bank_mask:0xc
  v_add_f32_dpp v129, v89, v89 row_ror:8 row_mask:0xf bank_mask:0xc
  v_add_f32_dpp v130, v90, v90 row_ror:8 row_mask:0xf bank_mask:0xc
  v_add_f32_dpp v131, v91, v91 row_ror:8 row_mask:0xf bank_mask:0xc
  v_add_f32_dpp v132, v92, v92 row_ror:8 row_mask:0xf bank_mask:0xc
  v_add_f32_dpp v133, v93, v93 row_ror:8 row_mask:0xf bank_mask:0xc
  v_add_f32_dpp v134, v94, v94 row_ror:8 row_mask:0xf bank_mask:0xc
  v_add_f32_dpp v135, v95, v95 row_ror:8 row_mask:0xf bank_mask:0xc
  v_add_f32_dpp v136, v112, v112 row_ror:8 row_mask:0xf bank_mask:0x3
  v_add_f32_dpp v137, v113, v113 row_ror:8 row_mask:0xf bank_mask:0x3
  v_add_f32_dpp v138, v114, v114 row_ror:8 row_mask:0xf bank_mask:0x3
  v_add_f32_dpp v139, v115, v115 row_ror:8 row_mask:0xf bank_mask:0x3
  v_add_f32_dpp v140, v116, v116 row_ror:8 row_mask:0xf bank_mask:0x3
  v_add_f32_dpp v141, v117, v117 row_ror:8 row_mask:0xf bank_mask:0x3
  v_add_f32_dpp v142, v118, v118 row_ror:8 row_mask:0xf bank_mask:0x3
  v_add_f32_dpp v143, v119, v119 row_ror:8 row_mask:0xf bank_mask:0x3
  v_add_f32_dpp v136, v120, v120 row_ror:8 row_mask:0xf bank_mask:0xc
  v_add_f32_dpp v137, v121, v121 row_ror:8 row_mask:0xf bank_mask:0xc
  v_add_f32_dpp v138, v122, v122 row_ror:8 row_mask:0xf bank_mask:0xc
  v_add_f32_dpp v139, v123, v123 row_ror:8 row_mask:0xf bank_mask:0xc
  v_add_f32_dpp v140, v124, v124 row_ror:8 row_mask:0xf bank_mask:0xc
  v_add_f32_dpp v141, v125, v125 row_ror:8 row_mask:0xf bank_mask:0xc
  v_add_f32_dpp v142, v126, v126 row_ror:8 row_mask:0xf bank_mask:0xc
  v_add_f32_dpp v143, v127, v127 row_ror:8 row_mask:0xf bank_mask:0xc
  v_add_f32_dpp v144, v128, v128 row_shl:4 row_mask:0xf bank_mask:0x5
  v_add_f32_dpp v145, v129, v129 row_shl:4 row_mask:0xf bank_mask:0x5
  v_add_f32_dpp v146, v130, v130 row_shl:4 row_mask:0xf bank_mask:0x5
  v_add_f32_dpp v147, v131, v131 row_shl:4 row_mask:0xf bank_mask:0x5
  v_add_f32_dpp v144, v132, v132 row_shr:4 row_mask:0xf bank_mask:0xa
  v_add_f32_dpp v145, v133, v133 row_shr:4 row_mask:0xf bank_mask:0xa
  v_add_f32_dpp v146, v134, v134 row_shr:4 row_mask:0xf bank_mask:0xa
  v_add_f32_dpp v147, v135, v135 row_shr:4 row_mask:0xf bank_mask:0xa
  v_add_f32_dpp v148, v136, v136 row_shl:4 row_mask:0xf bank_mask:0x5
  v_add_f32_dpp v149, v137, v137 row_shl:4 row_mask:0xf bank_mask:0x5
  v_add_f32_dpp v150, v138, v138 row_shl:4 row_mask:0xf bank_mask:0x5
  v_add_f32_dpp v151, v139, v139 row_shl:4 row_mask:0xf bank_mask:0x5
  v_add_f32_dpp v148, v140, v140 row_shr:4 row_mask:0xf bank_mask:0xa
  v_add_f32_dpp v149, v141, v141 row_shr:4 row_mask:0xf bank_mask:0xa
  v_add_f32_dpp v150, v142, v142 row_shr:4 row_mask:0xf bank_mask:0xa
  v_add_f32_dpp v151, v143, v143 row_shr:4 row_mask:0xf bank_mask:0xa
  v_add_f32_dpp v144, v144, v144 quad_perm:[2,3,0,1] row_mask:0xf bank_mask:0xf
  v_add_f32_dpp v145, v145, v145 quad_perm:[2,3,0,1] row_mask:0xf bank_mask:0xf
  v_add_f32_dpp v146, v146, v146 quad_perm:[2,3,0,1] row_mask:0xf bank_mask:0xf
  v_add_f32_dpp v147, v147, v147 quad_perm:[2,3,0,1] row_mask:0xf bank_mask:0xf
  v_add_f32_dpp v144, v144, v144 quad_perm:[1,0,3,2] row_mask:0xf bank_mask:0xf
  v_add_f32_dpp v145, v145, v145 quad_perm:[1,0,3,2] row_mask:0xf bank_mask:0xf
  v_add_f32_dpp v146, v146, v146 quad_perm:[1,0,3,2] row_mask:0xf bank_mask:0xf
  v_add_f32_dpp v147, v147, v147 quad_perm:[1,0,3,2] row_mask:0xf bank_mask:0xf
  v_add_f32_dpp v148, v148, v148 quad_perm:[2,3,0,1] row_mask:0xf bank_mask:0xf
  v_add_f32_dpp v149, v149, v149 quad_perm:[2,3,0,1] row_mask:0xf bank_mask:0xf
  v_add_f32_dpp v150, v150, v150 quad_perm:[2,3,0,1] row_mask:0xf bank_mask:0xf
  v_add_f32_dpp v151, v151, v151 quad_perm:[2,3,0,1] row_mask:0xf bank_mask:0xf
  v_add_f32_dpp v148, v148, v148 quad_perm:[1,0,3,2] row_mask:0xf bank_mask:0xf
  v_add_f32_dpp v149, v149, v149 quad_perm:[1,0,3,2] row_mask:0xf bank_mask:0xf
  v_add_f32_dpp v150, v150, v150 quad_perm:[1,0,3,2] row_mask:0xf bank_mask:0xf
  v_add_f32_dpp v151, v151, v151 quad_perm:[1,0,3,2] row_mask:0xf bank_mask:0xf
  v_cndmask_b32 v144, v144, v145, s[60:61]
  v_cndmask_b32 v148, v148, v149, s[60:61]
  v_cndmask_b32 v144, v144, v146, s[62:63]
  v_cndmask_b32 v148, v148, v150, s[62:63]
  v_cndmask_b32 v144, v144, v147, s[64:65]
  v_cndmask_b32 v145, v148, v151, s[64:65]
  v_lshlrev_b32 v72, 3, v0
  v_add_u32 v72, 65536, v72
  ds_write_b64 v72, v[144:145]
  v_lshlrev_b32 v73, 3, v1
  s_lshl_b32 s52, s44, 2
  s_add_u32 s52, s52, 65536
  v_add_u32 v73, s52, v73
  s_waitcnt lgkmcnt(0)
  s_barrier
  s_cmp_ge_u32 s44, 2
  s_cbranch_scc1 L_pa_17
  ds_read_b32 v152, v73 offset:0
  ds_read_b32 v153, v73 offset:512
  ds_read_b32 v154, v73 offset:1024
  ds_read_b32 v155, v73 offset:1536
  s_lshl_b32 s50, s44, 13
  s_add_u32 s50, s50, 131072
  s_waitcnt lgkmcnt(0)
  v_add_f32 v152, v152, v153
  v_add_f32 v154, v154, v155
  v_add_f32 v152, v152, v154
  buffer_atomic_add_f32 v152, v69, s[16:19], s50 offen
L_pa_17:
  v_pk_mul_f32 v[192:193], v[194:195], v[178:179] op_sel:[0,0] op_sel_hi:[0,1]
  v_pk_fma_f32 v[192:193], v[194:195], v[178:179], v[192:193] op_sel:[1,1,0] op_sel_hi:[1,0,1] neg_lo:[1,0,0]
  v_cvt_pk_bf16_f32 v218, v192, v193
  v_pk_mul_f32 v[196:197], v[192:193], v[168:169] op_sel:[0,0] op_sel_hi:[0,1]
  v_pk_fma_f32 v[196:197], v[192:193], v[168:169], v[196:197] op_sel:[1,1,0] op_sel_hi:[1,0,1] neg_lo:[1,0,0]
  v_cvt_pk_bf16_f32 v219, v196, v197
  v_pk_mul_f32 v[194:195], v[192:193], v[178:179] op_sel:[0,0] op_sel_hi:[0,1]
  v_pk_fma_f32 v[194:195], v[192:193], v[178:179], v[194:195] op_sel:[1,1,0] op_sel_hi:[1,0,1] neg_lo:[1,0,0]
  v_cvt_pk_bf16_f32 v220, v194, v195
  v_pk_mul_f32 v[198:199], v[194:195], v[168:169] op_sel:[0,0] op_sel_hi:[0,1]
  v_pk_fma_f32 v[198:199], v[194:195], v[168:169], v[198:199] op_sel:[1,1,0] op_sel_hi:[1,0,1] neg_lo:[1,0,0]
  v_cvt_pk_bf16_f32 v221, v198, v199
  v_pk_mul_f32 v[192:193], v[194:195], v[178:179] op_sel:[0,0] op_sel_hi:[0,1]
  v_pk_fma_f32 v[192:193], v[194:195], v[178:179], v[192:193] op_sel:[1,1,0] op_sel_hi:[1,0,1] neg_lo:[1,0,0]
  v_cvt_pk_bf16_f32 v222, v192, v193
  v_pk_mul_f32 v[196:197], v[192:193], v[168:169] op_sel:[0,0] op_sel_hi:[0,1]
  v_pk_fma_f32 v[196:197], v[192:193], v[168:169], v[196:197] op_sel:[1,1,0] op_sel_hi:[1,0,1] neg_lo:[1,0,0]
  v_cvt_pk_bf16_f32 v223, v196, v197
  v_pk_mul_f32 v[194:195], v[192:193], v[178:179] op_sel:[0,0] op_sel_hi:[0,1]
  v_pk_fma_f32 v[194:195], v[192:193], v[178:179], v[194:195] op_sel:[1,1,0] op_sel_hi:[1,0,1] neg_lo:[1,0,0]
  v_cvt_pk_bf16_f32 v224, v194, v195
  v_pk_mul_f32 v[198:199], v[194:195], v[168:169] op_sel:[0,0] op_sel_hi:[0,1]
  v_pk_fma_f32 v[198:199], v[194:195], v[168:169], v[198:199] op_sel:[1,1,0] op_sel_hi:[1,0,1] neg_lo:[1,0,0]
  v_cvt_pk_bf16_f32 v225, v198, v199
  ds_write_b32 v180, v218 offset:12672
  ds_write_b32 v180, v219 offset:13200
  ds_write_b32 v180, v220 offset:13728
  ds_write_b32 v180, v221 offset:14256
  ds_write_b32 v180, v222 offset:14784
  ds_write_b32 v180, v223 offset:15312
  ds_write_b32 v180, v224 offset:15840
  ds_write_b32 v180, v225 offset:16368
  v_pk_mul_f32 v[192:193], v[194:195], v[178:179] op_sel:[0,0] op_sel_hi:[0,1]
  v_pk_fma_f32 v[192:193], v[194:195], v[178:179], v[192:193] op_sel:[1,1,0] op_sel_hi:[1,0,1] neg_lo:[1,0,0]
  v_cvt_pk_bf16_f32 v210, v192, v193
  v_pk_mul_f32 v[194:195], v[192:193], v[178:179] op_sel:[0,0] op_sel_hi:[0,1]
  v_pk_fma_f32 v[194:195], v[192:193], v[178:179], v[194:195] op_sel:[1,1,0] op_sel_hi:[1,0,1] neg_lo:[1,0,0]
  v_cvt_pk_bf16_f32 v211, v194, v195
  v_pk_mul_f32 v[192:193], v[194:195], v[178:179] op_sel:[0,0] op_sel_hi:[0,1]
  v_pk_fma_f32 v[192:193], v[194:195], v[178:179], v[192:193] op_sel:[1,1,0] op_sel_hi:[1,0,1] neg_lo:[1,0,0]
  v_cvt_pk_bf16_f32 v212, v192, v193
  v_pk_mul_f32 v[194:195], v[192:193], v[178:179] op_sel:[0,0] op_sel_hi:[0,1]
  v_pk_fma_f32 v[194:195], v[192:193], v[178:179], v[194:195] op_sel:[1,1,0] op_sel_hi:[1,0,1] neg_lo:[1,0,0]
  v_cvt_pk_bf16_f32 v213, v194, v195
  v_pk_mul_f32 v[192:193], v[194:195], v[178:179] op_sel:[0,0] op_sel_hi:[0,1]
  v_pk_fma_f32 v[192:193], v[194:195], v[178:179], v[192:193] op_sel:[1,1,0] op_sel_hi:[1,0,1] neg_lo:[1,0,0]
  v_cvt_pk_bf16_f32 v214, v192, v193
  v_pk_mul_f32 v[194:195], v[192:193], v[178:179] op_sel:[0,0] op_sel_hi:[0,1]
  v_pk_fma_f32 v[194:195], v[192:193], v[178:179], v[194:195] op_sel:[1,1,0] op_sel_hi:[1,0,1] neg_lo:[1,0,0]
  v_cvt_pk_bf16_f32 v215, v194, v195
  v_pk_mul_f32 v[192:193], v[194:195], v[178:179] op_sel:[0,0] op_sel_hi:[0,1]
  v_pk_fma_f32 v[192:193], v[194:195], v[178:179], v[192:193] op_sel:[1,1,0] op_sel_hi:[1,0,1] neg_lo:[1,0,0]
  v_cvt_pk_bf16_f32 v216, v192, v193
  v_pk_mul_f32 v[194:195], v[192:193], v[178:179] op_sel:[0,0] op_sel_hi:[0,1]
  v_pk_fma_f32 v[194:195], v[192:193], v[178:179], v[194:195] op_sel:[1,1,0] op_sel_hi:[1,0,1] neg_lo:[1,0,0]
  v_cvt_pk_bf16_f32 v217, v194, v195
  ds_write_b32 v180, v210 offset:16896
  ds_write_b32 v180, v211 offset:17424
  ds_write_b32 v180, v212 offset:17952
  ds_write_b32 v180, v213 offset:18480
  ds_write_b32 v180, v214 offset:19008
  ds_write_b32 v180, v215 offset:19536
  ds_write_b32 v180, v216 offset:20064
  ds_write_b32 v180, v217 offset:20592
  v_pk_mul_f32 v[192:193], v[194:195], v[178:179] op_sel:[0,0] op_sel_hi:[0,1]
  v_pk_fma_f32 v[192:193], v[194:195], v[178:179], v[192:193] op_sel:[1,1,0] op_sel_hi:[1,0,1] neg_lo:[1,0,0]
  v_cvt_pk_bf16_f32 v218, v192, v193
  v_mov_b32 v188, 1.0
  v_mov_b32 v189, 0
  v_cvt_pk_bf16_f32 v219, v188, -v189
  v_cvt_pk_bf16_f32 v220, v176, -v177
  v_pk_mul_f32 v[188:189], v[176:177], v[176:177] op_sel:[0,0] op_sel_hi:[0,1]
  v_pk_fma_f32 v[188:189], v[176:177], v[176:177], v[188:189] op_sel:[1,1,0] op_sel_hi:[1,0,1] neg_lo:[1,0,0]
  v_cvt_pk_bf16_f32 v221, v188, -v189
  v_pk_mul_f32 v[190:191], v[188:189], v[176:177] op_sel:[0,0] op_sel_hi:[0,1]
  v_pk_fma_f32 v[190:191], v[188:189], v[176:177], v[190:191] op_sel:[1,1,0] op_sel_hi:[1,0,1] neg_lo:[1,0,0]
  v_cvt_pk_bf16_f32 v222, v190, -v191
  v_pk_mul_f32 v[188:189], v[190:191], v[176:177] op_sel:[0,0] op_sel_hi:[0,1]
  v_pk_fma_f32 v[188:189], v[190:191], v[176:177], v[188:189] op_sel:[1,1,0] op_sel_hi:[1,0,1] neg_lo:[1,0,0]
  v_cvt_pk_bf16_f32 v223, v188, -v189
  v_pk_mul_f32 v[190:191], v[188:189], v[176:177] op_sel:[0,0] op_sel_hi:[0,1]
  v_pk_fma_f32 v[190:191], v[188:189], v[176:177], v[190:191] op_sel:[1,1,0] op_sel_hi:[1,0,1] neg_lo:[1,0,0]
  v_cvt_pk_bf16_f32 v224, v190, -v191
  v_pk_mul_f32 v[188:189], v[190:191], v[176:177] op_sel:[0,0] op_sel_hi:[0,1]
  v_pk_fma_f32 v[188:189], v[190:191], v[176:177], v[188:189] op_sel:[1,1,0] op_sel_hi:[1,0,1] neg_lo:[1,0,0]
  v_cvt_pk_bf16_f32 v225, v188, -v189
  ds_write_b32 v180, v218 offset:21120
  ds_write_b32 v181, v219 offset:0
  ds_write_b32 v181, v220 offset:528
  ds_write_b32 v181, v221 offset:1056
  ds_write_b32 v181, v222 offset:1584
  ds_write_b32 v181, v223 offset:2112
  ds_write_b32 v181, v224 offset:2640
  ds_write_b32 v181, v225 offset:3168
  v_pk_mul_f32 v[190:191], v[188:189], v[176:177] op_sel:[0,0] op_sel_hi:[0,1]
  v_pk_fma_f32 v[190:191], v[188:189], v[176:177], v[190:191] op_sel:[1,1,0] op_sel_hi:[1,0,1] neg_lo:[1,0,0]
  v_cvt_pk_bf16_f32 v210, v190, -v191
  v_pk_mul_f32 v[188:189], v[190:191], v[176:177] op_sel:[0,0] op_sel_hi:[0,1]
  v_pk_fma_f32 v[188:189], v[190:191], v[176:177], v[188:189] op_sel:[1,1,0] op_sel_hi:[1,0,1] neg_lo:[1,0,0]
  v_cvt_pk_bf16_f32 v211, v188, -v189
  v_pk_mul_f32 v[190:191], v[188:189], v[176:177] op_sel:[0,0] op_sel_hi:[0,1]
  v_pk_fma_f32 v[190:191], v[188:189], v[176:177], v[190:191] op_sel:[1,1,0] op_sel_hi:[1,0,1] neg_lo:[1,0,0]
  v_cvt_pk_bf16_f32 v212, v190, -v191
  v_pk_mul_f32 v[188:189], v[190:191], v[176:177] op_sel:[0,0] op_sel_hi:[0,1]
  v_pk_fma_f32 v[188:189], v[190:191], v[176:177], v[188:189] op_sel:[1,1,0] op_sel_hi:[1,0,1] neg_lo:[1,0,0]
  v_cvt_pk_bf16_f32 v213, v188, -v189
  v_pk_mul_f32 v[190:191], v[188:189], v[176:177] op_sel:[0,0] op_sel_hi:[0,1]
  v_pk_fma_f32 v[190:191], v[188:189], v[176:177], v[190:191] op_sel:[1,1,0] op_sel_hi:[1,0,1] neg_lo:[1,0,0]
  v_cvt_pk_bf16_f32 v214, v190, -v191
  v_pk_mul_f32 v[188:189], v[190:191], v[176:177] op_sel:[0,0] op_sel_hi:[0,1]
  v_pk_fma_f32 v[188:189], v[190:191], v[176:177], v[188:189] op_sel:[1,1,0] op_sel_hi:[1,0,1] neg_lo:[1,0,0]
  v_cvt_pk_bf16_f32 v215, v188, -v189
  v_pk_mul_f32 v[190:191], v[188:189], v[176:177] op_sel:[0,0] op_sel_hi:[0,1]
  v_pk_fma_f32 v[190:191], v[188:189], v[176:177], v[190:191] op_sel:[1,1,0] op_sel_hi:[1,0,1] neg_lo:[1,0,0]
  v_cvt_pk_bf16_f32 v216, v190, -v191
  v_pk_mul_f32 v[188:189], v[190:191], v[176:177] op_sel:[0,0] op_sel_hi:[0,1]
  v_pk_fma_f32 v[188:189], v[190:191], v[176:177], v[188:189] op_sel:[1,1,0] op_sel_hi:[1,0,1] neg_lo:[1,0,0]
  v_cvt_pk_bf16_f32 v217, v188, -v189
  ds_write_b32 v181, v210 offset:3696
  ds_write_b32 v181, v211 offset:4224
  ds_write_b32 v181, v212 offset:4752
  ds_write_b32 v181, v213 offset:5280
  ds_write_b32 v181, v214 offset:5808
  ds_write_b32 v181, v215 offset:6336
  ds_write_b32 v181, v216 offset:6864
  ds_write_b32 v181, v217 offset:7392
  v_pk_mul_f32 v[190:191], v[188:189], v[176:177] op_sel:[0,0] op_sel_hi:[0,1]
  v_pk_fma_f32 v[190:191], v[188:189], v[176:177], v[190:191] op_sel:[1,1,0] op_sel_hi:[1,0,1] neg_lo:[1,0,0]
  v_cvt_pk_bf16_f32 v218, v190, -v191
  ds_write_b32 v181, v218 offset:7920
  s_waitcnt lgkmcnt(0)
  s_waitcnt vmcnt(0) lgkmcnt(0)
  s_barrier
  s_cmp_lg_u32 s44, 0
  s_cbranch_scc1 L_fs_18
  s_mov_b64 exec, 1
  s_lshl_b32 s50, s2, 6
  s_add_u32 s50, s50, 16384
  v_mov_b32 v252, 0
  v_mov_b32 v253, 1
  buffer_store_dword v253, v252, s[16:19], s50 offen sc1
  s_mov_b64 exec, -1
L_fs_18:
  s_add_u32 s56, s79, 1
  s_mov_b32 exec_hi, 0
  v_cmp_ne_u32 vcc, s56, v157
  s_mov_b32 exec_hi, -1
  s_nop 0
  s_cmp_eq_u64 vcc, 0
  s_cselect_b32 s59, 1, 0
  s_mov_b32 s78, s59
  s_cmp_lg_u32 s44, 3
  s_cbranch_scc1 L_pt4_19
  v_and_b32 v252, 31, v1
  v_lshlrev_b32 v252, 7, v252
  v_lshrrev_b32 v253, 5, v1
  v_lshl_add_u32 v252, v253, 17, v252
  s_lshl_b32 s57, s48, 12
  s_add_u32 s57, s57, 11534336
  buffer_load_dword v253, v252, s[16:19], s57 offen sc1
L_pt4_19:
  s_cmp_lg_u32 s44, 2
  s_cbranch_scc1 L_pt5_20
  s_lshr_b32 s57, s2, 3
  s_lshl_b32 s57, s57, 6
  v_add_u32 v252, s57, v1
  v_lshlrev_b32 v252, 10, v252
  s_and_b32 s57, s2, 7
  s_lshl_b32 s57, s57, 7
  buffer_load_dword v253, v252, s[20:23], s57 offen sc1
L_pt5_20:
  s_barrier
  s_lshr_b32 s50, s44, 1
  v_mul_u32_u24 v52, 528, v2
  v_lshl_add_u32 v52, v3, 4, v52
  s_mul_i32 s52, s50, 8448
  s_add_u32 s52, s52, 125216
  v_add_u32 v55, s52, v52
  s_mul_i32 s50, s50, 21648
  s_add_u32 s50, s50, 81920
  s_and_b32 s51, s44, 1
  s_mul_i32 s52, s51, 16896
  s_add_u32 s52, s52, s50
  v_add_u32 v53, s52, v52
  s_mul_i32 s52, s51, 8448
  s_add_u32 s52, s52, 8448
  s_add_u32 s52, s52, s50
  v_add_u32 v54, s52, v52
  ds_read_b128 v[128:131], v55 offset:0
  ds_read_b128 v[64:67], v53 offset:0
  ds_read_b128 v[96:99], v54 offset:0
  ds_read_b128 v[132:135], v55 offset:64
  ds_read_b128 v[68:71], v53 offset:64
  ds_read_b128 v[100:103], v54 offset:64
  ds_read_b128 v[136:139], v55 offset:128
  ds_read_b128 v[72:75], v53 offset:128
  ds_read_b128 v[104:107], v54 offset:128
  ds_read_b128 v[140:143], v55 offset:192
  ds_read_b128 v[76:79], v53 offset:192
  ds_read_b128 v[108:111], v54 offset:192
  s_waitcnt lgkmcnt(6)
  ds_read_b128 v[144:147], v55 offset:256
  ds_read_b128 v[80:83], v53 offset:256
  ds_read_b128 v[112:115], v54 offset:256
  ds_read_b128 v[148:151], v55 offset:320
  ds_read_b128 v[84:87], v53 offset:320
  ds_read_b128 v[116:119], v54 offset:320
  ds_read_b128 v[152:155], v55 offset:384
  ds_read_b128 v[88:91], v53 offset:384
  ds_read_b128 v[120:123], v54 offset:384
  ds_read_b128 v[156:159], v55 offset:448
  ds_read_b128 v[92:95], v53 offset:448
  ds_read_b128 v[124:127], v54 offset:448
  s_cmp_eq_u32 s51, 1
  s_cbranch_scc1 L_kodd_21
  v_and_b32 v48, 1, v3
  v_lshlrev_b32 v48, 2, v48
  v_lshrrev_b32 v49, 1, v3
  v_lshl_add_u32 v48, v49, 7, v48
  v_add_u32 v40, 0, v48
  v_add_u32 v41, 1, v48
  v_add_u32 v42, 2, v48
  v_add_u32 v43, 3, v48
  v_lshlrev_b32 v48, 7, v3
  v_add_u32 v48, 256, v48
  v_lshlrev_b32 v49, 8, v3
  v_cmp_lt_u32 vcc, 1, v3
  v_add_u32 v50, 0, v48
  v_add_u32 v51, 0, v49
  v_cndmask_b32 v44, v50, v51, vcc
  v_add_u32 v50, 2, v48
  v_add_u32 v51, 4, v49
  v_cndmask_b32 v45, v50, v51, vcc
  v_add_u32 v50, 4, v48
  v_add_u32 v51, 128, v49
  v_cndmask_b32 v46, v50, v51, vcc
  v_add_u32 v50, 6, v48
  v_add_u32 v51, 132, v49
  v_cndmask_b32 v47, v50, v51, vcc
  s_branch L_kdone_22
L_kodd_21:
  v_lshlrev_b32 v48, 9, v3
  v_add_u32 v40, 1024, v48
  v_mov_b32 v44, v40
  v_add_u32 v41, 1152, v48
  v_mov_b32 v45, v41
  v_add_u32 v42, 1280, v48
  v_mov_b32 v46, v42
  v_add_u32 v43, 1408, v48
  v_mov_b32 v47, v43
L_kdone_22:
  s_waitcnt lgkmcnt(0)
  v_mfma_f32_16x16x32_bf16 v[32:35], v[64:67], v[128:131], 0
  v_mfma_f32_16x16x32_bf16 v[36:39], v[96:99], v[128:131], 0
  v_mfma_f32_16x16x32_bf16 v[32:35], v[68:71], v[132:135], v[32:35]
  v_mfma_f32_16x16x32_bf16 v[36:39], v[100:103], v[132:135], v[36:39]
  v_mfma_f32_16x16x32_bf16 v[32:35], v[72:75], v[136:139], v[32:35]
  v_mfma_f32_16x16x32_bf16 v[36:39], v[104:107], v[136:139], v[36:39]
  v_mfma_f32_16x16x32_bf16 v[32:35], v[76:79], v[140:143], v[32:35]
  v_mfma_f32_16x16x32_bf16 v[36:39], v[108:111], v[140:143], v[36:39]
  v_mfma_f32_16x16x32_bf16 v[32:35], v[80:83], v[144:147], v[32:35]
  v_mfma_f32_16x16x32_bf16 v[36:39], v[112:115], v[144:147], v[36:39]
  v_mfma_f32_16x16x32_bf16 v[32:35], v[84:87], v[148:151], v[32:35]
  v_mfma_f32_16x16x32_bf16 v[36:39], v[116:119], v[148:151], v[36:39]
  v_mfma_f32_16x16x32_bf16 v[32:35], v[88:91], v[152:155], v[32:35]
  v_mfma_f32_16x16x32_bf16 v[36:39], v[120:123], v[152:155], v[36:39]
  v_mfma_f32_16x16x32_bf16 v[32:35], v[92:95], v[156:159], v[32:35]
  v_mfma_f32_16x16x32_bf16 v[36:39], v[124:127], v[156:159], v[36:39]
  s_lshr_b32 s50, s44, 1
  s_mul_i32 s50, s50, 4352
  s_add_u32 s50, s50, 148480
  v_lshl_add_u32 v40, v2, 3, v40
  v_min_u32 v40, 2175, v40
  v_lshl_add_u32 v40, v40, 1, s50
  v_lshl_add_u32 v41, v2, 3, v41
  v_min_u32 v41, 2175, v41
  v_lshl_add_u32 v41, v41, 1, s50
  v_lshl_add_u32 v42, v2, 3, v42
  v_min_u32 v42, 2175, v42
  v_lshl_add_u32 v42, v42, 1, s50
  v_lshl_add_u32 v43, v2, 3, v43
  v_min_u32 v43, 2175, v43
  v_lshl_add_u32 v43, v43, 1, s50
  v_lshl_add_u32 v44, v2, 3, v44
  v_min_u32 v44, 2175, v44
  v_lshl_add_u32 v44, v44, 1, s50
  v_lshl_add_u32 v45, v2, 3, v45
  v_min_u32 v45, 2175, v45
  v_lshl_add_u32 v45, v45, 1, s50
  v_lshl_add_u32 v46, v2, 3, v46
  v_min_u32 v46, 2175, v46
  v_lshl_add_u32 v46, v46, 1, s50
  v_lshl_add_u32 v47, v2, 3, v47
  v_min_u32 v47, 2175, v47
  v_lshl_add_u32 v47, v47, 1, s50
  v_mul_f32 v32, v32, v14
  v_cvt_pk_bf16_f32 v32, v32, v32
  ds_write_b16 v40, v32
  v_mul_f32 v33, v33, v14
  v_cvt_pk_bf16_f32 v33, v33, v33
  ds_write_b16 v41, v33
  v_mul_f32 v34, v34, v14
  v_cvt_pk_bf16_f32 v34, v34, v34
  ds_write_b16 v42, v34
  v_mul_f32 v35, v35, v14
  v_cvt_pk_bf16_f32 v35, v35, v35
  ds_write_b16 v43, v35
  v_mul_f32 v36, v36, v14
  v_cvt_pk_bf16_f32 v36, v36, v36
  ds_write_b16 v44, v36
  v_mul_f32 v37, v37, v14
  v_cvt_pk_bf16_f32 v37, v37, v37
  ds_write_b16 v45, v37
  v_mul_f32 v38, v38, v14
  v_cvt_pk_bf16_f32 v38, v38, v38
  ds_write_b16 v46, v38
  v_mul_f32 v39, v39, v14
  v_cvt_pk_bf16_f32 v39, v39, v39
  ds_write_b16 v47, v39
  v_mov_b32 v48, s50
  v_mov_b32 v49, 0
  ds_write_b16 v48, v49 offset:4340
  s_waitcnt lgkmcnt(0)
  s_barrier
  v_lshrrev_b32 v48, 7, v0
  v_mul_u32_u24 v49, 4352, v48
  v_add_u32 v49, 148480, v49
  v_mul_u32_u24 v50, 33280, v48
  v_add_u32 v50, 81920, v50
  v_and_b32 v51, 127, v0
  v_lshl_add_u32 v53, v51, 4, v50
  v_lshlrev_b32 v52, 4, v51
  v_sub_u32 v52, 4094, v52
  v_mov_b32 v56, v52
  v_subrev_u32 v57, 2, v52
  v_subrev_u32 v58, 4, v52
  v_subrev_u32 v59, 6, v52
  v_subrev_u32 v60, 8, v52
  v_subrev_u32 v61, 10, v52
  v_subrev_u32 v62, 12, v52
  v_subrev_u32 v63, 14, v52
  v_subrev_u32 v64, 2048, v52
  v_subrev_u32 v65, 2050, v52
  v_subrev_u32 v66, 2052, v52
  v_subrev_u32 v67, 2054, v52
  v_subrev_u32 v68, 2056, v52
  v_subrev_u32 v69, 2058, v52
  v_subrev_u32 v70, 2060, v52
  v_subrev_u32 v71, 2062, v52
  v_cvt_f32_u32 v56, v56
  v_cvt_f32_u32 v57, v57
  v_cvt_f32_u32 v58, v58
  v_cvt_f32_u32 v59, v59
  v_cvt_f32_u32 v60, v60
  v_cvt_f32_u32 v61, v61
  v_cvt_f32_u32 v62, v62
  v_cvt_f32_u32 v63, v63
  v_cvt_f32_u32 v64, v64
  v_cvt_f32_u32 v65, v65
  v_cvt_f32_u32 v66, v66
  v_cvt_f32_u32 v67, v67
  v_cvt_f32_u32 v68, v68
  v_cvt_f32_u32 v69, v69
  v_cvt_f32_u32 v70, v70
  v_cvt_f32_u32 v71, v71
  v_cvt_pk_bf16_f32 v56, 0, v56
  v_cvt_pk_bf16_f32 v57, 0, v57
  v_cvt_pk_bf16_f32 v58, 0, v58
  v_cvt_pk_bf16_f32 v59, 0, v59
  v_cvt_pk_bf16_f32 v60, 0, v60
  v_cvt_pk_bf16_f32 v61, 0, v61
  v_cvt_pk_bf16_f32 v62, 0, v62
  v_cvt_pk_bf16_f32 v63, 0, v63
  v_cvt_pk_bf16_f32 v64, 0, v64
  v_cvt_pk_bf16_f32 v65, 0, v65
  v_cvt_pk_bf16_f32 v66, 0, v66
  v_cvt_pk_bf16_f32 v67, 0, v67
  v_cvt_pk_bf16_f32 v68, 0, v68
  v_cvt_pk_bf16_f32 v69, 0, v69
  v_cvt_pk_bf16_f32 v70, 0, v70
  v_cvt_pk_bf16_f32 v71, 0, v71
  v_cvt_u32_f32 v56, v56
  v_cvt_u32_f32 v57, v57
  v_cvt_u32_f32 v58, v58
  v_cvt_u32_f32 v59, v59
  v_cvt_u32_f32 v60, v60
  v_cvt_u32_f32 v61, v61
  v_cvt_u32_f32 v62, v62
  v_cvt_u32_f32 v63, v63
  v_cvt_u32_f32 v64, v64
  v_cvt_u32_f32 v65, v65
  v_cvt_u32_f32 v66, v66
  v_cvt_u32_f32 v67, v67
  v_cvt_u32_f32 v68, v68
  v_cvt_u32_f32 v69, v69
  v_cvt_u32_f32 v70, v70
  v_cvt_u32_f32 v71, v71
  v_add_u32 v56, v49, v56
  ds_read_u16 v72, v56
  v_add_u32 v57, v49, v57
  ds_read_u16 v73, v57
  v_add_u32 v58, v49, v58
  ds_read_u16 v74, v58
  v_add_u32 v59, v49, v59
  ds_read_u16 v75, v59
  v_add_u32 v60, v49, v60
  ds_read_u16 v76, v60
  v_add_u32 v61, v49, v61
  ds_read_u16 v77, v61
  v_add_u32 v62, v49, v62
  ds_read_u16 v78, v62
  v_add_u32 v63, v49, v63
  ds_read_u16 v79, v63
  v_add_u32 v64, v49, v64
  ds_read_u16 v80, v64
  v_add_u32 v65, v49, v65
  ds_read_u16 v81, v65
  v_add_u32 v66, v49, v66
  ds_read_u16 v82, v66
  v_add_u32 v67, v49, v67
  ds_read_u16 v83, v67
  s_waitcnt lgkmcnt(8)
  v_add_u32 v68, v49, v68
  ds_read_u16 v84, v68
  v_add_u32 v69, v49, v69
  ds_read_u16 v85, v69
  v_add_u32 v70, v49, v70
  ds_read_u16 v86, v70
  v_add_u32 v71, v49, v71
  ds_read_u16 v87, v71
  v_mov_b64 v[92:93], 0
  v_mov_b64 v[94:95], 0
  v_mul_u32_u24 v54, 4160, v51
  v_add_u32 v54, v50, v54
  v_cmp_gt_u32 vcc, 8, v51
  s_and_saveexec_b64 s[54:55], vcc
  ds_write_b128 v54, v[92:95] offset:4096
  s_mov_b64 exec, s[54:55]
  v_cmp_eq_u32 vcc, 0, v51
  s_and_saveexec_b64 s[54:55], vcc
  ds_write_b128 v54, v[92:95] offset:4112
  s_mov_b64 exec, s[54:55]
  s_waitcnt lgkmcnt(0)
  v_lshl_or_b32 v16, v73, 16, v72
  v_lshl_or_b32 v17, v75, 16, v74
  v_lshl_or_b32 v18, v77, 16, v76
  v_lshl_or_b32 v19, v79, 16, v78
  v_lshl_or_b32 v20, v81, 16, v80
  v_lshl_or_b32 v21, v83, 16, v82
  v_lshl_or_b32 v22, v85, 16, v84
  v_lshl_or_b32 v23, v87, 16, v86
  ds_write_b128 v53, v[16:19]
  ds_write_b128 v53, v[20:23] offset:2048
  s_waitcnt lgkmcnt(0)
  s_barrier
  v_lshlrev_b32 v252, 6, v0
  s_mov_b32 s57, 16384
  buffer_load_dword v253, v252, s[16:19], s57 offen sc1
  ds_read_b128 v[16:19], v53 offset:0
  ds_read_b128 v[20:23], v53 offset:16
  ds_read_b128 v[96:99], v53 offset:2048
  ds_read_b128 v[100:103], v53 offset:2064
  s_waitcnt lgkmcnt(2)
  v_alignbit_b32 v32, v17, v16, 16
  v_alignbit_b32 v33, v18, v17, 16
  v_alignbit_b32 v34, v19, v18, 16
  v_alignbit_b32 v35, v20, v19, 16
  v_alignbit_b32 v36, v21, v20, 16
  v_alignbit_b32 v37, v22, v21, 16
  v_alignbit_b32 v38, v23, v22, 16
  ds_write_b128 v53, v[18:21] offset:16640
  v_mov_b32 v24, v17
  v_mov_b32 v25, v18
  v_mov_b32 v26, v19
  v_mov_b32 v27, v20
  v_mov_b32 v28, v21
  v_mov_b32 v29, v22
  v_mov_b32 v30, v23
  ds_write_b128 v53, v[32:35] offset:4160
  ds_write_b128 v53, v[34:37] offset:20800
  v_mov_b32 v40, v33
  v_mov_b32 v41, v34
  v_mov_b32 v42, v35
  v_mov_b32 v43, v36
  v_mov_b32 v44, v37
  v_mov_b32 v45, v38
  ds_write_b128 v53, v[24:27] offset:8320
  ds_write_b128 v53, v[26:29] offset:24960
  ds_write_b128 v53, v[40:43] offset:12480
  ds_write_b128 v53, v[42:45] offset:29120
  s_waitcnt lgkmcnt(7)
  v_alignbit_b32 v112, v97, v96, 16
  v_alignbit_b32 v113, v98, v97, 16
  v_alignbit_b32 v114, v99, v98, 16
  v_alignbit_b32 v115, v100, v99, 16
  v_alignbit_b32 v116, v101, v100, 16
  v_alignbit_b32 v117, v102, v101, 16
  v_alignbit_b32 v118, v103, v102, 16
  ds_write_b128 v53, v[98:101] offset:18688
  v_mov_b32 v104, v97
  v_mov_b32 v105, v98
  v_mov_b32 v106, v99
  v_mov_b32 v107, v100
  v_mov_b32 v108, v101
  v_mov_b32 v109, v102
  v_mov_b32 v110, v103
  ds_write_b128 v53, v[112:115] offset:6208
  ds_write_b128 v53, v[114:117] offset:22848
  v_mov_b32 v120, v113
  v_mov_b32 v121, v114
  v_mov_b32 v122, v115
  v_mov_b32 v123, v116
  v_mov_b32 v124, v117
  v_mov_b32 v125, v118
  ds_write_b128 v53, v[104:107] offset:10368
  ds_write_b128 v53, v[106:109] offset:27008
  ds_write_b128 v53, v[120:123] offset:14528
  ds_write_b128 v53, v[122:125] offset:31168
  s_waitcnt lgkmcnt(0)
  s_barrier
  s_lshl_b32 s53, s44, 7
  v_and_b32 v180, 7, v2
  v_sub_u32 v180, 7, v180
  v_mul_u32_u24 v180, 4160, v180
  v_lshrrev_b32 v181, 3, v2
  v_sub_u32 v181, v3, v181
  v_lshlrev_b32 v181, 4, v181
  s_sub_u32 s52, 81936, s53
  v_add3_u32 v176, v180, v181, s52
  v_add_u32 v178, 33280, v176
  s_sub_u32 s52, 384, s53
  v_lshlrev_b32 v180, 5, v2
  v_lshl_add_u32 v180, v3, 4, v180
  v_add_u32 v177, s52, v180
  v_add_u32 v179, 4608, v177
  v_mov_b64 v[16:17], 0
  v_mov_b64 v[18:19], 0
  v_mov_b64 v[20:21], 0
  v_mov_b64 v[22:23], 0
  v_mov_b64 v[24:25], 0
  v_mov_b64 v[26:27], 0
  v_mov_b64 v[28:29], 0
  v_mov_b64 v[30:31], 0
  v_mov_b64 v[32:33], 0
  v_mov_b64 v[34:35], 0
  v_mov_b64 v[36:37], 0
  v_mov_b64 v[38:39], 0
  v_mov_b64 v[40:41], 0
  v_mov_b64 v[42:43], 0
  v_mov_b64 v[44:45], 0
  v_mov_b64 v[46:47], 0
  v_mov_b64 v[184:185], 0
  v_mov_b64 v[186:187], 0
  v_mov_b64 v[188:189], 0
  v_mov_b64 v[190:191], 0
  v_mov_b64 v[192:193], 0
  v_mov_b64 v[194:195], 0
  v_mov_b64 v[196:197], 0
  v_mov_b64 v[198:199], 0
  v_mov_b64 v[200:201], 0
  v_mov_b64 v[202:203], 0
  v_mov_b64 v[204:205], 0
  v_mov_b64 v[206:207], 0
  v_mov_b64 v[208:209], 0
  v_mov_b64 v[210:211], 0
  v_mov_b64 v[212:213], 0
  v_mov_b64 v[214:215], 0
  v_lshlrev_b32 v180, 4, v1
  s_lshl_b32 s52, s44, 13
  s_add_u32 s52, s52, 25600
  v_add_u32 v216, s52, v180
  s_lshl_b32 s52, s44, 11
  s_add_u32 s52, s52, 25600
  v_add_u32 v217, s52, v180
  v_lshlrev_b32 v180, 6, v2
  v_lshl_add_u32 v180, v3, 4, v180
  s_lshl_b32 s52, s44, 11
  s_add_u32 s52, s52, 9216
  v_add_u32 v218, s52, v180
  v_and_b32 v180, 1, v3
  v_lshlrev_b32 v180, 9, v180
  v_lshl_add_u32 v180, v2, 5, v180
  v_lshrrev_b32 v181, 1, v3
  v_lshl_add_u32 v180, v181, 4, v180
  s_lshl_b32 s53, s44, 10
  v_add_u32 v219, s53, v180
  v_lshrrev_b32 v180, 7, v0
  v_mul_u32_u24 v180, 4608, v180
  v_and_b32 v181, 127, v0
  v_lshl_add_u32 v180, v181, 2, v180
  v_mov_b32 v181, 0
  ds_write_b32 v180, v181 offset:0
  v_lshlrev_b32 v182, 4, v0
  v_lshlrev_b32 v183, 5, v0
  ds_read_b128 v[48:51], v176 offset:4032
  ds_read_b128 v[52:55], v176 offset:3520
  ds_read_b128 v[56:59], v176 offset:3008
  ds_read_b128 v[60:63], v176 offset:2496
  ds_read_b128 v[64:67], v176 offset:1984
  ds_read_b128 v[68:71], v176 offset:1472
  ds_read_b128 v[72:75], v176 offset:960
  ds_read_b128 v[76:79], v176 offset:448
  s_waitcnt vmcnt(0)
  v_cmp_gt_u32 vcc, 1, v253
  s_cbranch_vccz L_wa_23
  s_mov_b32 s57, 16384
  s_mov_b32 s74, 0
L_poll_24:
  buffer_load_dword v253, v252, s[16:19], s57 offen sc1
  s_waitcnt vmcnt(0)
  v_cmp_gt_u32 vcc, 1, v253
  s_cbranch_vccz L_pdone_25
  s_add_u32 s74, s74, 1
  s_cmp_lt_u32 s74, 1048576
  s_cbranch_scc1 L_poll_24
L_pdone_25:
L_wa_23:
  s_barrier
  s_mov_b32 s52, 131072
  s_mov_b32 s53, 139264
  buffer_load_dwordx4 v[112:115], v183, s[16:19], s52 offen sc1
  buffer_load_dwordx4 v[116:119], v183, s[16:19], s52 offen offset:16 sc1
  buffer_load_dwordx4 v[120:123], v183, s[16:19], s53 offen sc1
  buffer_load_dwordx4 v[124:127], v183, s[16:19], s53 offen offset:16 sc1
  s_lshl_b32 s54, s48, 12
  s_add_u32 s54, s54, 3145728
  s_add_u32 s55, s54, 131072
  buffer_load_dwordx4 v[220:223], v182, s[16:19], s54 offen sc1
  buffer_load_dwordx4 v[224:227], v182, s[16:19], s55 offen sc1
  s_mov_b32 s54, 0x3b000000
  s_mov_b32 s55, 0x3727c5ac
  s_waitcnt vmcnt(2)
  v_pk_mul_f32 v[112:113], v[112:113], s[54:55] op_sel_hi:[1,0]
  v_pk_mul_f32 v[120:121], v[120:121], s[54:55] op_sel_hi:[1,0]
  v_pk_mul_f32 v[114:115], v[114:115], s[54:55] op_sel_hi:[1,0]
  v_pk_mul_f32 v[122:123], v[122:123], s[54:55] op_sel_hi:[1,0]
  v_pk_mul_f32 v[116:117], v[116:117], s[54:55] op_sel_hi:[1,0]
  v_pk_mul_f32 v[124:125], v[124:125], s[54:55] op_sel_hi:[1,0]
  v_pk_mul_f32 v[118:119], v[118:119], s[54:55] op_sel_hi:[1,0]
  v_pk_mul_f32 v[126:127], v[126:127], s[54:55] op_sel_hi:[1,0]
  v_pk_fma_f32 v[120:121], v[112:113], v[112:113], v[120:121] neg_lo:[1,0,0] neg_hi:[1,0,0]
  v_pk_fma_f32 v[122:123], v[114:115], v[114:115], v[122:123] neg_lo:[1,0,0] neg_hi:[1,0,0]
  v_pk_fma_f32 v[124:125], v[116:117], v[116:117], v[124:125] neg_lo:[1,0,0] neg_hi:[1,0,0]
  v_pk_fma_f32 v[126:127], v[118:119], v[118:119], v[126:127] neg_lo:[1,0,0] neg_hi:[1,0,0]
  v_max_f32 v120, 0, v120
  v_max_f32 v121, 0, v121
  v_max_f32 v122, 0, v122
  v_max_f32 v123, 0, v123
  v_max_f32 v124, 0, v124
  v_max_f32 v125, 0, v125
  v_max_f32 v126, 0, v126
  v_max_f32 v127, 0, v127
  v_pk_add_f32 v[120:121], v[120:121], s[54:55] op_sel:[0,1] op_sel_hi:[1,1]
  v_pk_add_f32 v[122:123], v[122:123], s[54:55] op_sel:[0,1] op_sel_hi:[1,1]
  v_pk_add_f32 v[124:125], v[124:125], s[54:55] op_sel:[0,1] op_sel_hi:[1,1]
  v_pk_add_f32 v[126:127], v[126:127], s[54:55] op_sel:[0,1] op_sel_hi:[1,1]
  v_rsq_f32 v120, v120
  v_rsq_f32 v121, v121
  v_rsq_f32 v122, v122
  v_rsq_f32 v123, v123
  v_rsq_f32 v124, v124
  v_rsq_f32 v125, v125
  v_rsq_f32 v126, v126
  v_rsq_f32 v127, v127
  s_nop 0
  v_pk_mul_f32 v[112:113], v[112:113], v[120:121] neg_lo:[1,0] neg_hi:[1,0]
  v_pk_mul_f32 v[114:115], v[114:115], v[122:123] neg_lo:[1,0] neg_hi:[1,0]
  v_pk_mul_f32 v[116:117], v[116:117], v[124:125] neg_lo:[1,0] neg_hi:[1,0]
  v_pk_mul_f32 v[118:119], v[118:119], v[126:127] neg_lo:[1,0] neg_hi:[1,0]
  s_waitcnt vmcnt(0)
  v_lshlrev_b32 v128, 16, v220
  v_and_b32 v129, s70, v220
  v_lshlrev_b32 v130, 16, v221
  v_and_b32 v131, s70, v221
  v_lshlrev_b32 v132, 16, v222
  v_and_b32 v133, s70, v222
  v_lshlrev_b32 v134, 16, v223
  v_and_b32 v135, s70, v223
  v_pk_fma_f32 v[136:137], v[128:129], v[120:121], v[112:113]
  v_pk_fma_f32 v[138:139], v[130:131], v[122:123], v[114:115]
  v_pk_fma_f32 v[140:141], v[132:133], v[124:125], v[116:117]
  v_pk_fma_f32 v[142:143], v[134:135], v[126:127], v[118:119]
  v_cvt_pk_bf16_f32 v144, v136, v137
  v_cvt_pk_bf16_f32 v145, v138, v139
  v_cvt_pk_bf16_f32 v146, v140, v141
  v_cvt_pk_bf16_f32 v147, v142, v143
  ds_write_b128 v182, v[144:147] offset:512
  v_pk_fma_f32 v[232:233], v[136:137], s[80:81], v[128:129] op_sel:[0,0,0] op_sel_hi:[1,0,1]
  v_pk_fma_f32 v[234:235], v[138:139], s[80:81], v[130:131] op_sel:[0,0,0] op_sel_hi:[1,0,1]
  v_pk_fma_f32 v[236:237], v[140:141], s[80:81], v[132:133] op_sel:[0,0,0] op_sel_hi:[1,0,1]
  v_pk_fma_f32 v[238:239], v[142:143], s[80:81], v[134:135] op_sel:[0,0,0] op_sel_hi:[1,0,1]
  v_lshlrev_b32 v128, 16, v224
  v_and_b32 v129, s70, v224
  v_lshlrev_b32 v130, 16, v225
  v_and_b32 v131, s70, v225
  v_lshlrev_b32 v132, 16, v226
  v_and_b32 v133, s70, v226
  v_lshlrev_b32 v134, 16, v227
  v_and_b32 v135, s70, v227
  v_pk_fma_f32 v[136:137], v[128:129], v[120:121], v[112:113]
  v_pk_fma_f32 v[138:139], v[130:131], v[122:123], v[114:115]
  v_pk_fma_f32 v[140:141], v[132:133], v[124:125], v[116:117]
  v_pk_fma_f32 v[142:143], v[134:135], v[126:127], v[118:119]
  v_cvt_pk_bf16_f32 v144, v136, v137
  v_cvt_pk_bf16_f32 v145, v138, v139
  v_cvt_pk_bf16_f32 v146, v140, v141
  v_cvt_pk_bf16_f32 v147, v142, v143
  ds_write_b128 v182, v[144:147] offset:5120
  v_pk_fma_f32 v[224:225], v[136:137], s[80:81], v[128:129] op_sel:[0,1,0] op_sel_hi:[1,1,1]
  v_pk_fma_f32 v[226:227], v[138:139], s[80:81], v[130:131] op_sel:[0,1,0] op_sel_hi:[1,1,1]
  v_pk_fma_f32 v[228:229], v[140:141], s[80:81], v[132:133] op_sel:[0,1,0] op_sel_hi:[1,1,1]
  v_pk_fma_f32 v[230:231], v[142:143], s[80:81], v[134:135] op_sel:[0,1,0] op_sel_hi:[1,1,1]
  s_waitcnt lgkmcnt(0)
  s_barrier
  ds_read_b128 v[80:83], v177 offset:96
  ds_read_b128 v[84:87], v177 offset:608
  ds_read_b128 v[88:91], v177 offset:1120
  ds_read_b128 v[92:95], v177 offset:1632
  ds_read_b128 v[96:99], v177 offset:2144
  ds_read_b128 v[100:103], v177 offset:2656
  ds_read_b128 v[104:107], v177 offset:3168
  ds_read_b128 v[108:111], v177 offset:3680
  s_waitcnt lgkmcnt(7)
  v_mfma_f32_16x16x32_bf16 v[16:19], v[48:51], v[80:83], v[16:19]
  v_mfma_f32_16x16x32_bf16 v[20:23], v[52:55], v[80:83], v[20:23]
  v_mfma_f32_16x16x32_bf16 v[24:27], v[56:59], v[80:83], v[24:27]
  v_mfma_f32_16x16x32_bf16 v[28:31], v[60:63], v[80:83], v[28:31]
  v_mfma_f32_16x16x32_bf16 v[32:35], v[64:67], v[80:83], v[32:35]
  v_mfma_f32_16x16x32_bf16 v[36:39], v[68:71], v[80:83], v[36:39]
  v_mfma_f32_16x16x32_bf16 v[40:43], v[72:75], v[80:83], v[40:43]
  v_mfma_f32_16x16x32_bf16 v[44:47], v[76:79], v[80:83], v[44:47]
  s_waitcnt lgkmcnt(6)
  v_mfma_f32_16x16x32_bf16 v[20:23], v[48:51], v[84:87], v[20:23]
  ds_read_b128 v[112:115], v176 offset:3968
  v_mfma_f32_16x16x32_bf16 v[24:27], v[52:55], v[84:87], v[24:27]
  ds_read_b128 v[144:147], v177 offset:32
  v_mfma_f32_16x16x32_bf16 v[28:31], v[56:59], v[84:87], v[28:31]
  ds_read_b128 v[116:119], v176 offset:3456
  v_mfma_f32_16x16x32_bf16 v[32:35], v[60:63], v[84:87], v[32:35]
  ds_read_b128 v[148:151], v177 offset:544
  v_mfma_f32_16x16x32_bf16 v[36:39], v[64:67], v[84:87], v[36:39]
  ds_read_b128 v[120:123], v176 offset:2944
  v_mfma_f32_16x16x32_bf16 v[40:43], v[68:71], v[84:87], v[40:43]
  ds_read_b128 v[152:155], v177 offset:1056
  v_mfma_f32_16x16x32_bf16 v[44:47], v[72:75], v[84:87], v[44:47]
  ds_read_b128 v[124:127], v176 offset:2432
  s_waitcnt lgkmcnt(12)
  v_mfma_f32_16x16x32_bf16 v[24:27], v[48:51], v[88:91], v[24:27]
  ds_read_b128 v[156:159], v177 offset:1568
  v_mfma_f32_16x16x32_bf16 v[28:31], v[52:55], v[88:91], v[28:31]
  ds_write_b128 v183, v[232:235] offset:9216
  v_mfma_f32_16x16x32_bf16 v[32:35], v[56:59], v[88:91], v[32:35]
  ds_write_b128 v183, v[236:239] offset:9232
  v_mfma_f32_16x16x32_bf16 v[36:39], v[60:63], v[88:91], v[36:39]
  ds_write_b128 v183, v[224:227] offset:17408
  v_mfma_f32_16x16x32_bf16 v[40:43], v[64:67], v[88:91], v[40:43]
  ds_write_b128 v183, v[228:231] offset:17424
  v_mfma_f32_16x16x32_bf16 v[44:47], v[68:71], v[88:91], v[44:47]
  s_waitcnt lgkmcnt(15)
  v_mfma_f32_16x16x32_bf16 v[28:31], v[48:51], v[92:95], v[28:31]
  ds_read_b128 v[128:131], v176 offset:1920
  v_mfma_f32_16x16x32_bf16 v[32:35], v[52:55], v[92:95], v[32:35]
  ds_read_b128 v[160:163], v177 offset:2080
  v_mfma_f32_16x16x32_bf16 v[36:39], v[56:59], v[92:95], v[36:39]
  ds_read_b128 v[132:135], v176 offset:1408
  v_mfma_f32_16x16x32_bf16 v[40:43], v[60:63], v[92:95], v[40:43]
  ds_read_b128 v[164:167], v177 offset:2592
  v_mfma_f32_16x16x32_bf16 v[44:47], v[64:67], v[92:95], v[44:47]
  ds_read_b128 v[136:139], v176 offset:896
  v_mfma_f32_16x16x32_bf16 v[32:35], v[48:51], v[96:99], v[32:35]
  ds_read_b128 v[168:171], v177 offset:3104
  v_mfma_f32_16x16x32_bf16 v[36:39], v[52:55], v[96:99], v[36:39]
  ds_read_b128 v[140:143], v176 offset:384
  v_mfma_f32_16x16x32_bf16 v[40:43], v[56:59], v[96:99], v[40:43]
  ds_read_b128 v[172:175], v177 offset:3616
  v_mfma_f32_16x16x32_bf16 v[44:47], v[60:63], v[96:99], v[44:47]
  s_waitcnt lgkmcnt(15)
  v_mfma_f32_16x16x32_bf16 v[36:39], v[48:51], v[100:103], v[36:39]
  v_mfma_f32_16x16x32_bf16 v[40:43], v[52:55], v[100:103], v[40:43]
  v_mfma_f32_16x16x32_bf16 v[44:47], v[56:59], v[100:103], v[44:47]
  v_mfma_f32_16x16x32_bf16 v[40:43], v[48:51], v[104:107], v[40:43]
  v_mfma_f32_16x16x32_bf16 v[44:47], v[52:55], v[104:107], v[44:47]
  v_mfma_f32_16x16x32_bf16 v[44:47], v[48:51], v[108:111], v[44:47]
  s_waitcnt lgkmcnt(0)
  v_mfma_f32_16x16x32_bf16 v[16:19], v[112:115], v[144:147], v[16:19]
  ds_read_b128 v[48:51], v178 offset:4032
  v_mfma_f32_16x16x32_bf16 v[20:23], v[116:119], v[144:147], v[20:23]
  ds_read_b128 v[80:83], v179 offset:96
  v_mfma_f32_16x16x32_bf16 v[24:27], v[120:123], v[144:147], v[24:27]
  ds_read_b128 v[52:55], v178 offset:3520
  v_mfma_f32_16x16x32_bf16 v[28:31], v[124:127], v[144:147], v[28:31]
  ds_read_b128 v[84:87], v179 offset:608
  v_mfma_f32_16x16x32_bf16 v[32:35], v[128:131], v[144:147], v[32:35]
  ds_read_b128 v[56:59], v178 offset:3008
  v_mfma_f32_16x16x32_bf16 v[36:39], v[132:135], v[144:147], v[36:39]
  ds_read_b128 v[88:91], v179 offset:1120
  v_mfma_f32_16x16x32_bf16 v[40:43], v[136:139], v[144:147], v[40:43]
  ds_read_b128 v[60:63], v178 offset:2496
  v_mfma_f32_16x16x32_bf16 v[44:47], v[140:143], v[144:147], v[44:47]
  ds_read_b128 v[92:95], v179 offset:1632
  v_mfma_f32_16x16x32_bf16 v[20:23], v[112:115], v[148:151], v[20:23]
  ds_read_b128 v[64:67], v178 offset:1984
  v_mfma_f32_16x16x32_bf16 v[24:27], v[116:119], v[148:151], v[24:27]
  ds_read_b128 v[96:99], v179 offset:2144
  v_mfma_f32_16x16x32_bf16 v[28:31], v[120:123], v[148:151], v[28:31]
  ds_read_b128 v[68:71], v178 offset:1472
  v_mfma_f32_16x16x32_bf16 v[32:35], v[124:127], v[148:151], v[32:35]
  ds_read_b128 v[100:103], v179 offset:2656
  v_mfma_f32_16x16x32_bf16 v[36:39], v[128:131], v[148:151], v[36:39]
  ds_read_b128 v[72:75], v178 offset:960
  v_mfma_f32_16x16x32_bf16 v[40:43], v[132:135], v[148:151], v[40:43]
  ds_read_b128 v[104:107], v179 offset:3168
  v_mfma_f32_16x16x32_bf16 v[44:47], v[136:139], v[148:151], v[44:47]
  ds_read_b128 v[76:79], v178 offset:448
  v_mfma_f32_16x16x32_bf16 v[24:27], v[112:115], v[152:155], v[24:27]
  ds_read_b128 v[108:111], v179 offset:3680
  v_mfma_f32_16x16x32_bf16 v[28:31], v[116:119], v[152:155], v[28:31]
  v_mfma_f32_16x16x32_bf16 v[32:35], v[120:123], v[152:155], v[32:35]
  v_mfma_f32_16x16x32_bf16 v[36:39], v[124:127], v[152:155], v[36:39]
  v_mfma_f32_16x16x32_bf16 v[40:43], v[128:131], v[152:155], v[40:43]
  v_mfma_f32_16x16x32_bf16 v[44:47], v[132:135], v[152:155], v[44:47]
  v_mfma_f32_16x16x32_bf16 v[28:31], v[112:115], v[156:159], v[28:31]
  v_mfma_f32_16x16x32_bf16 v[32:35], v[116:119], v[156:159], v[32:35]
  v_mfma_f32_16x16x32_bf16 v[36:39], v[120:123], v[156:159], v[36:39]
  v_mfma_f32_16x16x32_bf16 v[40:43], v[124:127], v[156:159], v[40:43]
  v_mfma_f32_16x16x32_bf16 v[44:47], v[128:131], v[156:159], v[44:47]
  v_mfma_f32_16x16x32_bf16 v[32:35], v[112:115], v[160:163], v[32:35]
  v_mfma_f32_16x16x32_bf16 v[36:39], v[116:119], v[160:163], v[36:39]
  v_mfma_f32_16x16x32_bf16 v[40:43], v[120:123], v[160:163], v[40:43]
  v_mfma_f32_16x16x32_bf16 v[44:47], v[124:127], v[160:163], v[44:47]
  v_mfma_f32_16x16x32_bf16 v[36:39], v[112:115], v[164:167], v[36:39]
  v_mfma_f32_16x16x32_bf16 v[40:43], v[116:119], v[164:167], v[40:43]
  v_mfma_f32_16x16x32_bf16 v[44:47], v[120:123], v[164:167], v[44:47]
  v_mfma_f32_16x16x32_bf16 v[40:43], v[112:115], v[168:171], v[40:43]
  v_mfma_f32_16x16x32_bf16 v[44:47], v[116:119], v[168:171], v[44:47]
  v_mfma_f32_16x16x32_bf16 v[44:47], v[112:115], v[172:175], v[44:47]
  s_nop 3
  ds_write_b128 v216, v[16:19] offset:0
  ds_write_b128 v216, v[20:23] offset:1024
  ds_write_b128 v216, v[24:27] offset:2048
  ds_write_b128 v216, v[28:31] offset:3072
  ds_write_b128 v216, v[32:35] offset:4096
  ds_write_b128 v216, v[36:39] offset:5120
  ds_write_b128 v216, v[40:43] offset:6144
  ds_write_b128 v216, v[44:47] offset:7168
  ds_read_b128 v[220:223], v218 offset:0
  ds_read_b128 v[224:227], v218 offset:1024
  s_waitcnt lgkmcnt(0)
  s_barrier
  ds_read_b128 v[16:19], v217 offset:0
  ds_read_b128 v[20:23], v217 offset:1024
  ds_read_b128 v[24:27], v217 offset:8192
  ds_read_b128 v[28:31], v217 offset:9216
  ds_read_b128 v[32:35], v217 offset:16384
  ds_read_b128 v[36:39], v217 offset:17408
  ds_read_b128 v[40:43], v217 offset:24576
  ds_read_b128 v[44:47], v217 offset:25600
  s_waitcnt lgkmcnt(6)
  v_pk_add_f32 v[220:221], v[220:221], v[16:17]
  v_pk_add_f32 v[222:223], v[222:223], v[18:19]
  v_pk_add_f32 v[224:225], v[224:225], v[20:21]
  v_pk_add_f32 v[226:227], v[226:227], v[22:23]
  s_waitcnt lgkmcnt(4)
  v_pk_add_f32 v[220:221], v[220:221], v[24:25]
  v_pk_add_f32 v[222:223], v[222:223], v[26:27]
  v_pk_add_f32 v[224:225], v[224:225], v[28:29]
  v_pk_add_f32 v[226:227], v[226:227], v[30:31]
  s_waitcnt lgkmcnt(2)
  v_pk_add_f32 v[220:221], v[220:221], v[32:33]
  v_pk_add_f32 v[222:223], v[222:223], v[34:35]
  v_pk_add_f32 v[224:225], v[224:225], v[36:37]
  v_pk_add_f32 v[226:227], v[226:227], v[38:39]
  s_waitcnt lgkmcnt(0)
  v_pk_add_f32 v[220:221], v[220:221], v[40:41]
  v_pk_add_f32 v[222:223], v[222:223], v[42:43]
  v_pk_add_f32 v[224:225], v[224:225], v[44:45]
  v_pk_add_f32 v[226:227], v[226:227], v[46:47]
  v_cvt_pk_bf16_f32 v228, v220, v221
  v_cvt_pk_bf16_f32 v229, v222, v223
  v_cvt_pk_bf16_f32 v230, v224, v225
  v_cvt_pk_bf16_f32 v231, v226, v227
  s_add_u32 s54, s48, 0
  s_lshl_b32 s54, s54, 12
  s_add_u32 s54, s54, 5242880
  v_permlane16_swap_b32 v228, v230
  v_permlane16_swap_b32 v229, v231
  buffer_store_dwordx4 v[228:231], v219, s[16:19], s54 offen sc1
  s_waitcnt lgkmcnt(0)
  v_mfma_f32_16x16x32_bf16 v[184:187], v[48:51], v[80:83], v[184:187]
  ds_read_b128 v[112:115], v178 offset:3968
  v_mfma_f32_16x16x32_bf16 v[188:191], v[52:55], v[80:83], v[188:191]
  ds_read_b128 v[144:147], v179 offset:32
  v_mfma_f32_16x16x32_bf16 v[192:195], v[56:59], v[80:83], v[192:195]
  ds_read_b128 v[116:119], v178 offset:3456
  v_mfma_f32_16x16x32_bf16 v[196:199], v[60:63], v[80:83], v[196:199]
  ds_read_b128 v[148:151], v179 offset:544
  v_mfma_f32_16x16x32_bf16 v[200:203], v[64:67], v[80:83], v[200:203]
  ds_read_b128 v[120:123], v178 offset:2944
  v_mfma_f32_16x16x32_bf16 v[204:207], v[68:71], v[80:83], v[204:207]
  ds_read_b128 v[152:155], v179 offset:1056
  v_mfma_f32_16x16x32_bf16 v[208:211], v[72:75], v[80:83], v[208:211]
  ds_read_b128 v[124:127], v178 offset:2432
  v_mfma_f32_16x16x32_bf16 v[212:215], v[76:79], v[80:83], v[212:215]
  ds_read_b128 v[156:159], v179 offset:1568
  v_mfma_f32_16x16x32_bf16 v[188:191], v[48:51], v[84:87], v[188:191]
  ds_read_b128 v[128:131], v178 offset:1920
  v_mfma_f32_16x16x32_bf16 v[192:195], v[52:55], v[84:87], v[192:195]
  ds_read_b128 v[160:163], v179 offset:2080
  v_mfma_f32_16x16x32_bf16 v[196:199], v[56:59], v[84:87], v[196:199]
  ds_read_b128 v[132:135], v178 offset:1408
  v_mfma_f32_16x16x32_bf16 v[200:203], v[60:63], v[84:87], v[200:203]
  ds_read_b128 v[164:167], v179 offset:2592
  v_mfma_f32_16x16x32_bf16 v[204:207], v[64:67], v[84:87], v[204:207]
  ds_read_b128 v[136:139], v178 offset:896
  v_mfma_f32_16x16x32_bf16 v[208:211], v[68:71], v[84:87], v[208:211]
  ds_read_b128 v[168:171], v179 offset:3104
  v_mfma_f32_16x16x32_bf16 v[212:215], v[72:75], v[84:87], v[212:215]
  ds_read_b128 v[140:143], v178 offset:384
  v_mfma_f32_16x16x32_bf16 v[192:195], v[48:51], v[88:91], v[192:195]
  ds_read_b128 v[172:175], v179 offset:3616
  v_mfma_f32_16x16x32_bf16 v[196:199], v[52:55], v[88:91], v[196:199]
  v_mfma_f32_16x16x32_bf16 v[200:203], v[56:59], v[88:91], v[200:203]
  v_mfma_f32_16x16x32_bf16 v[204:207], v[60:63], v[88:91], v[204:207]
  v_mfma_f32_16x16x32_bf16 v[208:211], v[64:67], v[88:91], v[208:211]
  v_mfma_f32_16x16x32_bf16 v[212:215], v[68:71], v[88:91], v[212:215]
  v_mfma_f32_16x16x32_bf16 v[196:199], v[48:51], v[92:95], v[196:199]
  v_mfma_f32_16x16x32_bf16 v[200:203], v[52:55], v[92:95], v[200:203]
  v_mfma_f32_16x16x32_bf16 v[204:207], v[56:59], v[92:95], v[204:207]
  v_mfma_f32_16x16x32_bf16 v[208:211], v[60:63], v[92:95], v[208:211]
  v_mfma_f32_16x16x32_bf16 v[212:215], v[64:67], v[92:95], v[212:215]
  v_mfma_f32_16x16x32_bf16 v[200:203], v[48:51], v[96:99], v[200:203]
  v_mfma_f32_16x16x32_bf16 v[204:207], v[52:55], v[96:99], v[204:207]
  v_mfma_f32_16x16x32_bf16 v[208:211], v[56:59], v[96:99], v[208:211]
  v_mfma_f32_16x16x32_bf16 v[212:215], v[60:63], v[96:99], v[212:215]
  v_mfma_f32_16x16x32_bf16 v[204:207], v[48:51], v[100:103], v[204:207]
  v_mfma_f32_16x16x32_bf16 v[208:211], v[52:55], v[100:103], v[208:211]
  v_mfma_f32_16x16x32_bf16 v[212:215], v[56:59], v[100:103], v[212:215]
  v_mfma_f32_16x16x32_bf16 v[208:211], v[48:51], v[104:107], v[208:211]
  v_mfma_f32_16x16x32_bf16 v[212:215], v[52:55], v[104:107], v[212:215]
  v_mfma_f32_16x16x32_bf16 v[212:215], v[48:51], v[108:111], v[212:215]
  s_waitcnt lgkmcnt(0)
  v_mfma_f32_16x16x32_bf16 v[184:187], v[112:115], v[144:147], v[184:187]
  v_mfma_f32_16x16x32_bf16 v[188:191], v[116:119], v[144:147], v[188:191]
  v_mfma_f32_16x16x32_bf16 v[192:195], v[120:123], v[144:147], v[192:195]
  v_mfma_f32_16x16x32_bf16 v[196:199], v[124:127], v[144:147], v[196:199]
  v_mfma_f32_16x16x32_bf16 v[200:203], v[128:131], v[144:147], v[200:203]
  v_mfma_f32_16x16x32_bf16 v[204:207], v[132:135], v[144:147], v[204:207]
  v_mfma_f32_16x16x32_bf16 v[208:211], v[136:139], v[144:147], v[208:211]
  v_mfma_f32_16x16x32_bf16 v[212:215], v[140:143], v[144:147], v[212:215]
  v_mfma_f32_16x16x32_bf16 v[188:191], v[112:115], v[148:151], v[188:191]
  v_mfma_f32_16x16x32_bf16 v[192:195], v[116:119], v[148:151], v[192:195]
  v_mfma_f32_16x16x32_bf16 v[196:199], v[120:123], v[148:151], v[196:199]
  v_mfma_f32_16x16x32_bf16 v[200:203], v[124:127], v[148:151], v[200:203]
  v_mfma_f32_16x16x32_bf16 v[204:207], v[128:131], v[148:151], v[204:207]
  v_mfma_f32_16x16x32_bf16 v[208:211], v[132:135], v[148:151], v[208:211]
  v_mfma_f32_16x16x32_bf16 v[212:215], v[136:139], v[148:151], v[212:215]
  v_mfma_f32_16x16x32_bf16 v[192:195], v[112:115], v[152:155], v[192:195]
  v_mfma_f32_16x16x32_bf16 v[196:199], v[116:119], v[152:155], v[196:199]
  v_mfma_f32_16x16x32_bf16 v[200:203], v[120:123], v[152:155], v[200:203]
  v_mfma_f32_16x16x32_bf16 v[204:207], v[124:127], v[152:155], v[204:207]
  v_mfma_f32_16x16x32_bf16 v[208:211], v[128:131], v[152:155], v[208:211]
  v_mfma_f32_16x16x32_bf16 v[212:215], v[132:135], v[152:155], v[212:215]
  v_mfma_f32_16x16x32_bf16 v[196:199], v[112:115], v[156:159], v[196:199]
  v_mfma_f32_16x16x32_bf16 v[200:203], v[116:119], v[156:159], v[200:203]
  v_mfma_f32_16x16x32_bf16 v[204:207], v[120:123], v[156:159], v[204:207]
  v_mfma_f32_16x16x32_bf16 v[208:211], v[124:127], v[156:159], v[208:211]
  v_mfma_f32_16x16x32_bf16 v[212:215], v[128:131], v[156:159], v[212:215]
  v_mfma_f32_16x16x32_bf16 v[200:203], v[112:115], v[160:163], v[200:203]
  v_mfma_f32_16x16x32_bf16 v[204:207], v[116:119], v[160:163], v[204:207]
  v_mfma_f32_16x16x32_bf16 v[208:211], v[120:123], v[160:163], v[208:211]
  v_mfma_f32_16x16x32_bf16 v[212:215], v[124:127], v[160:163], v[212:215]
  v_mfma_f32_16x16x32_bf16 v[204:207], v[112:115], v[164:167], v[204:207]
  v_mfma_f32_16x16x32_bf16 v[208:211], v[116:119], v[164:167], v[208:211]
  v_mfma_f32_16x16x32_bf16 v[212:215], v[120:123], v[164:167], v[212:215]
  v_mfma_f32_16x16x32_bf16 v[208:211], v[112:115], v[168:171], v[208:211]
  v_mfma_f32_16x16x32_bf16 v[212:215], v[116:119], v[168:171], v[212:215]
  v_mfma_f32_16x16x32_bf16 v[212:215], v[112:115], v[172:175], v[212:215]
  s_waitcnt vmcnt(0)
  s_barrier
  s_cmp_lg_u32 s44, 0
  s_cbranch_scc1 L_fs_26
  s_mov_b64 exec, 1
  s_lshl_b32 s57, s2, 6
  s_add_u32 s57, s57, 32768
  v_mov_b32 v252, 0
  v_mov_b32 v253, 1
  buffer_store_dword v253, v252, s[16:19], s57 offen sc1
  s_mov_b64 exec, -1
L_fs_26:
  ds_write_b128 v216, v[184:187] offset:0
  ds_write_b128 v216, v[188:191] offset:1024
  ds_write_b128 v216, v[192:195] offset:2048
  ds_write_b128 v216, v[196:199] offset:3072
  ds_write_b128 v216, v[200:203] offset:4096
  ds_write_b128 v216, v[204:207] offset:5120
  ds_write_b128 v216, v[208:211] offset:6144
  ds_write_b128 v216, v[212:215] offset:7168
  ds_read_b128 v[220:223], v218 offset:8192
  ds_read_b128 v[224:227], v218 offset:9216
  s_waitcnt lgkmcnt(0)
  s_barrier
  ds_read_b128 v[184:187], v217 offset:0
  ds_read_b128 v[188:191], v217 offset:1024
  ds_read_b128 v[192:195], v217 offset:8192
  ds_read_b128 v[196:199], v217 offset:9216
  ds_read_b128 v[200:203], v217 offset:16384
  ds_read_b128 v[204:207], v217 offset:17408
  ds_read_b128 v[208:211], v217 offset:24576
  ds_read_b128 v[212:215], v217 offset:25600
  s_waitcnt lgkmcnt(6)
  v_pk_add_f32 v[220:221], v[220:221], v[184:185]
  v_pk_add_f32 v[222:223], v[222:223], v[186:187]
  v_pk_add_f32 v[224:225], v[224:225], v[188:189]
  v_pk_add_f32 v[226:227], v[226:227], v[190:191]
  s_waitcnt lgkmcnt(4)
  v_pk_add_f32 v[220:221], v[220:221], v[192:193]
  v_pk_add_f32 v[222:223], v[222:223], v[194:195]
  v_pk_add_f32 v[224:225], v[224:225], v[196:197]
  v_pk_add_f32 v[226:227], v[226:227], v[198:199]
  s_waitcnt lgkmcnt(2)
  v_pk_add_f32 v[220:221], v[220:221], v[200:201]
  v_pk_add_f32 v[222:223], v[222:223], v[202:203]
  v_pk_add_f32 v[224:225], v[224:225], v[204:205]
  v_pk_add_f32 v[226:227], v[226:227], v[206:207]
  s_waitcnt lgkmcnt(0)
  v_pk_add_f32 v[220:221], v[220:221], v[208:209]
  v_pk_add_f32 v[222:223], v[222:223], v[210:211]
  v_pk_add_f32 v[224:225], v[224:225], v[212:213]
  v_pk_add_f32 v[226:227], v[226:227], v[214:215]
  v_cvt_pk_bf16_f32 v228, v220, v221
  v_cvt_pk_bf16_f32 v229, v222, v223
  v_cvt_pk_bf16_f32 v230, v224, v225
  v_cvt_pk_bf16_f32 v231, v226, v227
  s_add_u32 s54, s48, 32
  s_lshl_b32 s54, s54, 12
  s_add_u32 s54, s54, 5242880
  v_permlane16_swap_b32 v228, v230
  v_permlane16_swap_b32 v229, v231
  buffer_store_dwordx4 v[228:231], v219, s[16:19], s54 offen sc1
  s_lshl_b32 s50, s49, 1
  s_sub_u32 s50, s50, 32
  v_add_u32 v180, 0, v1
  v_mul_u32_u24 v181, 6554, v180
  v_lshrrev_b32 v181, 16, v181
  v_mul_u32_u24 v182, 10, v181
  v_sub_u32 v182, v180, v182
  v_lshlrev_b32 v182, 4, v182
  v_add_u32 v182, s50, v182
  v_max_i32 v182, 0, v182
  s_and_b32 s51, s44, 1
  s_lshl_b32 s51, s51, 4
  v_add_u32 v181, s51, v181
  v_and_b32 v183, 0x13, v181
  v_and_b32 v184, 4, v181
  v_lshl_add_u32 v183, v184, 1, v183
  v_and_b32 v184, 8, v181
  v_lshrrev_b32 v184, 1, v184
  v_add_u32 v183, v183, v184
  v_lshl_add_u32 v175, v183, 12, v182
  v_add_u32 v180, 64, v1
  v_mul_u32_u24 v181, 6554, v180
  v_lshrrev_b32 v181, 16, v181
  v_mul_u32_u24 v182, 10, v181
  v_sub_u32 v182, v180, v182
  v_lshlrev_b32 v182, 4, v182
  v_add_u32 v182, s50, v182
  v_max_i32 v182, 0, v182
  s_and_b32 s51, s44, 1
  s_lshl_b32 s51, s51, 4
  v_add_u32 v181, s51, v181
  v_and_b32 v183, 0x13, v181
  v_and_b32 v184, 4, v181
  v_lshl_add_u32 v183, v184, 1, v183
  v_and_b32 v184, 8, v181
  v_lshrrev_b32 v184, 1, v184
  v_add_u32 v183, v183, v184
  v_lshl_add_u32 v176, v183, 12, v182
  v_add_u32 v180, 128, v1
  v_mul_u32_u24 v181, 6554, v180
  v_lshrrev_b32 v181, 16, v181
  v_mul_u32_u24 v182, 10, v181
  v_sub_u32 v182, v180, v182
  v_lshlrev_b32 v182, 4, v182
  v_add_u32 v182, s50, v182
  v_max_i32 v182, 0, v182
  s_and_b32 s51, s44, 1
  s_lshl_b32 s51, s51, 4
  v_add_u32 v181, s51, v181
  v_and_b32 v183, 0x13, v181
  v_and_b32 v184, 4, v181
  v_lshl_add_u32 v183, v184, 1, v183
  v_and_b32 v184, 8, v181
  v_lshrrev_b32 v184, 1, v184
  v_add_u32 v183, v183, v184
  v_lshl_add_u32 v177, v183, 12, v182
  s_mul_i32 s71, s44, 2560
  s_lshr_b32 s72, s44, 1
  s_add_u32 s72, s72, s47
  v_lshrrev_b32 v180, 1, v3
  v_lshlrev_b32 v180, 4, v180
  v_and_b32 v181, 1, v3
  v_lshl_add_u32 v180, v181, 2, v180
  v_lshrrev_b32 v181, 2, v2
  v_add_u32 v180, v180, v181
  v_mul_u32_u24 v180, 160, v180
  v_and_b32 v181, 3, v2
  v_lshl_add_u32 v168, v181, 3, v180
  v_add_u32 v169, 40960, v168
  v_mov_b64 v[16:17], 0
  v_mov_b64 v[18:19], 0
  v_mov_b64 v[20:21], 0
  v_mov_b64 v[22:23], 0
  v_mov_b64 v[24:25], 0
  v_mov_b64 v[26:27], 0
  v_mov_b64 v[28:29], 0
  v_mov_b64 v[30:31], 0
  v_mov_b64 v[32:33], 0
  v_mov_b64 v[34:35], 0
  v_mov_b64 v[36:37], 0
  v_mov_b64 v[38:39], 0
  v_mov_b64 v[40:41], 0
  v_mov_b64 v[42:43], 0
  v_mov_b64 v[44:45], 0
  v_mov_b64 v[46:47], 0
  v_mov_b64 v[48:49], 0
  v_mov_b64 v[50:51], 0
  v_mov_b64 v[52:53], 0
  v_mov_b64 v[54:55], 0
  v_mov_b64 v[56:57], 0
  v_mov_b64 v[58:59], 0
  v_mov_b64 v[60:61], 0
  v_mov_b64 v[62:63], 0
  v_mov_b64 v[64:65], 0
  v_mov_b64 v[66:67], 0
  v_mov_b64 v[68:69], 0
  v_mov_b64 v[70:71], 0
  v_mov_b64 v[72:73], 0
  v_mov_b64 v[74:75], 0
  v_mov_b64 v[76:77], 0
  v_mov_b64 v[78:79], 0
  v_mov_b64 v[80:81], 0
  v_mov_b64 v[82:83], 0
  v_mov_b64 v[84:85], 0
  v_mov_b64 v[86:87], 0
  v_mov_b64 v[88:89], 0
  v_mov_b64 v[90:91], 0
  v_mov_b64 v[92:93], 0
  v_mov_b64 v[94:95], 0
  v_mov_b64 v[96:97], 0
  v_mov_b64 v[98:99], 0
  v_mov_b64 v[100:101], 0
  v_mov_b64 v[102:103], 0
  v_mov_b64 v[104:105], 0
  v_mov_b64 v[106:107], 0
  v_mov_b64 v[108:109], 0
  v_mov_b64 v[110:111], 0
  s_lshr_b32 s50, s44, 1
  s_mul_i32 s50, s50, 10240
  s_and_b32 s51, s44, 1
  s_mul_i32 s51, s51, 5120
  s_add_u32 s50, s50, s51
  v_add_u32 v170, s50, v168
  v_add_u32 v171, 40960, v170
  v_lshlrev_b32 v178, 5, v2
  s_lshl_b32 s50, s44, 3
  s_add_u32 s50, s50, 155648
  v_add_u32 v178, s50, v178
  v_lshlrev_b32 v180, 5, v1
  v_add_u32 v180, 155648, v180
  v_lshlrev_b32 v181, 5, v2
  v_add_u32 v181, 157696, v181
  s_mul_i32 s50, s44, 640
  s_add_u32 s50, s50, 158208
  v_lshl_add_u32 v182, v1, 2, s50
  v_lshlrev_b32 v183, 2, v2
  v_add_u32 v183, s50, v183
  v_lshl_add_u32 v179, v3, 4, s50
  s_waitcnt vmcnt(0) lgkmcnt(0)
  s_barrier
  s_cmp_lg_u32 s44, 0
  s_cbranch_scc1 L_fs_27
  s_mov_b64 exec, 1
  s_lshl_b32 s50, s2, 6
  s_add_u32 s50, s50, 114688
  v_mov_b32 v252, 0
  v_mov_b32 v253, 1
  buffer_store_dword v253, v252, s[16:19], s50 offen sc1
  s_mov_b64 exec, -1
L_fs_27:
  v_lshlrev_b32 v252, 6, v0
  s_mov_b32 s50, 32768
  s_mov_b32 s74, 0
L_poll_28:
  buffer_load_dword v253, v252, s[16:19], s50 offen sc1
  s_waitcnt vmcnt(0)
  v_cmp_gt_u32 vcc, 1, v253
  s_cbranch_vccz L_pdone_29
  s_add_u32 s74, s74, 1
  s_cmp_lt_u32 s74, 1048576
  s_cbranch_scc1 L_poll_28
L_pdone_29:
  s_barrier
  s_add_u32 s75, s72, 0
  s_and_b32 s75, s75, 7
  s_lshl_b32 s76, s75, 18
  s_add_u32 s76, s76, 5242880
  s_add_u32 m0, s71, 0
  s_nop 0
  buffer_load_dwordx4 v175, s[16:19], s76 offen sc1 lds
  s_add_u32 m0, s71, 1024
  s_nop 0
  buffer_load_dwordx4 v176, s[16:19], s76 offen sc1 lds
  s_add_u32 m0, s71, 2048
  s_mov_b32 exec_hi, 0
  buffer_load_dwordx4 v177, s[16:19], s76 offen sc1 lds
  s_mov_b32 exec_hi, -1
  s_add_u32 s75, s72, 2
  s_and_b32 s75, s75, 7
  s_lshl_b32 s76, s75, 18
  s_add_u32 s76, s76, 5242880
  s_add_u32 m0, s71, 10240
  s_nop 0
  buffer_load_dwordx4 v175, s[16:19], s76 offen sc1 lds
  s_add_u32 m0, s71, 11264
  s_nop 0
  buffer_load_dwordx4 v176, s[16:19], s76 offen sc1 lds
  s_add_u32 m0, s71, 12288
  s_mov_b32 exec_hi, 0
  buffer_load_dwordx4 v177, s[16:19], s76 offen sc1 lds
  s_mov_b32 exec_hi, -1
  s_add_u32 s75, s72, 4
  s_and_b32 s75, s75, 7
  s_lshl_b32 s76, s75, 18
  s_add_u32 s76, s76, 5242880
  s_add_u32 m0, s71, 20480
  s_nop 0
  buffer_load_dwordx4 v175, s[16:19], s76 offen sc1 lds
  s_add_u32 m0, s71, 21504
  s_nop 0
  buffer_load_dwordx4 v176, s[16:19], s76 offen sc1 lds
  s_add_u32 m0, s71, 22528
  s_mov_b32 exec_hi, 0
  buffer_load_dwordx4 v177, s[16:19], s76 offen sc1 lds
  s_mov_b32 exec_hi, -1
  s_waitcnt vmcnt(6)
  s_barrier
  ds_read_b64_tr_b16 v[128:129], v168 offset:0
  ds_read_b64_tr_b16 v[130:131], v168 offset:1280
  ds_read_b64_tr_b16 v[132:133], v168 offset:32
  ds_read_b64_tr_b16 v[134:135], v168 offset:1312
  ds_read_b64_tr_b16 v[136:137], v168 offset:64
  ds_read_b64_tr_b16 v[138:139], v168 offset:1344
  ds_read_b64_tr_b16 v[140:141], v168 offset:96
  ds_read_b64_tr_b16 v[142:143], v168 offset:1376
  ds_read_b64_tr_b16 v[144:145], v168 offset:128
  ds_read_b64_tr_b16 v[146:147], v168 offset:1408
  s_waitcnt lgkmcnt(8)
  v_mfma_f32_16x16x32_bf16 v[32:35], a[4:7], v[128:131], v[32:35]
  ds_read_b64_tr_b16 v[148:149], v168 offset:5120
  v_mfma_f32_16x16x32_bf16 v[52:55], v[128:131], a[8:11], v[52:55]
  ds_read_b64_tr_b16 v[150:151], v168 offset:6400
  s_waitcnt lgkmcnt(8)
  v_mfma_f32_16x16x32_bf16 v[36:39], a[4:7], v[132:135], v[36:39]
  ds_read_b64_tr_b16 v[152:153], v168 offset:5152
  v_mfma_f32_16x16x32_bf16 v[56:59], v[132:135], a[8:11], v[56:59]
  ds_read_b64_tr_b16 v[154:155], v168 offset:6432
  v_mfma_f32_16x16x32_bf16 v[16:19], a[0:3], v[132:135], v[16:19]
  s_add_u32 s75, s72, 6
  s_and_b32 s75, s75, 7
  s_lshl_b32 s76, s75, 18
  s_add_u32 s76, s76, 5242880
  s_add_u32 m0, s71, 30720
  s_nop 0
  buffer_load_dwordx4 v175, s[16:19], s76 offen sc1 lds
  s_waitcnt lgkmcnt(8)
  v_mfma_f32_16x16x32_bf16 v[40:43], a[4:7], v[136:139], v[40:43]
  ds_read_b64_tr_b16 v[156:157], v168 offset:5184
  v_mfma_f32_16x16x32_bf16 v[60:63], v[136:139], a[8:11], v[60:63]
  ds_read_b64_tr_b16 v[158:159], v168 offset:6464
  v_mfma_f32_16x16x32_bf16 v[20:23], a[0:3], v[136:139], v[20:23]
  s_add_u32 m0, s71, 31744
  s_nop 0
  buffer_load_dwordx4 v176, s[16:19], s76 offen sc1 lds
  s_waitcnt lgkmcnt(8)
  v_mfma_f32_16x16x32_bf16 v[44:47], a[4:7], v[140:143], v[44:47]
  ds_read_b64_tr_b16 v[160:161], v168 offset:5216
  v_mfma_f32_16x16x32_bf16 v[64:67], v[140:143], a[8:11], v[64:67]
  ds_read_b64_tr_b16 v[162:163], v168 offset:6496
  v_mfma_f32_16x16x32_bf16 v[24:27], a[0:3], v[140:143], v[24:27]
  s_add_u32 m0, s71, 32768
  s_mov_b32 exec_hi, 0
  buffer_load_dwordx4 v177, s[16:19], s76 offen sc1 lds
  s_mov_b32 exec_hi, -1
  s_waitcnt lgkmcnt(8)
  v_mfma_f32_16x16x32_bf16 v[48:51], a[4:7], v[144:147], v[48:51]
  ds_read_b64_tr_b16 v[164:165], v168 offset:5248
  v_mfma_f32_16x16x32_bf16 v[68:71], v[144:147], a[8:11], v[68:71]
  ds_read_b64_tr_b16 v[166:167], v168 offset:6528
  v_mfma_f32_16x16x32_bf16 v[28:31], a[0:3], v[144:147], v[28:31]
  s_waitcnt vmcnt(6)
  s_barrier
  s_waitcnt lgkmcnt(8)
  v_mfma_f32_16x16x32_bf16 v[32:35], a[28:31], v[148:151], v[32:35]
  ds_read_b64_tr_b16 v[128:129], v168 offset:10240
  v_mfma_f32_16x16x32_bf16 v[52:55], v[148:151], a[32:35], v[52:55]
  ds_read_b64_tr_b16 v[130:131], v168 offset:11520
  s_waitcnt lgkmcnt(8)
  v_mfma_f32_16x16x32_bf16 v[36:39], a[28:31], v[152:155], v[36:39]
  ds_read_b64_tr_b16 v[132:133], v168 offset:10272
  v_mfma_f32_16x16x32_bf16 v[56:59], v[152:155], a[32:35], v[56:59]
  ds_read_b64_tr_b16 v[134:135], v168 offset:11552
  v_mfma_f32_16x16x32_bf16 v[16:19], a[24:27], v[152:155], v[16:19]
  s_waitcnt lgkmcnt(8)
  v_mfma_f32_16x16x32_bf16 v[40:43], a[28:31], v[156:159], v[40:43]
  ds_read_b64_tr_b16 v[136:137], v168 offset:10304
  v_mfma_f32_16x16x32_bf16 v[60:63], v[156:159], a[32:35], v[60:63]
  ds_read_b64_tr_b16 v[138:139], v168 offset:11584
  v_mfma_f32_16x16x32_bf16 v[20:23], a[24:27], v[156:159], v[20:23]
  s_waitcnt lgkmcnt(8)
  v_mfma_f32_16x16x32_bf16 v[44:47], a[28:31], v[160:163], v[44:47]
  ds_read_b64_tr_b16 v[140:141], v168 offset:10336
  v_mfma_f32_16x16x32_bf16 v[64:67], v[160:163], a[32:35], v[64:67]
  ds_read_b64_tr_b16 v[142:143], v168 offset:11616
  v_mfma_f32_16x16x32_bf16 v[24:27], a[24:27], v[160:163], v[24:27]
  s_waitcnt lgkmcnt(8)
  v_mfma_f32_16x16x32_bf16 v[48:51], a[28:31], v[164:167], v[48:51]
  ds_read_b64_tr_b16 v[144:145], v168 offset:10368
  v_mfma_f32_16x16x32_bf16 v[68:71], v[164:167], a[32:35], v[68:71]
  ds_read_b64_tr_b16 v[146:147], v168 offset:11648
  v_mfma_f32_16x16x32_bf16 v[28:31], a[24:27], v[164:167], v[28:31]
  v_lshlrev_b32 v252, 6, v0
  s_mov_b32 s57, 114688
  buffer_load_dword v253, v252, s[16:19], s57 offen sc1
  s_waitcnt lgkmcnt(8)
  v_mfma_f32_16x16x32_bf16 v[32:35], a[52:55], v[128:131], v[32:35]
  ds_read_b64_tr_b16 v[148:149], v168 offset:15360
  v_mfma_f32_16x16x32_bf16 v[52:55], v[128:131], a[56:59], v[52:55]
  ds_read_b64_tr_b16 v[150:151], v168 offset:16640
  s_waitcnt lgkmcnt(8)
  v_mfma_f32_16x16x32_bf16 v[36:39], a[52:55], v[132:135], v[36:39]
  ds_read_b64_tr_b16 v[152:153], v168 offset:15392
  v_mfma_f32_16x16x32_bf16 v[56:59], v[132:135], a[56:59], v[56:59]
  ds_read_b64_tr_b16 v[154:155], v168 offset:16672
  v_mfma_f32_16x16x32_bf16 v[16:19], a[48:51], v[132:135], v[16:19]
  s_waitcnt lgkmcnt(8)
  v_mfma_f32_16x16x32_bf16 v[40:43], a[52:55], v[136:139], v[40:43]
  ds_read_b64_tr_b16 v[156:157], v168 offset:15424
  v_mfma_f32_16x16x32_bf16 v[60:63], v[136:139], a[56:59], v[60:63]
  ds_read_b64_tr_b16 v[158:159], v168 offset:16704
  v_mfma_f32_16x16x32_bf16 v[20:23], a[48:51], v[136:139], v[20:23]
  ds_read_b64_tr_b16 v[188:189], v170 offset:0
  ds_read_b64_tr_b16 v[190:191], v170 offset:1280
  s_waitcnt lgkmcnt(10)
  v_mfma_f32_16x16x32_bf16 v[44:47], a[52:55], v[140:143], v[44:47]
  ds_read_b64_tr_b16 v[160:161], v168 offset:15456
  v_mfma_f32_16x16x32_bf16 v[64:67], v[140:143], a[56:59], v[64:67]
  ds_read_b64_tr_b16 v[162:163], v168 offset:16736
  v_mfma_f32_16x16x32_bf16 v[24:27], a[48:51], v[140:143], v[24:27]
  s_waitcnt lgkmcnt(10)
  v_mfma_f32_16x16x32_bf16 v[48:51], a[52:55], v[144:147], v[48:51]
  ds_read_b64_tr_b16 v[164:165], v168 offset:15488
  v_mfma_f32_16x16x32_bf16 v[68:71], v[144:147], a[56:59], v[68:71]
  ds_read_b64_tr_b16 v[166:167], v168 offset:16768
  v_mfma_f32_16x16x32_bf16 v[28:31], a[48:51], v[144:147], v[28:31]
  ds_read_b64_tr_b16 v[192:193], v170 offset:32
  ds_read_b64_tr_b16 v[194:195], v170 offset:1312
  s_waitcnt vmcnt(4)
  s_barrier
  s_waitcnt lgkmcnt(12)
  v_mfma_f32_16x16x32_bf16 v[32:35], a[76:79], v[148:151], v[32:35]
  ds_read_b64_tr_b16 v[128:129], v168 offset:20480
  v_mfma_f32_16x16x32_bf16 v[52:55], v[148:151], a[80:83], v[52:55]
  ds_read_b64_tr_b16 v[130:131], v168 offset:21760
  s_waitcnt lgkmcnt(12)
  v_mfma_f32_16x16x32_bf16 v[36:39], a[76:79], v[152:155], v[36:39]
  ds_read_b64_tr_b16 v[132:133], v168 offset:20512
  v_mfma_f32_16x16x32_bf16 v[56:59], v[152:155], a[80:83], v[56:59]
  ds_read_b64_tr_b16 v[134:135], v168 offset:21792
  v_mfma_f32_16x16x32_bf16 v[16:19], a[72:75], v[152:155], v[16:19]
  s_waitcnt lgkmcnt(10)
  v_mfma_f32_16x16x32_bf16 v[72:75], v[248:251], v[188:191], v[72:75]
  v_mfma_f32_16x16x32_bf16 v[92:95], v[188:191], v[188:191], v[92:95]
  v_mfma_f32_16x16x32_bf16 v[40:43], a[76:79], v[156:159], v[40:43]
  ds_read_b64_tr_b16 v[136:137], v168 offset:20544
  v_mfma_f32_16x16x32_bf16 v[60:63], v[156:159], a[80:83], v[60:63]
  ds_read_b64_tr_b16 v[138:139], v168 offset:21824
  v_mfma_f32_16x16x32_bf16 v[20:23], a[72:75], v[156:159], v[20:23]
  ds_read_b64_tr_b16 v[188:189], v170 offset:64
  ds_read_b64_tr_b16 v[190:191], v170 offset:1344
  s_waitcnt lgkmcnt(12)
  v_mfma_f32_16x16x32_bf16 v[44:47], a[76:79], v[160:163], v[44:47]
  ds_read_b64_tr_b16 v[140:141], v168 offset:20576
  v_mfma_f32_16x16x32_bf16 v[64:67], v[160:163], a[80:83], v[64:67]
  ds_read_b64_tr_b16 v[142:143], v168 offset:21856
  v_mfma_f32_16x16x32_bf16 v[24:27], a[72:75], v[160:163], v[24:27]
  s_waitcnt lgkmcnt(10)
  v_mfma_f32_16x16x32_bf16 v[76:79], v[248:251], v[192:195], v[76:79]
  v_mfma_f32_16x16x32_bf16 v[96:99], v[192:195], v[192:195], v[96:99]
  v_mfma_f32_16x16x32_bf16 v[48:51], a[76:79], v[164:167], v[48:51]
  ds_read_b64_tr_b16 v[144:145], v168 offset:20608
  v_mfma_f32_16x16x32_bf16 v[68:71], v[164:167], a[80:83], v[68:71]
  ds_read_b64_tr_b16 v[146:147], v168 offset:21888
  v_mfma_f32_16x16x32_bf16 v[28:31], a[72:75], v[164:167], v[28:31]
  ds_read_b64_tr_b16 v[192:193], v170 offset:96
  ds_read_b64_tr_b16 v[194:195], v170 offset:1376
  s_waitcnt vmcnt(0)
  v_cmp_gt_u32 vcc, 1, v253
  s_cbranch_vccz L_wa_30
  s_mov_b32 s57, 114688
  s_mov_b32 s74, 0
L_poll_31:
  buffer_load_dword v253, v252, s[16:19], s57 offen sc1
  s_waitcnt vmcnt(0)
  v_cmp_gt_u32 vcc, 1, v253
  s_cbranch_vccz L_pdone_32
  s_add_u32 s74, s74, 1
  s_cmp_lt_u32 s74, 1048576
  s_cbranch_scc1 L_poll_31
L_pdone_32:
L_wa_30:
  s_barrier
  s_waitcnt lgkmcnt(12)
  v_mfma_f32_16x16x32_bf16 v[32:35], a[100:103], v[128:131], v[32:35]
  ds_read_b64_tr_b16 v[148:149], v168 offset:25600
  v_mfma_f32_16x16x32_bf16 v[52:55], v[128:131], a[104:107], v[52:55]
  ds_read_b64_tr_b16 v[150:151], v168 offset:26880
  s_waitcnt lgkmcnt(12)
  v_mfma_f32_16x16x32_bf16 v[36:39], a[100:103], v[132:135], v[36:39]
  ds_read_b64_tr_b16 v[152:153], v168 offset:25632
  v_mfma_f32_16x16x32_bf16 v[56:59], v[132:135], a[104:107], v[56:59]
  ds_read_b64_tr_b16 v[154:155], v168 offset:26912
  v_mfma_f32_16x16x32_bf16 v[16:19], a[96:99], v[132:135], v[16:19]
  s_add_u32 s75, s72, 0
  s_and_b32 s75, s75, 7
  s_lshl_b32 s76, s75, 18
  s_add_u32 s76, s76, 5373952
  s_add_u32 m0, s71, 40960
  s_nop 0
  buffer_load_dwordx4 v175, s[16:19], s76 offen sc1 lds
  s_waitcnt lgkmcnt(10)
  v_mfma_f32_16x16x32_bf16 v[80:83], v[248:251], v[188:191], v[80:83]
  v_mfma_f32_16x16x32_bf16 v[100:103], v[188:191], v[188:191], v[100:103]
  v_mfma_f32_16x16x32_bf16 v[40:43], a[100:103], v[136:139], v[40:43]
  ds_read_b64_tr_b16 v[156:157], v168 offset:25664
  v_mfma_f32_16x16x32_bf16 v[60:63], v[136:139], a[104:107], v[60:63]
  ds_read_b64_tr_b16 v[158:159], v168 offset:26944
  v_mfma_f32_16x16x32_bf16 v[20:23], a[96:99], v[136:139], v[20:23]
  s_add_u32 m0, s71, 41984
  s_nop 0
  buffer_load_dwordx4 v176, s[16:19], s76 offen sc1 lds
  ds_read_b64_tr_b16 v[188:189], v170 offset:128
  ds_read_b64_tr_b16 v[190:191], v170 offset:1408
  s_waitcnt lgkmcnt(12)
  v_mfma_f32_16x16x32_bf16 v[44:47], a[100:103], v[140:143], v[44:47]
  ds_read_b64_tr_b16 v[160:161], v168 offset:25696
  v_mfma_f32_16x16x32_bf16 v[64:67], v[140:143], a[104:107], v[64:67]
  ds_read_b64_tr_b16 v[162:163], v168 offset:26976
  v_mfma_f32_16x16x32_bf16 v[24:27], a[96:99], v[140:143], v[24:27]
  s_add_u32 m0, s71, 43008
  s_mov_b32 exec_hi, 0
  buffer_load_dwordx4 v177, s[16:19], s76 offen sc1 lds
  s_mov_b32 exec_hi, -1
  s_waitcnt lgkmcnt(10)
  v_mfma_f32_16x16x32_bf16 v[84:87], v[248:251], v[192:195], v[84:87]
  v_mfma_f32_16x16x32_bf16 v[104:107], v[192:195], v[192:195], v[104:107]
  v_mfma_f32_16x16x32_bf16 v[48:51], a[100:103], v[144:147], v[48:51]
  ds_read_b64_tr_b16 v[164:165], v168 offset:25728
  v_mfma_f32_16x16x32_bf16 v[68:71], v[144:147], a[104:107], v[68:71]
  ds_read_b64_tr_b16 v[166:167], v168 offset:27008
  v_mfma_f32_16x16x32_bf16 v[28:31], a[96:99], v[144:147], v[28:31]
  s_add_u32 s75, s72, 2
  s_and_b32 s75, s75, 7
  s_lshl_b32 s76, s75, 18
  s_add_u32 s76, s76, 5373952
  s_add_u32 m0, s71, 51200
  s_nop 0
  buffer_load_dwordx4 v175, s[16:19], s76 offen sc1 lds
  s_waitcnt lgkmcnt(10)
  v_mfma_f32_16x16x32_bf16 v[32:35], a[124:127], v[148:151], v[32:35]
  ds_read_b64_tr_b16 v[128:129], v168 offset:30720
  v_mfma_f32_16x16x32_bf16 v[52:55], v[148:151], a[128:131], v[52:55]
  ds_read_b64_tr_b16 v[130:131], v168 offset:32000
  s_waitcnt lgkmcnt(10)
  v_mfma_f32_16x16x32_bf16 v[36:39], a[124:127], v[152:155], v[36:39]
  ds_read_b64_tr_b16 v[132:133], v168 offset:30752
  v_mfma_f32_16x16x32_bf16 v[56:59], v[152:155], a[128:131], v[56:59]
  ds_read_b64_tr_b16 v[134:135], v168 offset:32032
  v_mfma_f32_16x16x32_bf16 v[16:19], a[120:123], v[152:155], v[16:19]
  s_add_u32 m0, s71, 52224
  s_nop 0
  buffer_load_dwordx4 v176, s[16:19], s76 offen sc1 lds
  s_waitcnt lgkmcnt(8)
  v_mfma_f32_16x16x32_bf16 v[88:91], v[248:251], v[188:191], v[88:91]
  v_mfma_f32_16x16x32_bf16 v[108:111], v[188:191], v[188:191], v[108:111]
  v_mfma_f32_16x16x32_bf16 v[40:43], a[124:127], v[156:159], v[40:43]
  ds_read_b64_tr_b16 v[136:137], v168 offset:30784
  v_mfma_f32_16x16x32_bf16 v[60:63], v[156:159], a[128:131], v[60:63]
  ds_read_b64_tr_b16 v[138:139], v168 offset:32064
  v_mfma_f32_16x16x32_bf16 v[20:23], a[120:123], v[156:159], v[20:23]
  s_add_u32 m0, s71, 53248
  s_mov_b32 exec_hi, 0
  buffer_load_dwordx4 v177, s[16:19], s76 offen sc1 lds
  s_mov_b32 exec_hi, -1
  ds_read_b64_tr_b16 v[192:193], v170 offset:20480
  ds_read_b64_tr_b16 v[194:195], v170 offset:21760
  s_waitcnt lgkmcnt(10)
  v_mfma_f32_16x16x32_bf16 v[44:47], a[124:127], v[160:163], v[44:47]
  ds_read_b64_tr_b16 v[140:141], v168 offset:30816
  v_mfma_f32_16x16x32_bf16 v[64:67], v[160:163], a[128:131], v[64:67]
  ds_read_b64_tr_b16 v[142:143], v168 offset:32096
  v_mfma_f32_16x16x32_bf16 v[24:27], a[120:123], v[160:163], v[24:27]
  s_add_u32 s75, s72, 4
  s_and_b32 s75, s75, 7
  s_lshl_b32 s76, s75, 18
  s_add_u32 s76, s76, 5373952
  s_add_u32 m0, s71, 61440
  s_nop 0
  buffer_load_dwordx4 v175, s[16:19], s76 offen sc1 lds
  s_waitcnt lgkmcnt(10)
  v_mfma_f32_16x16x32_bf16 v[48:51], a[124:127], v[164:167], v[48:51]
  ds_read_b64_tr_b16 v[144:145], v168 offset:30848
  v_mfma_f32_16x16x32_bf16 v[68:71], v[164:167], a[128:131], v[68:71]
  ds_read_b64_tr_b16 v[146:147], v168 offset:32128
  v_mfma_f32_16x16x32_bf16 v[28:31], a[120:123], v[164:167], v[28:31]
  s_add_u32 m0, s71, 62464
  s_nop 0
  buffer_load_dwordx4 v176, s[16:19], s76 offen sc1 lds
  s_waitcnt lgkmcnt(10)
  v_mfma_f32_16x16x32_bf16 v[32:35], a[148:151], v[128:131], v[32:35]
  ds_read_b64_tr_b16 v[148:149], v168 offset:35840
  v_mfma_f32_16x16x32_bf16 v[52:55], v[128:131], a[152:155], v[52:55]
  ds_read_b64_tr_b16 v[150:151], v168 offset:37120
  s_waitcnt lgkmcnt(10)
  v_mfma_f32_16x16x32_bf16 v[36:39], a[148:151], v[132:135], v[36:39]
  ds_read_b64_tr_b16 v[152:153], v168 offset:35872
  v_mfma_f32_16x16x32_bf16 v[56:59], v[132:135], a[152:155], v[56:59]
  ds_read_b64_tr_b16 v[154:155], v168 offset:37152
  v_mfma_f32_16x16x32_bf16 v[16:19], a[144:147], v[132:135], v[16:19]
  s_add_u32 m0, s71, 63488
  s_mov_b32 exec_hi, 0
  buffer_load_dwordx4 v177, s[16:19], s76 offen sc1 lds
  s_mov_b32 exec_hi, -1
  s_waitcnt lgkmcnt(8)
  v_mfma_f32_16x16x32_bf16 v[72:75], v[248:251], v[192:195], v[72:75]
  v_mfma_f32_16x16x32_bf16 v[92:95], v[192:195], v[192:195], v[92:95]
  v_mfma_f32_16x16x32_bf16 v[40:43], a[148:151], v[136:139], v[40:43]
  ds_read_b64_tr_b16 v[156:157], v168 offset:35904
  v_mfma_f32_16x16x32_bf16 v[60:63], v[136:139], a[152:155], v[60:63]
  ds_read_b64_tr_b16 v[158:159], v168 offset:37184
  v_mfma_f32_16x16x32_bf16 v[20:23], a[144:147], v[136:139], v[20:23]
  s_add_u32 s75, s72, 6
  s_and_b32 s75, s75, 7
  s_lshl_b32 s76, s75, 18
  s_add_u32 s76, s76, 5373952
  s_add_u32 m0, s71, 71680
  s_nop 0
  buffer_load_dwordx4 v175, s[16:19], s76 offen sc1 lds
  ds_read_b64_tr_b16 v[188:189], v170 offset:20512
  ds_read_b64_tr_b16 v[190:191], v170 offset:21792
  s_waitcnt lgkmcnt(10)
  v_mfma_f32_16x16x32_bf16 v[44:47], a[148:151], v[140:143], v[44:47]
  ds_read_b64_tr_b16 v[160:161], v168 offset:35936
  v_mfma_f32_16x16x32_bf16 v[64:67], v[140:143], a[152:155], v[64:67]
  ds_read_b64_tr_b16 v[162:163], v168 offset:37216
  v_mfma_f32_16x16x32_bf16 v[24:27], a[144:147], v[140:143], v[24:27]
  s_add_u32 m0, s71, 72704
  s_nop 0
  buffer_load_dwordx4 v176, s[16:19], s76 offen sc1 lds
  s_waitcnt lgkmcnt(10)
  v_mfma_f32_16x16x32_bf16 v[48:51], a[148:151], v[144:147], v[48:51]
  ds_read_b64_tr_b16 v[164:165], v168 offset:35968
  v_mfma_f32_16x16x32_bf16 v[68:71], v[144:147], a[152:155], v[68:71]
  ds_read_b64_tr_b16 v[166:167], v168 offset:37248
  v_mfma_f32_16x16x32_bf16 v[28:31], a[144:147], v[144:147], v[28:31]
  s_add_u32 m0, s71, 73728
  s_mov_b32 exec_hi, 0
  buffer_load_dwordx4 v177, s[16:19], s76 offen sc1 lds
  s_mov_b32 exec_hi, -1
  s_waitcnt vmcnt(6)
  s_barrier
  s_waitcnt lgkmcnt(10)
  v_mfma_f32_16x16x32_bf16 v[32:35], a[172:175], v[148:151], v[32:35]
  ds_read_b64_tr_b16 v[128:129], v169 offset:0
  v_mfma_f32_16x16x32_bf16 v[52:55], v[148:151], a[176:179], v[52:55]
  ds_read_b64_tr_b16 v[130:131], v169 offset:1280
  s_waitcnt lgkmcnt(10)
  v_mfma_f32_16x16x32_bf16 v[36:39], a[172:175], v[152:155], v[36:39]
  ds_read_b64_tr_b16 v[132:133], v169 offset:32
  v_mfma_f32_16x16x32_bf16 v[56:59], v[152:155], a[176:179], v[56:59]
  ds_read_b64_tr_b16 v[134:135], v169 offset:1312
  v_mfma_f32_16x16x32_bf16 v[16:19], a[168:171], v[152:155], v[16:19]
  s_waitcnt lgkmcnt(8)
  v_mfma_f32_16x16x32_bf16 v[76:79], v[248:251], v[188:191], v[76:79]
  v_mfma_f32_16x16x32_bf16 v[96:99], v[188:191], v[188:191], v[96:99]
  v_mfma_f32_16x16x32_bf16 v[40:43], a[172:175], v[156:159], v[40:43]
  ds_read_b64_tr_b16 v[136:137], v169 offset:64
  v_mfma_f32_16x16x32_bf16 v[60:63], v[156:159], a[176:179], v[60:63]
  ds_read_b64_tr_b16 v[138:139], v169 offset:1344
  v_mfma_f32_16x16x32_bf16 v[20:23], a[168:171], v[156:159], v[20:23]
  ds_read_b64_tr_b16 v[192:193], v170 offset:20544
  ds_read_b64_tr_b16 v[194:195], v170 offset:21824
  s_waitcnt lgkmcnt(10)
  v_mfma_f32_16x16x32_bf16 v[44:47], a[172:175], v[160:163], v[44:47]
  ds_read_b64_tr_b16 v[140:141], v169 offset:96
  v_mfma_f32_16x16x32_bf16 v[64:67], v[160:163], a[176:179], v[64:67]
  ds_read_b64_tr_b16 v[142:143], v169 offset:1376
  v_mfma_f32_16x16x32_bf16 v[24:27], a[168:171], v[160:163], v[24:27]
  s_waitcnt lgkmcnt(10)
  v_mfma_f32_16x16x32_bf16 v[48:51], a[172:175], v[164:167], v[48:51]
  ds_read_b64_tr_b16 v[144:145], v169 offset:128
  v_mfma_f32_16x16x32_bf16 v[68:71], v[164:167], a[176:179], v[68:71]
  ds_read_b64_tr_b16 v[146:147], v169 offset:1408
  v_mfma_f32_16x16x32_bf16 v[28:31], a[168:171], v[164:167], v[28:31]
  ds_read_b64_tr_b16 v[188:189], v170 offset:20576
  ds_read_b64_tr_b16 v[190:191], v170 offset:21856
  s_waitcnt lgkmcnt(12)
  v_mfma_f32_16x16x32_bf16 v[32:35], a[16:19], v[128:131], v[32:35]
  ds_read_b64_tr_b16 v[148:149], v169 offset:5120
  v_mfma_f32_16x16x32_bf16 v[52:55], v[128:131], a[20:23], v[52:55]
  ds_read_b64_tr_b16 v[150:151], v169 offset:6400
  s_waitcnt lgkmcnt(12)
  v_mfma_f32_16x16x32_bf16 v[36:39], a[16:19], v[132:135], v[36:39]
  ds_read_b64_tr_b16 v[152:153], v169 offset:5152
  v_mfma_f32_16x16x32_bf16 v[56:59], v[132:135], a[20:23], v[56:59]
  ds_read_b64_tr_b16 v[154:155], v169 offset:6432
  v_mfma_f32_16x16x32_bf16 v[16:19], a[12:15], v[132:135], v[16:19]
  s_waitcnt lgkmcnt(10)
  v_mfma_f32_16x16x32_bf16 v[80:83], v[248:251], v[192:195], v[80:83]
  v_mfma_f32_16x16x32_bf16 v[100:103], v[192:195], v[192:195], v[100:103]
  v_mfma_f32_16x16x32_bf16 v[40:43], a[16:19], v[136:139], v[40:43]
  ds_read_b64_tr_b16 v[156:157], v169 offset:5184
  v_mfma_f32_16x16x32_bf16 v[60:63], v[136:139], a[20:23], v[60:63]
  ds_read_b64_tr_b16 v[158:159], v169 offset:6464
  v_mfma_f32_16x16x32_bf16 v[20:23], a[12:15], v[136:139], v[20:23]
  ds_read_b64_tr_b16 v[192:193], v170 offset:20608
  ds_read_b64_tr_b16 v[194:195], v170 offset:21888
  s_waitcnt lgkmcnt(12)
  v_mfma_f32_16x16x32_bf16 v[44:47], a[16:19], v[140:143], v[44:47]
  ds_read_b64_tr_b16 v[160:161], v169 offset:5216
  v_mfma_f32_16x16x32_bf16 v[64:67], v[140:143], a[20:23], v[64:67]
  ds_read_b64_tr_b16 v[162:163], v169 offset:6496
  v_mfma_f32_16x16x32_bf16 v[24:27], a[12:15], v[140:143], v[24:27]
  s_waitcnt lgkmcnt(10)
  v_mfma_f32_16x16x32_bf16 v[84:87], v[248:251], v[188:191], v[84:87]
  v_mfma_f32_16x16x32_bf16 v[104:107], v[188:191], v[188:191], v[104:107]
  v_mfma_f32_16x16x32_bf16 v[48:51], a[16:19], v[144:147], v[48:51]
  ds_read_b64_tr_b16 v[164:165], v169 offset:5248
  v_mfma_f32_16x16x32_bf16 v[68:71], v[144:147], a[20:23], v[68:71]
  ds_read_b64_tr_b16 v[166:167], v169 offset:6528
  v_mfma_f32_16x16x32_bf16 v[28:31], a[12:15], v[144:147], v[28:31]
  ds_read_b64_tr_b16 v[188:189], v171 offset:0
  ds_read_b64_tr_b16 v[190:191], v171 offset:1280
  s_waitcnt lgkmcnt(12)
  v_mfma_f32_16x16x32_bf16 v[32:35], a[40:43], v[148:151], v[32:35]
  ds_read_b64_tr_b16 v[128:129], v169 offset:10240
  v_mfma_f32_16x16x32_bf16 v[52:55], v[148:151], a[44:47], v[52:55]
  ds_read_b64_tr_b16 v[130:131], v169 offset:11520
  s_waitcnt lgkmcnt(12)
  v_mfma_f32_16x16x32_bf16 v[36:39], a[40:43], v[152:155], v[36:39]
  ds_read_b64_tr_b16 v[132:133], v169 offset:10272
  v_mfma_f32_16x16x32_bf16 v[56:59], v[152:155], a[44:47], v[56:59]
  ds_read_b64_tr_b16 v[134:135], v169 offset:11552
  v_mfma_f32_16x16x32_bf16 v[16:19], a[36:39], v[152:155], v[16:19]
  s_waitcnt lgkmcnt(10)
  v_mfma_f32_16x16x32_bf16 v[88:91], v[248:251], v[192:195], v[88:91]
  v_mfma_f32_16x16x32_bf16 v[108:111], v[192:195], v[192:195], v[108:111]
  v_mfma_f32_16x16x32_bf16 v[40:43], a[40:43], v[156:159], v[40:43]
  ds_read_b64_tr_b16 v[136:137], v169 offset:10304
  v_mfma_f32_16x16x32_bf16 v[60:63], v[156:159], a[44:47], v[60:63]
  ds_read_b64_tr_b16 v[138:139], v169 offset:11584
  v_mfma_f32_16x16x32_bf16 v[20:23], a[36:39], v[156:159], v[20:23]
  ds_read_b64_tr_b16 v[192:193], v171 offset:32
  ds_read_b64_tr_b16 v[194:195], v171 offset:1312
  s_waitcnt lgkmcnt(12)
  v_mfma_f32_16x16x32_bf16 v[44:47], a[40:43], v[160:163], v[44:47]
  ds_read_b64_tr_b16 v[140:141], v169 offset:10336
  v_mfma_f32_16x16x32_bf16 v[64:67], v[160:163], a[44:47], v[64:67]
  ds_read_b64_tr_b16 v[142:143], v169 offset:11616
  v_mfma_f32_16x16x32_bf16 v[24:27], a[36:39], v[160:163], v[24:27]
  s_waitcnt lgkmcnt(10)
  v_mfma_f32_16x16x32_bf16 v[72:75], v[248:251], v[188:191], v[72:75]
  v_mfma_f32_16x16x32_bf16 v[92:95], v[188:191], v[188:191], v[92:95]
  v_mfma_f32_16x16x32_bf16 v[48:51], a[40:43], v[164:167], v[48:51]
  ds_read_b64_tr_b16 v[144:145], v169 offset:10368
  v_mfma_f32_16x16x32_bf16 v[68:71], v[164:167], a[44:47], v[68:71]
  ds_read_b64_tr_b16 v[146:147], v169 offset:11648
  v_mfma_f32_16x16x32_bf16 v[28:31], a[36:39], v[164:167], v[28:31]
  ds_read_b64_tr_b16 v[188:189], v171 offset:64
  ds_read_b64_tr_b16 v[190:191], v171 offset:1344
  s_waitcnt lgkmcnt(12)
  v_mfma_f32_16x16x32_bf16 v[32:35], a[64:67], v[128:131], v[32:35]
  ds_read_b64_tr_b16 v[148:149], v169 offset:15360
  v_mfma_f32_16x16x32_bf16 v[52:55], v[128:131], a[68:71], v[52:55]
  ds_read_b64_tr_b16 v[150:151], v169 offset:16640
  s_waitcnt lgkmcnt(12)
  v_mfma_f32_16x16x32_bf16 v[36:39], a[64:67], v[132:135], v[36:39]
  ds_read_b64_tr_b16 v[152:153], v169 offset:15392
  v_mfma_f32_16x16x32_bf16 v[56:59], v[132:135], a[68:71], v[56:59]
  ds_read_b64_tr_b16 v[154:155], v169 offset:16672
  v_mfma_f32_16x16x32_bf16 v[16:19], a[60:63], v[132:135], v[16:19]
  s_waitcnt lgkmcnt(10)
  v_mfma_f32_16x16x32_bf16 v[76:79], v[248:251], v[192:195], v[76:79]
  v_mfma_f32_16x16x32_bf16 v[96:99], v[192:195], v[192:195], v[96:99]
  v_mfma_f32_16x16x32_bf16 v[40:43], a[64:67], v[136:139], v[40:43]
  ds_read_b64_tr_b16 v[156:157], v169 offset:15424
  v_mfma_f32_16x16x32_bf16 v[60:63], v[136:139], a[68:71], v[60:63]
  ds_read_b64_tr_b16 v[158:159], v169 offset:16704
  v_mfma_f32_16x16x32_bf16 v[20:23], a[60:63], v[136:139], v[20:23]
  ds_read_b64_tr_b16 v[192:193], v171 offset:96
  ds_read_b64_tr_b16 v[194:195], v171 offset:1376
  s_waitcnt lgkmcnt(12)
  v_mfma_f32_16x16x32_bf16 v[44:47], a[64:67], v[140:143], v[44:47]
  ds_read_b64_tr_b16 v[160:161], v169 offset:15456
  v_mfma_f32_16x16x32_bf16 v[64:67], v[140:143], a[68:71], v[64:67]
  ds_read_b64_tr_b16 v[162:163], v169 offset:16736
  v_mfma_f32_16x16x32_bf16 v[24:27], a[60:63], v[140:143], v[24:27]
  s_waitcnt lgkmcnt(10)
  v_mfma_f32_16x16x32_bf16 v[80:83], v[248:251], v[188:191], v[80:83]
  v_mfma_f32_16x16x32_bf16 v[100:103], v[188:191], v[188:191], v[100:103]
  v_mfma_f32_16x16x32_bf16 v[48:51], a[64:67], v[144:147], v[48:51]
  ds_read_b64_tr_b16 v[164:165], v169 offset:15488
  v_mfma_f32_16x16x32_bf16 v[68:71], v[144:147], a[68:71], v[68:71]
  ds_read_b64_tr_b16 v[166:167], v169 offset:16768
  v_mfma_f32_16x16x32_bf16 v[28:31], a[60:63], v[144:147], v[28:31]
  ds_read_b64_tr_b16 v[188:189], v171 offset:128
  ds_read_b64_tr_b16 v[190:191], v171 offset:1408
  s_waitcnt vmcnt(0)
  s_barrier
  s_waitcnt lgkmcnt(12)
  v_mfma_f32_16x16x32_bf16 v[32:35], a[88:91], v[148:151], v[32:35]
  ds_read_b64_tr_b16 v[128:129], v169 offset:20480
  v_mfma_f32_16x16x32_bf16 v[52:55], v[148:151], a[92:95], v[52:55]
  ds_read_b64_tr_b16 v[130:131], v169 offset:21760
  s_waitcnt lgkmcnt(12)
  v_mfma_f32_16x16x32_bf16 v[36:39], a[88:91], v[152:155], v[36:39]
  ds_read_b64_tr_b16 v[132:133], v169 offset:20512
  v_mfma_f32_16x16x32_bf16 v[56:59], v[152:155], a[92:95], v[56:59]
  ds_read_b64_tr_b16 v[134:135], v169 offset:21792
  v_mfma_f32_16x16x32_bf16 v[16:19], a[84:87], v[152:155], v[16:19]
  s_waitcnt lgkmcnt(10)
  v_mfma_f32_16x16x32_bf16 v[84:87], v[248:251], v[192:195], v[84:87]
  v_mfma_f32_16x16x32_bf16 v[104:107], v[192:195], v[192:195], v[104:107]
  v_mfma_f32_16x16x32_bf16 v[40:43], a[88:91], v[156:159], v[40:43]
  ds_read_b64_tr_b16 v[136:137], v169 offset:20544
  v_mfma_f32_16x16x32_bf16 v[60:63], v[156:159], a[92:95], v[60:63]
  ds_read_b64_tr_b16 v[138:139], v169 offset:21824
  v_mfma_f32_16x16x32_bf16 v[20:23], a[84:87], v[156:159], v[20:23]
  ds_read_b64_tr_b16 v[192:193], v171 offset:20480
  ds_read_b64_tr_b16 v[194:195], v171 offset:21760
  s_waitcnt lgkmcnt(12)
  v_mfma_f32_16x16x32_bf16 v[44:47], a[88:91], v[160:163], v[44:47]
  ds_read_b64_tr_b16 v[140:141], v169 offset:20576
  v_mfma_f32_16x16x32_bf16 v[64:67], v[160:163], a[92:95], v[64:67]
  ds_read_b64_tr_b16 v[142:143], v169 offset:21856
  v_mfma_f32_16x16x32_bf16 v[24:27], a[84:87], v[160:163], v[24:27]
  s_waitcnt lgkmcnt(10)
  v_mfma_f32_16x16x32_bf16 v[88:91], v[248:251], v[188:191], v[88:91]
  v_mfma_f32_16x16x32_bf16 v[108:111], v[188:191], v[188:191], v[108:111]
  v_mfma_f32_16x16x32_bf16 v[48:51], a[88:91], v[164:167], v[48:51]
  ds_read_b64_tr_b16 v[144:145], v169 offset:20608
  v_mfma_f32_16x16x32_bf16 v[68:71], v[164:167], a[92:95], v[68:71]
  ds_read_b64_tr_b16 v[146:147], v169 offset:21888
  v_mfma_f32_16x16x32_bf16 v[28:31], a[84:87], v[164:167], v[28:31]
  ds_read_b64_tr_b16 v[188:189], v171 offset:20512
  ds_read_b64_tr_b16 v[190:191], v171 offset:21792
  s_waitcnt lgkmcnt(12)
  v_mfma_f32_16x16x32_bf16 v[32:35], a[112:115], v[128:131], v[32:35]
  ds_read_b64_tr_b16 v[148:149], v169 offset:25600
  v_mfma_f32_16x16x32_bf16 v[52:55], v[128:131], a[116:119], v[52:55]
  ds_read_b64_tr_b16 v[150:151], v169 offset:26880
  s_waitcnt lgkmcnt(12)
  v_mfma_f32_16x16x32_bf16 v[36:39], a[112:115], v[132:135], v[36:39]
  ds_read_b64_tr_b16 v[152:153], v169 offset:25632
  v_mfma_f32_16x16x32_bf16 v[56:59], v[132:135], a[116:119], v[56:59]
  ds_read_b64_tr_b16 v[154:155], v169 offset:26912
  v_mfma_f32_16x16x32_bf16 v[16:19], a[108:111], v[132:135], v[16:19]
  s_waitcnt lgkmcnt(10)
  v_mfma_f32_16x16x32_bf16 v[72:75], v[248:251], v[192:195], v[72:75]
  v_mfma_f32_16x16x32_bf16 v[92:95], v[192:195], v[192:195], v[92:95]
  v_mfma_f32_16x16x32_bf16 v[40:43], a[112:115], v[136:139], v[40:43]
  ds_read_b64_tr_b16 v[156:157], v169 offset:25664
  v_mfma_f32_16x16x32_bf16 v[60:63], v[136:139], a[116:119], v[60:63]
  ds_read_b64_tr_b16 v[158:159], v169 offset:26944
  v_mfma_f32_16x16x32_bf16 v[20:23], a[108:111], v[136:139], v[20:23]
  ds_read_b64_tr_b16 v[192:193], v171 offset:20544
  ds_read_b64_tr_b16 v[194:195], v171 offset:21824
  s_waitcnt lgkmcnt(12)
  v_mfma_f32_16x16x32_bf16 v[44:47], a[112:115], v[140:143], v[44:47]
  ds_read_b64_tr_b16 v[160:161], v169 offset:25696
  v_mfma_f32_16x16x32_bf16 v[64:67], v[140:143], a[116:119], v[64:67]
  ds_read_b64_tr_b16 v[162:163], v169 offset:26976
  v_mfma_f32_16x16x32_bf16 v[24:27], a[108:111], v[140:143], v[24:27]
  s_waitcnt lgkmcnt(10)
  v_mfma_f32_16x16x32_bf16 v[76:79], v[248:251], v[188:191], v[76:79]
  v_mfma_f32_16x16x32_bf16 v[96:99], v[188:191], v[188:191], v[96:99]
  v_mfma_f32_16x16x32_bf16 v[48:51], a[112:115], v[144:147], v[48:51]
  ds_read_b64_tr_b16 v[164:165], v169 offset:25728
  v_mfma_f32_16x16x32_bf16 v[68:71], v[144:147], a[116:119], v[68:71]
  ds_read_b64_tr_b16 v[166:167], v169 offset:27008
  v_mfma_f32_16x16x32_bf16 v[28:31], a[108:111], v[144:147], v[28:31]
  ds_read_b64_tr_b16 v[188:189], v171 offset:20576
  ds_read_b64_tr_b16 v[190:191], v171 offset:21856
  s_waitcnt lgkmcnt(12)
  v_mfma_f32_16x16x32_bf16 v[32:35], a[136:139], v[148:151], v[32:35]
  ds_read_b64_tr_b16 v[128:129], v169 offset:30720
  v_mfma_f32_16x16x32_bf16 v[52:55], v[148:151], a[140:143], v[52:55]
  ds_read_b64_tr_b16 v[130:131], v169 offset:32000
  s_waitcnt lgkmcnt(12)
  v_mfma_f32_16x16x32_bf16 v[36:39], a[136:139], v[152:155], v[36:39]
  ds_read_b64_tr_b16 v[132:133], v169 offset:30752
  v_mfma_f32_16x16x32_bf16 v[56:59], v[152:155], a[140:143], v[56:59]
  ds_read_b64_tr_b16 v[134:135], v169 offset:32032
  v_mfma_f32_16x16x32_bf16 v[16:19], a[132:135], v[152:155], v[16:19]
  s_waitcnt lgkmcnt(10)
  v_mfma_f32_16x16x32_bf16 v[80:83], v[248:251], v[192:195], v[80:83]
  v_mfma_f32_16x16x32_bf16 v[100:103], v[192:195], v[192:195], v[100:103]
  v_mfma_f32_16x16x32_bf16 v[40:43], a[136:139], v[156:159], v[40:43]
  ds_read_b64_tr_b16 v[136:137], v169 offset:30784
  v_mfma_f32_16x16x32_bf16 v[60:63], v[156:159], a[140:143], v[60:63]
  ds_read_b64_tr_b16 v[138:139], v169 offset:32064
  v_mfma_f32_16x16x32_bf16 v[20:23], a[132:135], v[156:159], v[20:23]
  ds_read_b64_tr_b16 v[192:193], v171 offset:20608
  ds_read_b64_tr_b16 v[194:195], v171 offset:21888
  s_waitcnt lgkmcnt(12)
  v_mfma_f32_16x16x32_bf16 v[44:47], a[136:139], v[160:163], v[44:47]
  ds_read_b64_tr_b16 v[140:141], v169 offset:30816
  v_mfma_f32_16x16x32_bf16 v[64:67], v[160:163], a[140:143], v[64:67]
  ds_read_b64_tr_b16 v[142:143], v169 offset:32096
  v_mfma_f32_16x16x32_bf16 v[24:27], a[132:135], v[160:163], v[24:27]
  s_waitcnt lgkmcnt(10)
  v_mfma_f32_16x16x32_bf16 v[84:87], v[248:251], v[188:191], v[84:87]
  v_mfma_f32_16x16x32_bf16 v[104:107], v[188:191], v[188:191], v[104:107]
  v_mfma_f32_16x16x32_bf16 v[48:51], a[136:139], v[164:167], v[48:51]
  ds_read_b64_tr_b16 v[144:145], v169 offset:30848
  v_mfma_f32_16x16x32_bf16 v[68:71], v[164:167], a[140:143], v[68:71]
  ds_read_b64_tr_b16 v[146:147], v169 offset:32128
  v_mfma_f32_16x16x32_bf16 v[28:31], a[132:135], v[164:167], v[28:31]
  s_waitcnt lgkmcnt(10)
  v_mfma_f32_16x16x32_bf16 v[32:35], a[160:163], v[128:131], v[32:35]
  ds_read_b64_tr_b16 v[148:149], v169 offset:35840
  v_mfma_f32_16x16x32_bf16 v[52:55], v[128:131], a[164:167], v[52:55]
  ds_read_b64_tr_b16 v[150:151], v169 offset:37120
  s_waitcnt lgkmcnt(10)
  v_mfma_f32_16x16x32_bf16 v[36:39], a[160:163], v[132:135], v[36:39]
  ds_read_b64_tr_b16 v[152:153], v169 offset:35872
  v_mfma_f32_16x16x32_bf16 v[56:59], v[132:135], a[164:167], v[56:59]
  ds_read_b64_tr_b16 v[154:155], v169 offset:37152
  v_mfma_f32_16x16x32_bf16 v[16:19], a[156:159], v[132:135], v[16:19]
  s_waitcnt lgkmcnt(8)
  v_mfma_f32_16x16x32_bf16 v[88:91], v[248:251], v[192:195], v[88:91]
  v_mfma_f32_16x16x32_bf16 v[108:111], v[192:195], v[192:195], v[108:111]
  v_mfma_f32_16x16x32_bf16 v[40:43], a[160:163], v[136:139], v[40:43]
  ds_read_b64_tr_b16 v[156:157], v169 offset:35904
  v_mfma_f32_16x16x32_bf16 v[60:63], v[136:139], a[164:167], v[60:63]
  ds_read_b64_tr_b16 v[158:159], v169 offset:37184
  v_mfma_f32_16x16x32_bf16 v[20:23], a[156:159], v[136:139], v[20:23]
  s_waitcnt lgkmcnt(8)
  v_mfma_f32_16x16x32_bf16 v[44:47], a[160:163], v[140:143], v[44:47]
  ds_read_b64_tr_b16 v[160:161], v169 offset:35936
  v_mfma_f32_16x16x32_bf16 v[64:67], v[140:143], a[164:167], v[64:67]
  ds_read_b64_tr_b16 v[162:163], v169 offset:37216
  v_mfma_f32_16x16x32_bf16 v[24:27], a[156:159], v[140:143], v[24:27]
  s_waitcnt lgkmcnt(8)
  v_mfma_f32_16x16x32_bf16 v[48:51], a[160:163], v[144:147], v[48:51]
  ds_read_b64_tr_b16 v[164:165], v169 offset:35968
  v_mfma_f32_16x16x32_bf16 v[68:71], v[144:147], a[164:167], v[68:71]
  ds_read_b64_tr_b16 v[166:167], v169 offset:37248
  v_mfma_f32_16x16x32_bf16 v[28:31], a[156:159], v[144:147], v[28:31]
  s_nop 4
  v_cndmask_b32 v92, v92, v93, s[60:61]
  v_cndmask_b32 v92, v92, v94, s[62:63]
  v_cndmask_b32 v73, v92, v95, s[64:65]
  v_cndmask_b32 v96, v96, v97, s[60:61]
  v_cndmask_b32 v96, v96, v98, s[62:63]
  v_cndmask_b32 v77, v96, v99, s[64:65]
  v_cndmask_b32 v100, v100, v101, s[60:61]
  v_cndmask_b32 v100, v100, v102, s[62:63]
  v_cndmask_b32 v81, v100, v103, s[64:65]
  v_cndmask_b32 v104, v104, v105, s[60:61]
  v_cndmask_b32 v104, v104, v106, s[62:63]
  v_cndmask_b32 v85, v104, v107, s[64:65]
  v_cndmask_b32 v108, v108, v109, s[60:61]
  v_cndmask_b32 v108, v108, v110, s[62:63]
  v_cndmask_b32 v89, v108, v111, s[64:65]
  s_mov_b64 exec, s[66:67]
  ds_write_b64 v178, v[72:73] offset:0
  ds_write_b64 v178, v[76:77] offset:512
  ds_write_b64 v178, v[80:81] offset:1024
  ds_write_b64 v178, v[84:85] offset:1536
  ds_write_b64 v178, v[88:89] offset:2048
  s_mov_b64 exec, -1
  s_waitcnt lgkmcnt(0)
  s_barrier
  ds_read_b128 v[184:187], v180
  ds_read_b128 v[188:191], v180 offset:16
  ds_read_b128 v[192:195], v181
  ds_read_b128 v[196:199], v181 offset:16
  v_mfma_f32_16x16x32_bf16 v[32:35], a[184:187], v[148:151], v[32:35]
  v_mfma_f32_16x16x32_bf16 v[52:55], v[148:151], a[188:191], v[52:55]
  v_mfma_f32_16x16x32_bf16 v[36:39], a[184:187], v[152:155], v[36:39]
  v_mfma_f32_16x16x32_bf16 v[56:59], v[152:155], a[188:191], v[56:59]
  v_mfma_f32_16x16x32_bf16 v[16:19], a[180:183], v[152:155], v[16:19]
  s_waitcnt lgkmcnt(0)
  v_mfma_f32_16x16x32_bf16 v[40:43], a[184:187], v[156:159], v[40:43]
  s_mov_b32 s52, 0x3b000000
  s_mov_b32 s53, 0x3727c5ac
  v_mfma_f32_16x16x32_bf16 v[60:63], v[156:159], a[188:191], v[60:63]
  v_add_f32 v184, v184, v186
  v_add_f32 v188, v188, v190
  v_mfma_f32_16x16x32_bf16 v[20:23], a[180:183], v[156:159], v[20:23]
  v_add_f32 v185, v185, v187
  v_add_f32 v189, v189, v191
  v_mfma_f32_16x16x32_bf16 v[44:47], a[184:187], v[160:163], v[44:47]
  v_add_f32 v192, v192, v194
  v_add_f32 v196, v196, v198
  v_mfma_f32_16x16x32_bf16 v[64:67], v[160:163], a[188:191], v[64:67]
  v_add_f32 v193, v193, v195
  v_add_f32 v197, v197, v199
  v_mfma_f32_16x16x32_bf16 v[24:27], a[180:183], v[160:163], v[24:27]
  v_add_f32 v184, v184, v188
  v_add_f32 v185, v185, v189
  v_mfma_f32_16x16x32_bf16 v[48:51], a[184:187], v[164:167], v[48:51]
  v_add_f32 v192, v192, v196
  v_add_f32 v193, v193, v197
  v_mfma_f32_16x16x32_bf16 v[68:71], v[164:167], a[188:191], v[68:71]
  v_mul_f32 v184, s52, v184
  v_mul_f32 v185, s52, v185
  v_mfma_f32_16x16x32_bf16 v[28:31], a[180:183], v[164:167], v[28:31]
  v_mul_f32 v192, s52, v192
  v_mul_f32 v193, s52, v193
  v_fma_f32 v185, -v184, v184, v185
  v_fma_f32 v193, -v192, v192, v193
  v_max_f32 v185, 0, v185
  v_max_f32 v193, 0, v193
  v_add_f32 v185, s53, v185
  v_add_f32 v193, s53, v193
  v_rsq_f32 v185, v185
  v_rsq_f32 v193, v193
  s_nop 0
  v_mul_f32_e64 v184, -v184, v185
  v_mul_f32_e64 v192, -v192, v193
  s_nop 7
  ds_write_b32 v182, v185
  ds_write_b32 v182, v184 offset:320
  ds_write_b32 v183, v193 offset:256
  ds_write_b32 v183, v192 offset:576
  s_waitcnt lgkmcnt(0)
  ds_read2_b32 v[128:129], v183 offset0:0 offset1:80
  ds_read_b128 v[140:143], v179 offset:0
  ds_read_b128 v[160:163], v179 offset:320
  ds_read2_b32 v[130:131], v183 offset0:16 offset1:96
  ds_read_b128 v[144:147], v179 offset:64
  ds_read_b128 v[164:167], v179 offset:384
  ds_read2_b32 v[132:133], v183 offset0:32 offset1:112
  ds_read_b128 v[148:151], v179 offset:128
  ds_read_b128 v[168:171], v179 offset:448
  ds_read2_b32 v[134:135], v183 offset0:48 offset1:128
  ds_read_b128 v[152:155], v179 offset:192
  ds_read_b128 v[172:175], v179 offset:512
  ds_read2_b32 v[136:137], v183 offset0:64 offset1:144
  ds_read_b128 v[156:159], v179 offset:256
  ds_read_b128 v[176:179], v179 offset:576
  s_waitcnt lgkmcnt(12)
  v_pk_mul_f32 v[214:215], v[8:9], v[128:129] op_sel:[0,1] op_sel_hi:[1,1]
  v_pk_fma_f32 v[214:215], v[32:33], v[128:129], v[214:215] op_sel:[0,0,0] op_sel_hi:[1,0,1]
  v_cvt_pk_bf16_f32 v192, v214, v215
  v_pk_mul_f32 v[216:217], v[10:11], v[128:129] op_sel:[0,1] op_sel_hi:[1,1]
  v_pk_fma_f32 v[216:217], v[34:35], v[128:129], v[216:217] op_sel:[0,0,0] op_sel_hi:[1,0,1]
  v_cvt_pk_bf16_f32 v193, v216, v217
  v_pk_mul_f32 v[218:219], v[160:161], v[12:13] op_sel:[0,0] op_sel_hi:[1,0]
  v_pk_fma_f32 v[218:219], v[52:53], v[140:141], v[218:219]
  v_cvt_pk_bf16_f32 v202, v218, v219
  v_pk_mul_f32 v[212:213], v[162:163], v[12:13] op_sel:[0,0] op_sel_hi:[1,0]
  v_pk_fma_f32 v[212:213], v[54:55], v[142:143], v[212:213]
  v_cvt_pk_bf16_f32 v203, v212, v213
  s_waitcnt lgkmcnt(9)
  v_pk_mul_f32 v[214:215], v[8:9], v[130:131] op_sel:[0,1] op_sel_hi:[1,1]
  v_pk_fma_f32 v[214:215], v[36:37], v[130:131], v[214:215] op_sel:[0,0,0] op_sel_hi:[1,0,1]
  v_cvt_pk_bf16_f32 v194, v214, v215
  v_pk_mul_f32 v[216:217], v[10:11], v[130:131] op_sel:[0,1] op_sel_hi:[1,1]
  v_pk_fma_f32 v[216:217], v[38:39], v[130:131], v[216:217] op_sel:[0,0,0] op_sel_hi:[1,0,1]
  v_cvt_pk_bf16_f32 v195, v216, v217
  v_pk_mul_f32 v[218:219], v[4:5], v[130:131] op_sel:[0,1] op_sel_hi:[1,1]
  v_pk_fma_f32 v[218:219], v[16:17], v[130:131], v[218:219] op_sel:[0,0,0] op_sel_hi:[1,0,1]
  v_cvt_pk_bf16_f32 v184, v218, v219
  v_pk_mul_f32 v[212:213], v[6:7], v[130:131] op_sel:[0,1] op_sel_hi:[1,1]
  v_pk_fma_f32 v[212:213], v[18:19], v[130:131], v[212:213] op_sel:[0,0,0] op_sel_hi:[1,0,1]
  v_cvt_pk_bf16_f32 v185, v212, v213
  v_pk_mul_f32 v[214:215], v[164:165], v[12:13] op_sel:[0,0] op_sel_hi:[1,0]
  v_pk_fma_f32 v[214:215], v[56:57], v[144:145], v[214:215]
  v_cvt_pk_bf16_f32 v204, v214, v215
  v_pk_mul_f32 v[216:217], v[166:167], v[12:13] op_sel:[0,0] op_sel_hi:[1,0]
  v_pk_fma_f32 v[216:217], v[58:59], v[146:147], v[216:217]
  v_cvt_pk_bf16_f32 v205, v216, v217
  s_waitcnt lgkmcnt(6)
  v_pk_mul_f32 v[218:219], v[8:9], v[132:133] op_sel:[0,1] op_sel_hi:[1,1]
  v_pk_fma_f32 v[218:219], v[40:41], v[132:133], v[218:219] op_sel:[0,0,0] op_sel_hi:[1,0,1]
  v_cvt_pk_bf16_f32 v196, v218, v219
  v_pk_mul_f32 v[212:213], v[10:11], v[132:133] op_sel:[0,1] op_sel_hi:[1,1]
  v_pk_fma_f32 v[212:213], v[42:43], v[132:133], v[212:213] op_sel:[0,0,0] op_sel_hi:[1,0,1]
  v_cvt_pk_bf16_f32 v197, v212, v213
  v_pk_mul_f32 v[214:215], v[4:5], v[132:133] op_sel:[0,1] op_sel_hi:[1,1]
  v_pk_fma_f32 v[214:215], v[20:21], v[132:133], v[214:215] op_sel:[0,0,0] op_sel_hi:[1,0,1]
  v_cvt_pk_bf16_f32 v186, v214, v215
  v_pk_mul_f32 v[216:217], v[6:7], v[132:133] op_sel:[0,1] op_sel_hi:[1,1]
  v_pk_fma_f32 v[216:217], v[22:23], v[132:133], v[216:217] op_sel:[0,0,0] op_sel_hi:[1,0,1]
  v_cvt_pk_bf16_f32 v187, v216, v217
  v_pk_mul_f32 v[218:219], v[168:169], v[12:13] op_sel:[0,0] op_sel_hi:[1,0]
  v_pk_fma_f32 v[218:219], v[60:61], v[148:149], v[218:219]
  v_cvt_pk_bf16_f32 v206, v218, v219
  v_pk_mul_f32 v[212:213], v[170:171], v[12:13] op_sel:[0,0] op_sel_hi:[1,0]
  v_pk_fma_f32 v[212:213], v[62:63], v[150:151], v[212:213]
  v_cvt_pk_bf16_f32 v207, v212, v213
  s_waitcnt lgkmcnt(3)
  v_pk_mul_f32 v[214:215], v[8:9], v[134:135] op_sel:[0,1] op_sel_hi:[1,1]
  v_pk_fma_f32 v[214:215], v[44:45], v[134:135], v[214:215] op_sel:[0,0,0] op_sel_hi:[1,0,1]
  v_cvt_pk_bf16_f32 v198, v214, v215
  v_pk_mul_f32 v[216:217], v[10:11], v[134:135] op_sel:[0,1] op_sel_hi:[1,1]
  v_pk_fma_f32 v[216:217], v[46:47], v[134:135], v[216:217] op_sel:[0,0,0] op_sel_hi:[1,0,1]
  v_cvt_pk_bf16_f32 v199, v216, v217
  v_pk_mul_f32 v[218:219], v[4:5], v[134:135] op_sel:[0,1] op_sel_hi:[1,1]
  v_pk_fma_f32 v[218:219], v[24:25], v[134:135], v[218:219] op_sel:[0,0,0] op_sel_hi:[1,0,1]
  v_cvt_pk_bf16_f32 v188, v218, v219
  v_pk_mul_f32 v[212:213], v[6:7], v[134:135] op_sel:[0,1] op_sel_hi:[1,1]
  v_pk_fma_f32 v[212:213], v[26:27], v[134:135], v[212:213] op_sel:[0,0,0] op_sel_hi:[1,0,1]
  v_cvt_pk_bf16_f32 v189, v212, v213
  v_pk_mul_f32 v[214:215], v[172:173], v[12:13] op_sel:[0,0] op_sel_hi:[1,0]
  v_pk_fma_f32 v[214:215], v[64:65], v[152:153], v[214:215]
  v_cvt_pk_bf16_f32 v208, v214, v215
  v_pk_mul_f32 v[216:217], v[174:175], v[12:13] op_sel:[0,0] op_sel_hi:[1,0]
  v_pk_fma_f32 v[216:217], v[66:67], v[154:155], v[216:217]
  v_cvt_pk_bf16_f32 v209, v216, v217
  s_waitcnt lgkmcnt(0)
  v_pk_mul_f32 v[218:219], v[8:9], v[136:137] op_sel:[0,1] op_sel_hi:[1,1]
  v_pk_fma_f32 v[218:219], v[48:49], v[136:137], v[218:219] op_sel:[0,0,0] op_sel_hi:[1,0,1]
  v_cvt_pk_bf16_f32 v200, v218, v219
  v_pk_mul_f32 v[212:213], v[10:11], v[136:137] op_sel:[0,1] op_sel_hi:[1,1]
  v_pk_fma_f32 v[212:213], v[50:51], v[136:137], v[212:213] op_sel:[0,0,0] op_sel_hi:[1,0,1]
  v_cvt_pk_bf16_f32 v201, v212, v213
  v_pk_mul_f32 v[214:215], v[4:5], v[136:137] op_sel:[0,1] op_sel_hi:[1,1]
  v_pk_fma_f32 v[214:215], v[28:29], v[136:137], v[214:215] op_sel:[0,0,0] op_sel_hi:[1,0,1]
  v_cvt_pk_bf16_f32 v190, v214, v215
  v_pk_mul_f32 v[216:217], v[6:7], v[136:137] op_sel:[0,1] op_sel_hi:[1,1]
  v_pk_fma_f32 v[216:217], v[30:31], v[136:137], v[216:217] op_sel:[0,0,0] op_sel_hi:[1,0,1]
  v_cvt_pk_bf16_f32 v191, v216, v217
  v_pk_mul_f32 v[218:219], v[176:177], v[12:13] op_sel:[0,0] op_sel_hi:[1,0]
  v_pk_fma_f32 v[218:219], v[68:69], v[156:157], v[218:219]
  v_cvt_pk_bf16_f32 v210, v218, v219
  v_pk_mul_f32 v[212:213], v[178:179], v[12:13] op_sel:[0,0] op_sel_hi:[1,0]
  v_pk_fma_f32 v[212:213], v[70:71], v[158:159], v[212:213]
  v_cvt_pk_bf16_f32 v211, v212, v213
  v_mfma_f32_16x16x16_bf16 v[16:19], v[192:193], v[184:185], 0
  v_mfma_f32_16x16x16_bf16 v[20:23], v[194:195], v[184:185], 0
  v_mfma_f32_16x16x16_bf16 v[24:27], v[194:195], v[186:187], 0
  v_mfma_f32_16x16x16_bf16 v[28:31], v[196:197], v[186:187], 0
  v_mfma_f32_16x16x16_bf16 v[32:35], v[196:197], v[188:189], 0
  v_mfma_f32_16x16x16_bf16 v[36:39], v[198:199], v[188:189], 0
  v_mfma_f32_16x16x16_bf16 v[40:43], v[198:199], v[190:191], 0
  v_mfma_f32_16x16x16_bf16 v[44:47], v[200:201], v[190:191], 0
  s_mov_b32 s52, 0x3eb8aa3b
  v_lshrrev_b32 v180, 1, v3
  s_lshl_b32 s50, s44, 1
  v_add_u32 v180, s50, v180
  v_and_b32 v181, 7, v2
  v_xor_b32 v180, v180, v181
  v_cndmask_b32 v48, v16, v17, s[68:69]
  v_cndmask_b32 v49, v18, v19, s[68:69]
  v_cndmask_b32 v50, v20, v21, s[68:69]
  v_cndmask_b32 v51, v22, v23, s[68:69]
  v_cndmask_b32 v52, v24, v25, s[68:69]
  v_cndmask_b32 v53, v26, v27, s[68:69]
  v_cndmask_b32 v54, v28, v29, s[68:69]
  v_cndmask_b32 v55, v30, v31, s[68:69]
  v_cndmask_b32 v56, v32, v33, s[68:69]
  v_cndmask_b32 v57, v34, v35, s[68:69]
  v_cndmask_b32 v58, v36, v37, s[68:69]
  v_cndmask_b32 v59, v38, v39, s[68:69]
  s_nop 1
  v_cndmask_b32 v60, v40, v41, s[68:69]
  v_cndmask_b32 v61, v42, v43, s[68:69]
  v_cndmask_b32 v62, v44, v45, s[68:69]
  v_cndmask_b32 v63, v46, v47, s[68:69]
  v_pk_fma_f32 v[48:49], v[48:49], s[52:53], v[244:245] op_sel_hi:[1,0,1]
  v_pk_fma_f32 v[50:51], v[50:51], s[52:53], v[242:243] op_sel_hi:[1,0,1]
  v_pk_fma_f32 v[52:53], v[52:53], s[52:53], v[240:241] op_sel_hi:[1,0,1]
  v_pk_fma_f32 v[54:55], v[54:55], s[52:53], v[242:243] op_sel_hi:[1,0,1]
  v_pk_fma_f32 v[56:57], v[56:57], s[52:53], v[240:241] op_sel_hi:[1,0,1]
  v_pk_fma_f32 v[58:59], v[58:59], s[52:53], v[242:243] op_sel_hi:[1,0,1]
  v_pk_fma_f32 v[60:61], v[60:61], s[52:53], v[240:241] op_sel_hi:[1,0,1]
  v_pk_fma_f32 v[62:63], v[62:63], s[52:53], v[242:243] op_sel_hi:[1,0,1]
  v_max3_f32 v64, v48, v49, v50
  v_max3_f32 v65, v52, v53, v54
  v_max3_f32 v66, v56, v57, v58
  v_max3_f32 v67, v60, v61, v62
  v_max_f32 v64, v64, v51
  v_max_f32 v65, v65, v55
  v_max_f32 v66, v66, v59
  v_max_f32 v67, v67, v63
  v_mov_b32 v68, v64
  v_mov_b32 v69, v65
  v_mov_b32 v70, v66
  v_mov_b32 v71, v67
  v_permlane16_swap_b32 v64, v68
  v_permlane16_swap_b32 v65, v69
  v_permlane16_swap_b32 v66, v70
  v_permlane16_swap_b32 v67, v71
  v_max_f32 v64, v64, v68
  v_max_f32 v65, v65, v69
  v_max_f32 v66, v66, v70
  v_max_f32 v67, v67, v71
  v_mov_b32 v68, v64
  v_mov_b32 v69, v65
  v_mov_b32 v70, v66
  v_mov_b32 v71, v67
  v_permlane32_swap_b32 v64, v68
  v_permlane32_swap_b32 v65, v69
  v_permlane32_swap_b32 v66, v70
  v_permlane32_swap_b32 v67, v71
  v_max_f32 v64, v64, v68
  v_max_f32 v65, v65, v69
  v_max_f32 v66, v66, v70
  v_max_f32 v67, v67, v71
  v_pk_add_f32 v[48:49], v[48:49], v[64:65] op_sel:[0,0] op_sel_hi:[1,0] neg_lo:[0,1] neg_hi:[0,1]
  v_pk_add_f32 v[50:51], v[50:51], v[64:65] op_sel:[0,0] op_sel_hi:[1,0] neg_lo:[0,1] neg_hi:[0,1]
  v_pk_add_f32 v[52:53], v[52:53], v[64:65] op_sel:[0,1] op_sel_hi:[1,1] neg_lo:[0,1] neg_hi:[0,1]
  v_pk_add_f32 v[54:55], v[54:55], v[64:65] op_sel:[0,1] op_sel_hi:[1,1] neg_lo:[0,1] neg_hi:[0,1]
  v_pk_add_f32 v[56:57], v[56:57], v[66:67] op_sel:[0,0] op_sel_hi:[1,0] neg_lo:[0,1] neg_hi:[0,1]
  v_pk_add_f32 v[58:59], v[58:59], v[66:67] op_sel:[0,0] op_sel_hi:[1,0] neg_lo:[0,1] neg_hi:[0,1]
  v_pk_add_f32 v[60:61], v[60:61], v[66:67] op_sel:[0,1] op_sel_hi:[1,1] neg_lo:[0,1] neg_hi:[0,1]
  v_pk_add_f32 v[62:63], v[62:63], v[66:67] op_sel:[0,1] op_sel_hi:[1,1] neg_lo:[0,1] neg_hi:[0,1]
  v_exp_f32 v48, v48
  v_exp_f32 v49, v49
  v_exp_f32 v50, v50
  v_exp_f32 v51, v51
  v_exp_f32 v52, v52
  v_exp_f32 v53, v53
  v_exp_f32 v54, v54
  v_exp_f32 v55, v55
  v_exp_f32 v56, v56
  v_exp_f32 v57, v57
  v_exp_f32 v58, v58
  v_exp_f32 v59, v59
  v_exp_f32 v60, v60
  v_exp_f32 v61, v61
  v_exp_f32 v62, v62
  v_exp_f32 v63, v63
  v_lshlrev_b32 v180, 4, v180
  v_pk_mul_f32 v[18:19], v[246:247], v[48:49] op_sel:[0,0] op_sel_hi:[1,0]
  v_cvt_pk_bf16_f32 v72, v18, v19
  v_pk_mul_f32 v[20:21], v[246:247], v[48:49] op_sel:[0,1] op_sel_hi:[1,1]
  v_cvt_pk_bf16_f32 v73, v20, v21
  v_pk_mul_f32 v[22:23], v[246:247], v[50:51] op_sel:[0,0] op_sel_hi:[1,0]
  v_cvt_pk_bf16_f32 v74, v22, v23
  v_pk_mul_f32 v[16:17], v[246:247], v[50:51] op_sel:[0,1] op_sel_hi:[1,1]
  v_cvt_pk_bf16_f32 v75, v16, v17
  v_pk_mul_f32 v[18:19], v[246:247], v[52:53] op_sel:[0,0] op_sel_hi:[1,0]
  v_cvt_pk_bf16_f32 v76, v18, v19
  v_pk_mul_f32 v[20:21], v[246:247], v[52:53] op_sel:[0,1] op_sel_hi:[1,1]
  v_cvt_pk_bf16_f32 v77, v20, v21
  v_pk_mul_f32 v[22:23], v[246:247], v[54:55] op_sel:[0,0] op_sel_hi:[1,0]
  v_cvt_pk_bf16_f32 v78, v22, v23
  v_pk_mul_f32 v[16:17], v[246:247], v[54:55] op_sel:[0,1] op_sel_hi:[1,1]
  v_cvt_pk_bf16_f32 v79, v16, v17
  v_pk_mul_f32 v[18:19], v[246:247], v[56:57] op_sel:[0,0] op_sel_hi:[1,0]
  v_cvt_pk_bf16_f32 v80, v18, v19
  v_pk_mul_f32 v[20:21], v[246:247], v[56:57] op_sel:[0,1] op_sel_hi:[1,1]
  v_cvt_pk_bf16_f32 v81, v20, v21
  v_pk_mul_f32 v[22:23], v[246:247], v[58:59] op_sel:[0,0] op_sel_hi:[1,0]
  v_cvt_pk_bf16_f32 v82, v22, v23
  v_pk_mul_f32 v[16:17], v[246:247], v[58:59] op_sel:[0,1] op_sel_hi:[1,1]
  v_cvt_pk_bf16_f32 v83, v16, v17
  v_pk_mul_f32 v[18:19], v[246:247], v[60:61] op_sel:[0,0] op_sel_hi:[1,0]
  v_cvt_pk_bf16_f32 v84, v18, v19
  v_pk_mul_f32 v[20:21], v[246:247], v[60:61] op_sel:[0,1] op_sel_hi:[1,1]
  v_cvt_pk_bf16_f32 v85, v20, v21
  v_pk_mul_f32 v[22:23], v[246:247], v[62:63] op_sel:[0,0] op_sel_hi:[1,0]
  v_cvt_pk_bf16_f32 v86, v22, v23
  v_pk_mul_f32 v[16:17], v[246:247], v[62:63] op_sel:[0,1] op_sel_hi:[1,1]
  v_cvt_pk_bf16_f32 v87, v16, v17
  v_and_b32 v181, 1, v3
  v_lshl_add_u32 v180, v181, 3, v180
  v_mfma_f32_16x16x32_bf16 v[104:107], v[248:251], v[72:75], 0
  v_mfma_f32_16x16x32_bf16 v[88:91], v[202:205], v[72:75], 0
  v_mfma_f32_16x16x32_bf16 v[108:111], v[248:251], v[76:79], 0
  v_mfma_f32_16x16x32_bf16 v[92:95], v[204:207], v[76:79], 0
  v_mfma_f32_16x16x32_bf16 v[112:115], v[248:251], v[80:83], 0
  v_mfma_f32_16x16x32_bf16 v[96:99], v[206:209], v[80:83], 0
  v_mfma_f32_16x16x32_bf16 v[116:119], v[248:251], v[84:87], 0
  v_mfma_f32_16x16x32_bf16 v[100:103], v[208:211], v[84:87], 0
  v_lshl_add_u32 v180, v2, 7, v180
  v_add_u32 v180, 65536, v180
  s_nop 1
  v_rcp_f32 v104, v104
  v_rcp_f32 v108, v108
  v_rcp_f32 v112, v112
  v_rcp_f32 v116, v116
  s_nop 0
  v_pk_mul_f32 v[88:89], v[88:89], v[104:105] op_sel_hi:[1,0]
  v_pk_mul_f32 v[90:91], v[90:91], v[104:105] op_sel_hi:[1,0]
  v_cvt_pk_bf16_f32 v24, v88, v89
  v_cvt_pk_bf16_f32 v25, v90, v91
  ds_write_b64 v180, v[24:25] offset:0
  v_pk_mul_f32 v[92:93], v[92:93], v[108:109] op_sel_hi:[1,0]
  v_pk_mul_f32 v[94:95], v[94:95], v[108:109] op_sel_hi:[1,0]
  v_cvt_pk_bf16_f32 v26, v92, v93
  v_cvt_pk_bf16_f32 v27, v94, v95
  ds_write_b64 v180, v[26:27] offset:2048
  v_pk_mul_f32 v[96:97], v[96:97], v[112:113] op_sel_hi:[1,0]
  v_pk_mul_f32 v[98:99], v[98:99], v[112:113] op_sel_hi:[1,0]
  v_cvt_pk_bf16_f32 v28, v96, v97
  v_cvt_pk_bf16_f32 v29, v98, v99
  ds_write_b64 v180, v[28:29] offset:4096
  v_pk_mul_f32 v[100:101], v[100:101], v[116:117] op_sel_hi:[1,0]
  v_pk_mul_f32 v[102:103], v[102:103], v[116:117] op_sel_hi:[1,0]
  v_cvt_pk_bf16_f32 v30, v100, v101
  v_cvt_pk_bf16_f32 v31, v102, v103
  ds_write_b64 v180, v[30:31] offset:6144
  v_lshrrev_b32 v180, 3, v0
  v_and_b32 v181, 7, v0
  v_and_b32 v182, 7, v180
  v_xor_b32 v182, v182, v181
  v_lshlrev_b32 v182, 4, v182
  v_lshl_add_u32 v182, v180, 7, v182
  v_add_u32 v182, 65536, v182
  v_add_u32 v180, s49, v180
  v_lshlrev_b32 v180, 10, v180
  v_lshl_add_u32 v180, v181, 4, v180
  s_lshl_b32 s50, s45, 7
  s_add_u32 s50, s50, 1048576
  s_add_u32 s51, s50, 32768
  s_waitcnt lgkmcnt(0)
  s_barrier
  ds_read_b128 v[184:187], v182
  ds_read_b128 v[188:191], v182 offset:4096
  s_cmp_eq_u32 s78, 0
  s_cbranch_scc1 L_osl_33
  s_waitcnt lgkmcnt(1)
  buffer_store_dwordx4 v[184:187], v180, s[16:19], s50 offen
  s_waitcnt lgkmcnt(0)
  buffer_store_dwordx4 v[188:191], v180, s[16:19], s51 offen
  s_branch L_osd_34
L_osl_33:
  s_waitcnt lgkmcnt(1)
  buffer_store_dwordx4 v[184:187], v180, s[16:19], s50 offen sc1
  s_waitcnt lgkmcnt(0)
  buffer_store_dwordx4 v[188:191], v180, s[16:19], s51 offen sc1
L_osd_34:
  s_waitcnt vmcnt(0) lgkmcnt(0)
  s_barrier
  s_cmp_lg_u32 s44, 0
  s_cbranch_scc1 L_fs_35
  s_mov_b64 exec, 1
  s_lshl_b32 s50, s2, 6
  s_add_u32 s50, s50, 49152
  v_mov_b32 v252, 0
  v_mov_b32 v253, 1
  s_cmp_eq_u32 s78, 0
  s_cbranch_scc1 L_fsl_36
  buffer_store_dword v253, v252, s[16:19], s50 offen
  s_branch L_fsd_37
L_fsl_36:
  buffer_store_dword v253, v252, s[16:19], s50 offen sc1
L_fsd_37:
  s_mov_b64 exec, -1
L_fs_35:
  v_lshrrev_b32 v70, 3, v1
  v_and_b32 v71, 7, v1
  s_lshl_b32 s50, s44, 4
  v_add_u32 v72, s50, v70
  v_lshrrev_b32 v73, 1, v72
  v_and_b32 v73, 1, v73
  v_lshrrev_b32 v66, 3, v72
  v_and_b32 v66, 3, v66
  v_lshl_or_b32 v73, v66, 1, v73
  v_xor_b32 v73, v73, v71
  v_lshlrev_b32 v73, 4, v73
  v_add_u32 v72, s49, v72
  v_lshl_add_u32 v66, v72, 10, v73
  s_lshl_b32 s50, s44, 4
  s_add_u32 s50, s50, 8
  v_add_u32 v72, s50, v70
  v_lshrrev_b32 v73, 1, v72
  v_and_b32 v73, 1, v73
  v_lshrrev_b32 v67, 3, v72
  v_and_b32 v67, 3, v67
  v_lshl_or_b32 v73, v67, 1, v73
  v_xor_b32 v73, v73, v71
  v_lshlrev_b32 v73, 4, v73
  v_add_u32 v72, s49, v72
  v_lshl_add_u32 v67, v72, 10, v73
  v_lshrrev_b32 v72, 2, v2
  v_lshrrev_b32 v73, 1, v2
  v_and_b32 v73, 1, v73
  v_lshl_or_b32 v73, v72, 1, v73
  v_add_u32 v70, 0, v3
  v_xor_b32 v73, v73, v70
  v_lshlrev_b32 v73, 4, v73
  v_and_b32 v70, 3, v2
  v_lshl_add_u32 v72, v72, 3, v70
  v_lshl_add_u32 v64, v72, 7, v73
  v_lshrrev_b32 v72, 2, v2
  v_lshrrev_b32 v73, 1, v2
  v_and_b32 v73, 1, v73
  v_lshl_or_b32 v73, v72, 1, v73
  v_add_u32 v70, 4, v3
  v_xor_b32 v73, v73, v70
  v_lshlrev_b32 v73, 4, v73
  v_and_b32 v70, 3, v2
  v_lshl_add_u32 v72, v72, 3, v70
  v_lshl_add_u32 v65, v72, 7, v73
  v_mov_b64 v[16:17], 0
  v_mov_b64 v[18:19], 0
  v_mov_b64 v[20:21], 0
  v_mov_b64 v[22:23], 0
  v_mov_b64 v[24:25], 0
  v_mov_b64 v[26:27], 0
  v_mov_b64 v[28:29], 0
  v_mov_b64 v[30:31], 0
  s_lshl_b32 s50, s45, 6
  s_lshl_b32 s51, s44, 4
  s_add_u32 s50, s50, s51
  v_add_u32 v68, s50, v2
  v_lshlrev_b32 v68, 12, v68
  v_lshl_add_u32 v68, v3, 4, v68
  v_lshrrev_b32 v72, 3, v2
  v_lshlrev_b32 v72, 5, v72
  v_lshl_add_u32 v72, v3, 3, v72
  v_and_b32 v73, 7, v2
  v_add3_u32 v72, v72, v73, s49
  v_lshlrev_b32 v69, 2, v72
  s_lshl_b32 s50, s49, 1
  s_add_u32 s50, s50, 5242880
  buffer_load_dwordx4 v[232:235], v68, s[16:19], s50 offen sc1
  buffer_load_dwordx4 v[236:239], v68, s[16:19], s50 offen offset:64 sc1
  s_cmp_lg_u32 s44, 0
  s_cbranch_scc1 L_wc_38
  s_mov_b64 exec, 0xff
  s_lshl_b32 s50, s58, 6
  s_and_b32 s51, s2, 7
  s_add_u32 s50, s50, s51
  s_lshl_b32 s50, s50, 6
  s_add_u32 s50, s50, 49152
  v_lshlrev_b32 v252, 9, v1
  s_mov_b32 s74, 0
L_poll_39:
  buffer_load_dword v253, v252, s[16:19], s50 offen sc1
  s_waitcnt vmcnt(0)
  v_cmp_gt_u32 vcc, 1, v253
  s_cbranch_vccz L_pdone_40
  s_add_u32 s74, s74, 1
  s_cmp_lt_u32 s74, 1048576
  s_cbranch_scc1 L_poll_39
L_pdone_40:
  s_mov_b64 exec, -1
L_wc_38:
  s_barrier
  s_lshl_b32 s71, s44, 11
  s_add_u32 s75, s45, 0
  s_and_b32 s75, s75, 7
  s_lshl_b32 s75, s75, 7
  s_add_u32 s75, s75, 1048576
  s_add_u32 m0, s71, 0
  s_nop 0
  buffer_load_dwordx4 v66, s[16:19], s75 offen sc1 lds
  s_add_u32 m0, s71, 1024
  s_nop 0
  buffer_load_dwordx4 v67, s[16:19], s75 offen sc1 lds
  s_add_u32 s75, s45, 1
  s_and_b32 s75, s75, 7
  s_lshl_b32 s75, s75, 7
  s_add_u32 s75, s75, 1048576
  s_add_u32 m0, s71, 8192
  s_nop 0
  buffer_load_dwordx4 v66, s[16:19], s75 offen sc1 lds
  s_add_u32 m0, s71, 9216
  s_nop 0
  buffer_load_dwordx4 v67, s[16:19], s75 offen sc1 lds
  s_add_u32 s75, s45, 2
  s_and_b32 s75, s75, 7
  s_lshl_b32 s75, s75, 7
  s_add_u32 s75, s75, 1048576
  s_add_u32 m0, s71, 16384
  s_nop 0
  buffer_load_dwordx4 v66, s[16:19], s75 offen sc1 lds
  s_add_u32 m0, s71, 17408
  s_nop 0
  buffer_load_dwordx4 v67, s[16:19], s75 offen sc1 lds
  s_add_u32 s75, s45, 3
  s_and_b32 s75, s75, 7
  s_lshl_b32 s75, s75, 7
  s_add_u32 s75, s75, 1048576
  s_add_u32 m0, s71, 24576
  s_nop 0
  buffer_load_dwordx4 v66, s[16:19], s75 offen sc1 lds
  s_add_u32 m0, s71, 25600
  s_nop 0
  buffer_load_dwordx4 v67, s[16:19], s75 offen sc1 lds
  s_waitcnt vmcnt(6)
  s_barrier
  ds_read_b128 v[32:35], v64 offset:0
  ds_read_b128 v[36:39], v64 offset:512
  ds_read_b128 v[40:43], v64 offset:4096
  ds_read_b128 v[44:47], v64 offset:4608
  s_waitcnt lgkmcnt(3)
  v_mfma_f32_16x16x32_bf16 v[16:19], v[32:35], a[192:195], v[16:19]
  ds_read_b128 v[48:51], v65 offset:0
  s_waitcnt lgkmcnt(3)
  v_mfma_f32_16x16x32_bf16 v[20:23], v[36:39], a[192:195], v[20:23]
  ds_read_b128 v[52:55], v65 offset:512
  s_add_u32 s75, s45, 4
  s_and_b32 s75, s75, 7
  s_lshl_b32 s75, s75, 7
  s_add_u32 s75, s75, 1048576
  s_add_u32 m0, s71, 32768
  s_nop 0
  buffer_load_dwordx4 v66, s[16:19], s75 offen sc1 lds
  s_waitcnt lgkmcnt(3)
  v_mfma_f32_16x16x32_bf16 v[24:27], v[40:43], a[192:195], v[24:27]
  ds_read_b128 v[56:59], v65 offset:4096
  s_waitcnt lgkmcnt(3)
  v_mfma_f32_16x16x32_bf16 v[28:31], v[44:47], a[192:195], v[28:31]
  ds_read_b128 v[60:63], v65 offset:4608
  s_add_u32 m0, s71, 33792
  s_nop 0
  buffer_load_dwordx4 v67, s[16:19], s75 offen sc1 lds
  s_waitcnt vmcnt(4)
  s_barrier
  s_waitcnt lgkmcnt(3)
  v_mfma_f32_16x16x32_bf16 v[16:19], v[48:51], a[196:199], v[16:19]
  ds_read_b128 v[32:35], v64 offset:8192
  s_waitcnt lgkmcnt(3)
  v_mfma_f32_16x16x32_bf16 v[20:23], v[52:55], a[196:199], v[20:23]
  ds_read_b128 v[36:39], v64 offset:8704
  s_add_u32 s75, s45, 5
  s_and_b32 s75, s75, 7
  s_lshl_b32 s75, s75, 7
  s_add_u32 s75, s75, 1048576
  s_add_u32 m0, s71, 40960
  s_nop 0
  buffer_load_dwordx4 v66, s[16:19], s75 offen sc1 lds
  s_waitcnt lgkmcnt(3)
  v_mfma_f32_16x16x32_bf16 v[24:27], v[56:59], a[196:199], v[24:27]
  ds_read_b128 v[40:43], v64 offset:12288
  s_waitcnt lgkmcnt(3)
  v_mfma_f32_16x16x32_bf16 v[28:31], v[60:63], a[196:199], v[28:31]
  ds_read_b128 v[44:47], v64 offset:12800
  s_add_u32 m0, s71, 41984
  s_nop 0
  buffer_load_dwordx4 v67, s[16:19], s75 offen sc1 lds
  s_waitcnt lgkmcnt(3)
  v_mfma_f32_16x16x32_bf16 v[16:19], v[32:35], a[200:203], v[16:19]
  ds_read_b128 v[48:51], v65 offset:8192
  s_waitcnt lgkmcnt(3)
  v_mfma_f32_16x16x32_bf16 v[20:23], v[36:39], a[200:203], v[20:23]
  ds_read_b128 v[52:55], v65 offset:8704
  s_add_u32 s75, s45, 6
  s_and_b32 s75, s75, 7
  s_lshl_b32 s75, s75, 7
  s_add_u32 s75, s75, 1048576
  s_add_u32 m0, s71, 49152
  s_nop 0
  buffer_load_dwordx4 v66, s[16:19], s75 offen sc1 lds
  s_waitcnt lgkmcnt(3)
  v_mfma_f32_16x16x32_bf16 v[24:27], v[40:43], a[200:203], v[24:27]
  ds_read_b128 v[56:59], v65 offset:12288
  s_waitcnt lgkmcnt(3)
  v_mfma_f32_16x16x32_bf16 v[28:31], v[44:47], a[200:203], v[28:31]
  ds_read_b128 v[60:63], v65 offset:12800
  s_add_u32 m0, s71, 50176
  s_nop 0
  buffer_load_dwordx4 v67, s[16:19], s75 offen sc1 lds
  s_waitcnt lgkmcnt(3)
  v_mfma_f32_16x16x32_bf16 v[16:19], v[48:51], a[204:207], v[16:19]
  ds_read_b128 v[32:35], v64 offset:16384
  s_waitcnt lgkmcnt(3)
  v_mfma_f32_16x16x32_bf16 v[20:23], v[52:55], a[204:207], v[20:23]
  ds_read_b128 v[36:39], v64 offset:16896
  s_add_u32 s75, s45, 7
  s_and_b32 s75, s75, 7
  s_lshl_b32 s75, s75, 7
  s_add_u32 s75, s75, 1048576
  s_add_u32 m0, s71, 57344
  s_nop 0
  buffer_load_dwordx4 v66, s[16:19], s75 offen sc1 lds
  s_waitcnt lgkmcnt(3)
  v_mfma_f32_16x16x32_bf16 v[24:27], v[56:59], a[204:207], v[24:27]
  ds_read_b128 v[40:43], v64 offset:20480
  s_waitcnt lgkmcnt(3)
  v_mfma_f32_16x16x32_bf16 v[28:31], v[60:63], a[204:207], v[28:31]
  ds_read_b128 v[44:47], v64 offset:20992
  s_add_u32 m0, s71, 58368
  s_nop 0
  buffer_load_dwordx4 v67, s[16:19], s75 offen sc1 lds
  s_waitcnt lgkmcnt(3)
  v_mfma_f32_16x16x32_bf16 v[16:19], v[32:35], a[208:211], v[16:19]
  ds_read_b128 v[48:51], v65 offset:16384
  s_waitcnt lgkmcnt(3)
  v_mfma_f32_16x16x32_bf16 v[20:23], v[36:39], a[208:211], v[20:23]
  ds_read_b128 v[52:55], v65 offset:16896
  s_waitcnt lgkmcnt(3)
  v_mfma_f32_16x16x32_bf16 v[24:27], v[40:43], a[208:211], v[24:27]
  ds_read_b128 v[56:59], v65 offset:20480
  s_waitcnt lgkmcnt(3)
  v_mfma_f32_16x16x32_bf16 v[28:31], v[44:47], a[208:211], v[28:31]
  ds_read_b128 v[60:63], v65 offset:20992
  s_waitcnt vmcnt(6)
  s_barrier
  s_waitcnt lgkmcnt(3)
  v_mfma_f32_16x16x32_bf16 v[16:19], v[48:51], a[212:215], v[16:19]
  ds_read_b128 v[32:35], v64 offset:24576
  s_waitcnt lgkmcnt(3)
  v_mfma_f32_16x16x32_bf16 v[20:23], v[52:55], a[212:215], v[20:23]
  ds_read_b128 v[36:39], v64 offset:25088
  s_waitcnt lgkmcnt(3)
  v_mfma_f32_16x16x32_bf16 v[24:27], v[56:59], a[212:215], v[24:27]
  ds_read_b128 v[40:43], v64 offset:28672
  s_waitcnt lgkmcnt(3)
  v_mfma_f32_16x16x32_bf16 v[28:31], v[60:63], a[212:215], v[28:31]
  ds_read_b128 v[44:47], v64 offset:29184
  s_waitcnt lgkmcnt(3)
  v_mfma_f32_16x16x32_bf16 v[16:19], v[32:35], a[216:219], v[16:19]
  ds_read_b128 v[48:51], v65 offset:24576
  s_waitcnt lgkmcnt(3)
  v_mfma_f32_16x16x32_bf16 v[20:23], v[36:39], a[216:219], v[20:23]
  ds_read_b128 v[52:55], v65 offset:25088
  s_waitcnt lgkmcnt(3)
  v_mfma_f32_16x16x32_bf16 v[24:27], v[40:43], a[216:219], v[24:27]
  ds_read_b128 v[56:59], v65 offset:28672
  s_waitcnt lgkmcnt(3)
  v_mfma_f32_16x16x32_bf16 v[28:31], v[44:47], a[216:219], v[28:31]
  ds_read_b128 v[60:63], v65 offset:29184
  s_waitcnt lgkmcnt(3)
  v_mfma_f32_16x16x32_bf16 v[16:19], v[48:51], a[220:223], v[16:19]
  ds_read_b128 v[32:35], v64 offset:32768
  s_waitcnt lgkmcnt(3)
  v_mfma_f32_16x16x32_bf16 v[20:23], v[52:55], a[220:223], v[20:23]
  ds_read_b128 v[36:39], v64 offset:33280
  s_waitcnt lgkmcnt(3)
  v_mfma_f32_16x16x32_bf16 v[24:27], v[56:59], a[220:223], v[24:27]
  ds_read_b128 v[40:43], v64 offset:36864
  s_waitcnt lgkmcnt(3)
  v_mfma_f32_16x16x32_bf16 v[28:31], v[60:63], a[220:223], v[28:31]
  ds_read_b128 v[44:47], v64 offset:37376
  s_waitcnt lgkmcnt(3)
  v_mfma_f32_16x16x32_bf16 v[16:19], v[32:35], a[224:227], v[16:19]
  ds_read_b128 v[48:51], v65 offset:32768
  s_waitcnt lgkmcnt(3)
  v_mfma_f32_16x16x32_bf16 v[20:23], v[36:39], a[224:227], v[20:23]
  ds_read_b128 v[52:55], v65 offset:33280
  s_waitcnt lgkmcnt(3)
  v_mfma_f32_16x16x32_bf16 v[24:27], v[40:43], a[224:227], v[24:27]
  ds_read_b128 v[56:59], v65 offset:36864
  s_waitcnt lgkmcnt(3)
  v_mfma_f32_16x16x32_bf16 v[28:31], v[44:47], a[224:227], v[28:31]
  ds_read_b128 v[60:63], v65 offset:37376
  s_waitcnt vmcnt(0)
  s_barrier
  s_waitcnt lgkmcnt(3)
  v_mfma_f32_16x16x32_bf16 v[16:19], v[48:51], a[228:231], v[16:19]
  ds_read_b128 v[32:35], v64 offset:40960
  s_waitcnt lgkmcnt(3)
  v_mfma_f32_16x16x32_bf16 v[20:23], v[52:55], a[228:231], v[20:23]
  ds_read_b128 v[36:39], v64 offset:41472
  s_waitcnt lgkmcnt(3)
  v_mfma_f32_16x16x32_bf16 v[24:27], v[56:59], a[228:231], v[24:27]
  ds_read_b128 v[40:43], v64 offset:45056
  s_waitcnt lgkmcnt(3)
  v_mfma_f32_16x16x32_bf16 v[28:31], v[60:63], a[228:231], v[28:31]
  ds_read_b128 v[44:47], v64 offset:45568
  s_waitcnt lgkmcnt(3)
  v_mfma_f32_16x16x32_bf16 v[16:19], v[32:35], a[232:235], v[16:19]
  ds_read_b128 v[48:51], v65 offset:40960
  s_waitcnt lgkmcnt(3)
  v_mfma_f32_16x16x32_bf16 v[20:23], v[36:39], a[232:235], v[20:23]
  ds_read_b128 v[52:55], v65 offset:41472
  s_waitcnt lgkmcnt(3)
  v_mfma_f32_16x16x32_bf16 v[24:27], v[40:43], a[232:235], v[24:27]
  ds_read_b128 v[56:59], v65 offset:45056
  s_waitcnt lgkmcnt(3)
  v_mfma_f32_16x16x32_bf16 v[28:31], v[44:47], a[232:235], v[28:31]
  ds_read_b128 v[60:63], v65 offset:45568
  s_waitcnt lgkmcnt(3)
  v_mfma_f32_16x16x32_bf16 v[16:19], v[48:51], a[236:239], v[16:19]
  ds_read_b128 v[32:35], v64 offset:49152
  s_waitcnt lgkmcnt(3)
  v_mfma_f32_16x16x32_bf16 v[20:23], v[52:55], a[236:239], v[20:23]
  ds_read_b128 v[36:39], v64 offset:49664
  s_waitcnt lgkmcnt(3)
  v_mfma_f32_16x16x32_bf16 v[24:27], v[56:59], a[236:239], v[24:27]
  ds_read_b128 v[40:43], v64 offset:53248
  s_waitcnt lgkmcnt(3)
  v_mfma_f32_16x16x32_bf16 v[28:31], v[60:63], a[236:239], v[28:31]
  ds_read_b128 v[44:47], v64 offset:53760
  s_waitcnt lgkmcnt(3)
  v_mfma_f32_16x16x32_bf16 v[16:19], v[32:35], a[240:243], v[16:19]
  ds_read_b128 v[48:51], v65 offset:49152
  s_waitcnt lgkmcnt(3)
  v_mfma_f32_16x16x32_bf16 v[20:23], v[36:39], a[240:243], v[20:23]
  ds_read_b128 v[52:55], v65 offset:49664
  s_waitcnt lgkmcnt(3)
  v_mfma_f32_16x16x32_bf16 v[24:27], v[40:43], a[240:243], v[24:27]
  ds_read_b128 v[56:59], v65 offset:53248
  s_waitcnt lgkmcnt(3)
  v_mfma_f32_16x16x32_bf16 v[28:31], v[44:47], a[240:243], v[28:31]
  ds_read_b128 v[60:63], v65 offset:53760
  s_waitcnt lgkmcnt(3)
  v_mfma_f32_16x16x32_bf16 v[16:19], v[48:51], a[244:247], v[16:19]
  ds_read_b128 v[32:35], v64 offset:57344
  s_waitcnt lgkmcnt(3)
  v_mfma_f32_16x16x32_bf16 v[20:23], v[52:55], a[244:247], v[20:23]
  ds_read_b128 v[36:39], v64 offset:57856
  s_waitcnt lgkmcnt(3)
  v_mfma_f32_16x16x32_bf16 v[24:27], v[56:59], a[244:247], v[24:27]
  ds_read_b128 v[40:43], v64 offset:61440
  s_waitcnt lgkmcnt(3)
  v_mfma_f32_16x16x32_bf16 v[28:31], v[60:63], a[244:247], v[28:31]
  ds_read_b128 v[44:47], v64 offset:61952
  s_waitcnt lgkmcnt(3)
  v_mfma_f32_16x16x32_bf16 v[16:19], v[32:35], a[248:251], v[16:19]
  ds_read_b128 v[48:51], v65 offset:57344
  s_waitcnt lgkmcnt(3)
  v_mfma_f32_16x16x32_bf16 v[20:23], v[36:39], a[248:251], v[20:23]
  ds_read_b128 v[52:55], v65 offset:57856
  s_waitcnt lgkmcnt(3)
  v_mfma_f32_16x16x32_bf16 v[24:27], v[40:43], a[248:251], v[24:27]
  ds_read_b128 v[56:59], v65 offset:61440
  s_waitcnt lgkmcnt(3)
  v_mfma_f32_16x16x32_bf16 v[28:31], v[44:47], a[248:251], v[28:31]
  ds_read_b128 v[60:63], v65 offset:61952
  s_waitcnt lgkmcnt(3)
  v_mfma_f32_16x16x32_bf16 v[16:19], v[48:51], a[252:255], v[16:19]
  s_waitcnt lgkmcnt(2)
  v_mfma_f32_16x16x32_bf16 v[20:23], v[52:55], a[252:255], v[20:23]
  s_waitcnt lgkmcnt(1)
  v_mfma_f32_16x16x32_bf16 v[24:27], v[56:59], a[252:255], v[24:27]
  s_waitcnt lgkmcnt(0)
  v_mfma_f32_16x16x32_bf16 v[28:31], v[60:63], a[252:255], v[28:31]
  v_lshlrev_b32 v80, 16, v232
  v_and_b32 v81, s70, v232
  v_lshlrev_b32 v82, 16, v233
  v_and_b32 v83, s70, v233
  v_lshlrev_b32 v84, 16, v234
  v_and_b32 v85, s70, v234
  v_lshlrev_b32 v86, 16, v235
  v_and_b32 v87, s70, v235
  v_lshlrev_b32 v88, 16, v236
  v_and_b32 v89, s70, v236
  v_lshlrev_b32 v90, 16, v237
  v_and_b32 v91, s70, v237
  v_lshlrev_b32 v92, 16, v238
  v_and_b32 v93, s70, v238
  v_lshlrev_b32 v94, 16, v239
  v_and_b32 v95, s70, v239
  v_pk_add_f32 v[80:81], v[80:81], v[16:17]
  v_pk_add_f32 v[82:83], v[82:83], v[18:19]
  v_pk_add_f32 v[84:85], v[84:85], v[20:21]
  v_pk_add_f32 v[86:87], v[86:87], v[22:23]
  v_pk_add_f32 v[88:89], v[88:89], v[24:25]
  v_pk_add_f32 v[90:91], v[90:91], v[26:27]
  v_pk_add_f32 v[92:93], v[92:93], v[28:29]
  v_pk_add_f32 v[94:95], v[94:95], v[30:31]
  v_cvt_pk_bf16_f32 v100, v80, v81
  v_cvt_pk_bf16_f32 v101, v82, v83
  v_cvt_pk_bf16_f32 v102, v84, v85
  v_cvt_pk_bf16_f32 v103, v86, v87
  v_cvt_pk_bf16_f32 v104, v88, v89
  v_cvt_pk_bf16_f32 v105, v90, v91
  v_cvt_pk_bf16_f32 v106, v92, v93
  v_cvt_pk_bf16_f32 v107, v94, v95
  s_lshl_b32 s50, s49, 1
  s_add_u32 s50, s50, 9437184
  buffer_store_dwordx4 v[100:103], v68, s[16:19], s50 offen sc1
  buffer_store_dwordx4 v[104:107], v68, s[16:19], s50 offen offset:64 sc1
  v_pk_mul_f32 v[112:113], v[80:81], v[80:81]
  v_pk_mul_f32 v[114:115], v[82:83], v[82:83]
  v_pk_mul_f32 v[116:117], v[84:85], v[84:85]
  v_pk_mul_f32 v[118:119], v[86:87], v[86:87]
  v_pk_mul_f32 v[120:121], v[88:89], v[88:89]
  v_pk_mul_f32 v[122:123], v[90:91], v[90:91]
  v_pk_mul_f32 v[124:125], v[92:93], v[92:93]
  v_pk_mul_f32 v[126:127], v[94:95], v[94:95]
  v_add_f32_dpp v128, v80, v80 row_ror:8 row_mask:0xf bank_mask:0x3
  v_add_f32_dpp v129, v81, v81 row_ror:8 row_mask:0xf bank_mask:0x3
  v_add_f32_dpp v130, v82, v82 row_ror:8 row_mask:0xf bank_mask:0x3
  v_add_f32_dpp v131, v83, v83 row_ror:8 row_mask:0xf bank_mask:0x3
  v_add_f32_dpp v132, v84, v84 row_ror:8 row_mask:0xf bank_mask:0x3
  v_add_f32_dpp v133, v85, v85 row_ror:8 row_mask:0xf bank_mask:0x3
  v_add_f32_dpp v134, v86, v86 row_ror:8 row_mask:0xf bank_mask:0x3
  v_add_f32_dpp v135, v87, v87 row_ror:8 row_mask:0xf bank_mask:0x3
  v_add_f32_dpp v128, v88, v88 row_ror:8 row_mask:0xf bank_mask:0xc
  v_add_f32_dpp v129, v89, v89 row_ror:8 row_mask:0xf bank_mask:0xc
  v_add_f32_dpp v130, v90, v90 row_ror:8 row_mask:0xf bank_mask:0xc
  v_add_f32_dpp v131, v91, v91 row_ror:8 row_mask:0xf bank_mask:0xc
  v_add_f32_dpp v132, v92, v92 row_ror:8 row_mask:0xf bank_mask:0xc
  v_add_f32_dpp v133, v93, v93 row_ror:8 row_mask:0xf bank_mask:0xc
  v_add_f32_dpp v134, v94, v94 row_ror:8 row_mask:0xf bank_mask:0xc
  v_add_f32_dpp v135, v95, v95 row_ror:8 row_mask:0xf bank_mask:0xc
  v_add_f32_dpp v136, v112, v112 row_ror:8 row_mask:0xf bank_mask:0x3
  v_add_f32_dpp v137, v113, v113 row_ror:8 row_mask:0xf bank_mask:0x3
  v_add_f32_dpp v138, v114, v114 row_ror:8 row_mask:0xf bank_mask:0x3
  v_add_f32_dpp v139, v115, v115 row_ror:8 row_mask:0xf bank_mask:0x3
  v_add_f32_dpp v140, v116, v116 row_ror:8 row_mask:0xf bank_mask:0x3
  v_add_f32_dpp v141, v117, v117 row_ror:8 row_mask:0xf bank_mask:0x3
  v_add_f32_dpp v142, v118, v118 row_ror:8 row_mask:0xf bank_mask:0x3
  v_add_f32_dpp v143, v119, v119 row_ror:8 row_mask:0xf bank_mask:0x3
  v_add_f32_dpp v136, v120, v120 row_ror:8 row_mask:0xf bank_mask:0xc
  v_add_f32_dpp v137, v121, v121 row_ror:8 row_mask:0xf bank_mask:0xc
  v_add_f32_dpp v138, v122, v122 row_ror:8 row_mask:0xf bank_mask:0xc
  v_add_f32_dpp v139, v123, v123 row_ror:8 row_mask:0xf bank_mask:0xc
  v_add_f32_dpp v140, v124, v124 row_ror:8 row_mask:0xf bank_mask:0xc
  v_add_f32_dpp v141, v125, v125 row_ror:8 row_mask:0xf bank_mask:0xc
  v_add_f32_dpp v142, v126, v126 row_ror:8 row_mask:0xf bank_mask:0xc
  v_add_f32_dpp v143, v127, v127 row_ror:8 row_mask:0xf bank_mask:0xc
  v_add_f32_dpp v144, v128, v128 row_shl:4 row_mask:0xf bank_mask:0x5
  v_add_f32_dpp v145, v129, v129 row_shl:4 row_mask:0xf bank_mask:0x5
  v_add_f32_dpp v146, v130, v130 row_shl:4 row_mask:0xf bank_mask:0x5
  v_add_f32_dpp v147, v131, v131 row_shl:4 row_mask:0xf bank_mask:0x5
  v_add_f32_dpp v144, v132, v132 row_shr:4 row_mask:0xf bank_mask:0xa
  v_add_f32_dpp v145, v133, v133 row_shr:4 row_mask:0xf bank_mask:0xa
  v_add_f32_dpp v146, v134, v134 row_shr:4 row_mask:0xf bank_mask:0xa
  v_add_f32_dpp v147, v135, v135 row_shr:4 row_mask:0xf bank_mask:0xa
  v_add_f32_dpp v148, v136, v136 row_shl:4 row_mask:0xf bank_mask:0x5
  v_add_f32_dpp v149, v137, v137 row_shl:4 row_mask:0xf bank_mask:0x5
  v_add_f32_dpp v150, v138, v138 row_shl:4 row_mask:0xf bank_mask:0x5
  v_add_f32_dpp v151, v139, v139 row_shl:4 row_mask:0xf bank_mask:0x5
  v_add_f32_dpp v148, v140, v140 row_shr:4 row_mask:0xf bank_mask:0xa
  v_add_f32_dpp v149, v141, v141 row_shr:4 row_mask:0xf bank_mask:0xa
  v_add_f32_dpp v150, v142, v142 row_shr:4 row_mask:0xf bank_mask:0xa
  v_add_f32_dpp v151, v143, v143 row_shr:4 row_mask:0xf bank_mask:0xa
  v_add_f32_dpp v144, v144, v144 quad_perm:[2,3,0,1] row_mask:0xf bank_mask:0xf
  v_add_f32_dpp v145, v145, v145 quad_perm:[2,3,0,1] row_mask:0xf bank_mask:0xf
  v_add_f32_dpp v146, v146, v146 quad_perm:[2,3,0,1] row_mask:0xf bank_mask:0xf
  v_add_f32_dpp v147, v147, v147 quad_perm:[2,3,0,1] row_mask:0xf bank_mask:0xf
  v_add_f32_dpp v144, v144, v144 quad_perm:[1,0,3,2] row_mask:0xf bank_mask:0xf
  v_add_f32_dpp v145, v145, v145 quad_perm:[1,0,3,2] row_mask:0xf bank_mask:0xf
  v_add_f32_dpp v146, v146, v146 quad_perm:[1,0,3,2] row_mask:0xf bank_mask:0xf
  v_add_f32_dpp v147, v147, v147 quad_perm:[1,0,3,2] row_mask:0xf bank_mask:0xf
  v_add_f32_dpp v148, v148, v148 quad_perm:[2,3,0,1] row_mask:0xf bank_mask:0xf
  v_add_f32_dpp v149, v149, v149 quad_perm:[2,3,0,1] row_mask:0xf bank_mask:0xf
  v_add_f32_dpp v150, v150, v150 quad_perm:[2,3,0,1] row_mask:0xf bank_mask:0xf
  v_add_f32_dpp v151, v151, v151 quad_perm:[2,3,0,1] row_mask:0xf bank_mask:0xf
  v_add_f32_dpp v148, v148, v148 quad_perm:[1,0,3,2] row_mask:0xf bank_mask:0xf
  v_add_f32_dpp v149, v149, v149 quad_perm:[1,0,3,2] row_mask:0xf bank_mask:0xf
  v_add_f32_dpp v150, v150, v150 quad_perm:[1,0,3,2] row_mask:0xf bank_mask:0xf
  v_add_f32_dpp v151, v151, v151 quad_perm:[1,0,3,2] row_mask:0xf bank_mask:0xf
  v_cndmask_b32 v144, v144, v145, s[60:61]
  v_cndmask_b32 v148, v148, v149, s[60:61]
  v_cndmask_b32 v144, v144, v146, s[62:63]
  v_cndmask_b32 v148, v148, v150, s[62:63]
  v_cndmask_b32 v144, v144, v147, s[64:65]
  v_cndmask_b32 v145, v148, v151, s[64:65]
  v_lshlrev_b32 v72, 3, v0
  v_add_u32 v72, 65536, v72
  ds_write_b64 v72, v[144:145]
  v_lshlrev_b32 v73, 3, v1
  s_lshl_b32 s52, s44, 2
  s_add_u32 s52, s52, 65536
  v_add_u32 v73, s52, v73
  s_waitcnt lgkmcnt(0)
  s_barrier
  s_cmp_ge_u32 s44, 2
  s_cbranch_scc1 L_pa_41
  ds_read_b32 v152, v73 offset:0
  ds_read_b32 v153, v73 offset:512
  ds_read_b32 v154, v73 offset:1024
  ds_read_b32 v155, v73 offset:1536
  s_lshl_b32 s50, s44, 13
  s_add_u32 s50, s50, 147456
  s_waitcnt lgkmcnt(0)
  v_add_f32 v152, v152, v153
  v_add_f32 v154, v154, v155
  v_add_f32 v152, v152, v154
  buffer_atomic_add_f32 v152, v69, s[16:19], s50 offen
L_pa_41:
  s_waitcnt vmcnt(0) lgkmcnt(0)
  s_barrier
  s_cmp_lg_u32 s44, 0
  s_cbranch_scc1 L_fs_42
  s_mov_b64 exec, 1
  s_lshl_b32 s50, s2, 6
  s_add_u32 s50, s50, 65536
  v_mov_b32 v252, 0
  v_mov_b32 v253, 1
  buffer_store_dword v253, v252, s[16:19], s50 offen sc1
  s_mov_b64 exec, -1
L_fs_42:
  s_lshr_b32 s50, s44, 1
  s_and_b32 s51, s44, 1
  s_mul_i32 s52, s50, 33280
  s_lshl_b32 s53, s51, 8
  s_sub_u32 s52, s52, s53
  s_add_u32 s52, s52, 81936
  v_and_b32 v178, 7, v2
  v_sub_u32 v178, 7, v178
  v_mul_u32_u24 v178, 4160, v178
  v_lshrrev_b32 v179, 3, v2
  v_sub_u32 v179, v3, v179
  v_lshlrev_b32 v179, 4, v179
  v_add3_u32 v176, v178, v179, s52
  s_mul_i32 s52, s50, 4608
  s_sub_u32 s52, s52, s53
  s_add_u32 s52, s52, 256
  v_lshlrev_b32 v178, 5, v2
  v_lshl_add_u32 v178, v3, 4, v178
  v_add_u32 v177, s52, v178
  v_mov_b64 v[16:17], 0
  v_mov_b64 v[18:19], 0
  v_mov_b64 v[20:21], 0
  v_mov_b64 v[22:23], 0
  v_mov_b64 v[24:25], 0
  v_mov_b64 v[26:27], 0
  v_mov_b64 v[28:29], 0
  v_mov_b64 v[30:31], 0
  v_mov_b64 v[32:33], 0
  v_mov_b64 v[34:35], 0
  v_mov_b64 v[36:37], 0
  v_mov_b64 v[38:39], 0
  v_mov_b64 v[40:41], 0
  v_mov_b64 v[42:43], 0
  v_mov_b64 v[44:45], 0
  v_mov_b64 v[46:47], 0
  v_lshlrev_b32 v178, 4, v1
  s_lshl_b32 s52, s44, 12
  s_add_u32 s52, s52, 25600
  v_add_u32 v210, s52, v178
  s_xor_b32 s52, s44, 1
  s_lshl_b32 s52, s52, 12
  s_add_u32 s52, s52, 25600
  v_add_u32 v211, s52, v178
  v_lshlrev_b32 v178, 6, v2
  v_lshl_add_u32 v178, v3, 4, v178
  s_lshl_b32 s52, s50, 13
  s_lshl_b32 s53, s51, 12
  s_add_u32 s52, s52, s53
  s_add_u32 s52, s52, 9216
  v_add_u32 v212, s52, v178
  v_and_b32 v178, 1, v3
  v_lshlrev_b32 v178, 9, v178
  v_lshl_add_u32 v178, v2, 5, v178
  v_lshrrev_b32 v179, 1, v3
  v_lshl_add_u32 v178, v179, 4, v178
  s_lshl_b32 s53, s51, 11
  v_add_u32 v213, s53, v178
  v_lshrrev_b32 v178, 7, v0
  v_mul_u32_u24 v178, 4608, v178
  v_and_b32 v179, 127, v0
  v_lshl_add_u32 v178, v179, 2, v178
  v_mov_b32 v179, 0
  ds_write_b32 v178, v179 offset:0
  v_lshlrev_b32 v180, 4, v0
  v_lshlrev_b32 v181, 5, v0
  ds_read_b128 v[48:51], v176 offset:4032
  ds_read_b128 v[52:55], v176 offset:3520
  ds_read_b128 v[56:59], v176 offset:3008
  ds_read_b128 v[60:63], v176 offset:2496
  ds_read_b128 v[64:67], v176 offset:1984
  ds_read_b128 v[68:71], v176 offset:1472
  ds_read_b128 v[72:75], v176 offset:960
  ds_read_b128 v[76:79], v176 offset:448
  v_lshlrev_b32 v252, 6, v0
  s_mov_b32 s50, 65536
  s_mov_b32 s74, 0
L_poll_43:
  buffer_load_dword v253, v252, s[16:19], s50 offen sc1
  s_waitcnt vmcnt(0)
  v_cmp_gt_u32 vcc, 1, v253
  s_cbranch_vccz L_pdone_44
  s_add_u32 s74, s74, 1
  s_cmp_lt_u32 s74, 1048576
  s_cbranch_scc1 L_poll_43
L_pdone_44:
  s_barrier
  s_mov_b32 s52, 147456
  s_mov_b32 s53, 155648
  buffer_load_dwordx4 v[190:193], v181, s[16:19], s52 offen sc1
  buffer_load_dwordx4 v[194:197], v181, s[16:19], s52 offen offset:16 sc1
  buffer_load_dwordx4 v[198:201], v181, s[16:19], s53 offen sc1
  buffer_load_dwordx4 v[202:205], v181, s[16:19], s53 offen offset:16 sc1
  s_lshl_b32 s54, s48, 12
  s_add_u32 s54, s54, 9437184
  s_add_u32 s55, s54, 131072
  buffer_load_dwordx4 v[182:185], v180, s[16:19], s54 offen sc1
  buffer_load_dwordx4 v[186:189], v180, s[16:19], s55 offen sc1
  s_mov_b32 s54, 0x3b000000
  s_mov_b32 s55, 0x3727c5ac
  s_waitcnt vmcnt(2)
  v_pk_mul_f32 v[190:191], v[190:191], s[54:55] op_sel_hi:[1,0]
  v_pk_mul_f32 v[198:199], v[198:199], s[54:55] op_sel_hi:[1,0]
  v_pk_mul_f32 v[192:193], v[192:193], s[54:55] op_sel_hi:[1,0]
  v_pk_mul_f32 v[200:201], v[200:201], s[54:55] op_sel_hi:[1,0]
  v_pk_mul_f32 v[194:195], v[194:195], s[54:55] op_sel_hi:[1,0]
  v_pk_mul_f32 v[202:203], v[202:203], s[54:55] op_sel_hi:[1,0]
  v_pk_mul_f32 v[196:197], v[196:197], s[54:55] op_sel_hi:[1,0]
  v_pk_mul_f32 v[204:205], v[204:205], s[54:55] op_sel_hi:[1,0]
  v_pk_fma_f32 v[198:199], v[190:191], v[190:191], v[198:199] neg_lo:[1,0,0] neg_hi:[1,0,0]
  v_pk_fma_f32 v[200:201], v[192:193], v[192:193], v[200:201] neg_lo:[1,0,0] neg_hi:[1,0,0]
  v_pk_fma_f32 v[202:203], v[194:195], v[194:195], v[202:203] neg_lo:[1,0,0] neg_hi:[1,0,0]
  v_pk_fma_f32 v[204:205], v[196:197], v[196:197], v[204:205] neg_lo:[1,0,0] neg_hi:[1,0,0]
  v_max_f32 v198, 0, v198
  v_max_f32 v199, 0, v199
  v_max_f32 v200, 0, v200
  v_max_f32 v201, 0, v201
  v_max_f32 v202, 0, v202
  v_max_f32 v203, 0, v203
  v_max_f32 v204, 0, v204
  v_max_f32 v205, 0, v205
  v_pk_add_f32 v[198:199], v[198:199], s[54:55] op_sel:[0,1] op_sel_hi:[1,1]
  v_pk_add_f32 v[200:201], v[200:201], s[54:55] op_sel:[0,1] op_sel_hi:[1,1]
  v_pk_add_f32 v[202:203], v[202:203], s[54:55] op_sel:[0,1] op_sel_hi:[1,1]
  v_pk_add_f32 v[204:205], v[204:205], s[54:55] op_sel:[0,1] op_sel_hi:[1,1]
  v_rsq_f32 v198, v198
  v_rsq_f32 v199, v199
  v_rsq_f32 v200, v200
  v_rsq_f32 v201, v201
  v_rsq_f32 v202, v202
  v_rsq_f32 v203, v203
  v_rsq_f32 v204, v204
  v_rsq_f32 v205, v205
  s_nop 0
  v_pk_mul_f32 v[190:191], v[190:191], v[198:199] neg_lo:[1,0] neg_hi:[1,0]
  v_pk_mul_f32 v[192:193], v[192:193], v[200:201] neg_lo:[1,0] neg_hi:[1,0]
  v_pk_mul_f32 v[194:195], v[194:195], v[202:203] neg_lo:[1,0] neg_hi:[1,0]
  v_pk_mul_f32 v[196:197], v[196:197], v[204:205] neg_lo:[1,0] neg_hi:[1,0]
  s_waitcnt vmcnt(0)
  v_lshlrev_b32 v214, 16, v182
  v_and_b32 v215, s70, v182
  v_lshlrev_b32 v216, 16, v183
  v_and_b32 v217, s70, v183
  v_lshlrev_b32 v218, 16, v184
  v_and_b32 v219, s70, v184
  v_lshlrev_b32 v220, 16, v185
  v_and_b32 v221, s70, v185
  v_pk_fma_f32 v[222:223], v[214:215], v[198:199], v[190:191]
  v_pk_fma_f32 v[224:225], v[216:217], v[200:201], v[192:193]
  v_pk_fma_f32 v[226:227], v[218:219], v[202:203], v[194:195]
  v_pk_fma_f32 v[228:229], v[220:221], v[204:205], v[196:197]
  v_cvt_pk_bf16_f32 v206, v222, v223
  v_cvt_pk_bf16_f32 v207, v224, v225
  v_cvt_pk_bf16_f32 v208, v226, v227
  v_cvt_pk_bf16_f32 v209, v228, v229
  ds_write_b128 v180, v[206:209] offset:512
  v_pk_fma_f32 v[232:233], v[222:223], s[80:81], v[214:215] op_sel:[0,0,0] op_sel_hi:[1,0,1]
  v_pk_fma_f32 v[234:235], v[224:225], s[80:81], v[216:217] op_sel:[0,0,0] op_sel_hi:[1,0,1]
  v_pk_fma_f32 v[236:237], v[226:227], s[80:81], v[218:219] op_sel:[0,0,0] op_sel_hi:[1,0,1]
  v_pk_fma_f32 v[238:239], v[228:229], s[80:81], v[220:221] op_sel:[0,0,0] op_sel_hi:[1,0,1]
  v_lshlrev_b32 v214, 16, v186
  v_and_b32 v215, s70, v186
  v_lshlrev_b32 v216, 16, v187
  v_and_b32 v217, s70, v187
  v_lshlrev_b32 v218, 16, v188
  v_and_b32 v219, s70, v188
  v_lshlrev_b32 v220, 16, v189
  v_and_b32 v221, s70, v189
  v_pk_fma_f32 v[222:223], v[214:215], v[198:199], v[190:191]
  v_pk_fma_f32 v[224:225], v[216:217], v[200:201], v[192:193]
  v_pk_fma_f32 v[226:227], v[218:219], v[202:203], v[194:195]
  v_pk_fma_f32 v[228:229], v[220:221], v[204:205], v[196:197]
  v_cvt_pk_bf16_f32 v206, v222, v223
  v_cvt_pk_bf16_f32 v207, v224, v225
  v_cvt_pk_bf16_f32 v208, v226, v227
  v_cvt_pk_bf16_f32 v209, v228, v229
  ds_write_b128 v180, v[206:209] offset:5120
  v_pk_fma_f32 v[182:183], v[222:223], s[80:81], v[214:215] op_sel:[0,1,0] op_sel_hi:[1,1,1]
  v_pk_fma_f32 v[184:185], v[224:225], s[80:81], v[216:217] op_sel:[0,1,0] op_sel_hi:[1,1,1]
  v_pk_fma_f32 v[186:187], v[226:227], s[80:81], v[218:219] op_sel:[0,1,0] op_sel_hi:[1,1,1]
  v_pk_fma_f32 v[188:189], v[228:229], s[80:81], v[220:221] op_sel:[0,1,0] op_sel_hi:[1,1,1]
  s_waitcnt lgkmcnt(0)
  s_barrier
  ds_read_b128 v[80:83], v177 offset:224
  ds_read_b128 v[84:87], v177 offset:736
  ds_read_b128 v[88:91], v177 offset:1248
  ds_read_b128 v[92:95], v177 offset:1760
  ds_read_b128 v[96:99], v177 offset:2272
  ds_read_b128 v[100:103], v177 offset:2784
  ds_read_b128 v[104:107], v177 offset:3296
  ds_read_b128 v[108:111], v177 offset:3808
  s_waitcnt lgkmcnt(7)
  v_mfma_f32_16x16x32_bf16 v[16:19], v[48:51], v[80:83], v[16:19]
  v_mfma_f32_16x16x32_bf16 v[20:23], v[52:55], v[80:83], v[20:23]
  v_mfma_f32_16x16x32_bf16 v[24:27], v[56:59], v[80:83], v[24:27]
  v_mfma_f32_16x16x32_bf16 v[28:31], v[60:63], v[80:83], v[28:31]
  v_mfma_f32_16x16x32_bf16 v[32:35], v[64:67], v[80:83], v[32:35]
  v_mfma_f32_16x16x32_bf16 v[36:39], v[68:71], v[80:83], v[36:39]
  v_mfma_f32_16x16x32_bf16 v[40:43], v[72:75], v[80:83], v[40:43]
  v_mfma_f32_16x16x32_bf16 v[44:47], v[76:79], v[80:83], v[44:47]
  s_waitcnt lgkmcnt(6)
  v_mfma_f32_16x16x32_bf16 v[20:23], v[48:51], v[84:87], v[20:23]
  ds_read_b128 v[112:115], v176 offset:3968
  v_mfma_f32_16x16x32_bf16 v[24:27], v[52:55], v[84:87], v[24:27]
  ds_read_b128 v[144:147], v177 offset:160
  v_mfma_f32_16x16x32_bf16 v[28:31], v[56:59], v[84:87], v[28:31]
  ds_read_b128 v[116:119], v176 offset:3456
  v_mfma_f32_16x16x32_bf16 v[32:35], v[60:63], v[84:87], v[32:35]
  ds_read_b128 v[148:151], v177 offset:672
  v_mfma_f32_16x16x32_bf16 v[36:39], v[64:67], v[84:87], v[36:39]
  ds_read_b128 v[120:123], v176 offset:2944
  v_mfma_f32_16x16x32_bf16 v[40:43], v[68:71], v[84:87], v[40:43]
  ds_read_b128 v[152:155], v177 offset:1184
  v_mfma_f32_16x16x32_bf16 v[44:47], v[72:75], v[84:87], v[44:47]
  ds_read_b128 v[124:127], v176 offset:2432
  s_waitcnt lgkmcnt(12)
  v_mfma_f32_16x16x32_bf16 v[24:27], v[48:51], v[88:91], v[24:27]
  ds_read_b128 v[156:159], v177 offset:1696
  v_mfma_f32_16x16x32_bf16 v[28:31], v[52:55], v[88:91], v[28:31]
  ds_write_b128 v181, v[232:235] offset:9216
  v_mfma_f32_16x16x32_bf16 v[32:35], v[56:59], v[88:91], v[32:35]
  ds_write_b128 v181, v[236:239] offset:9232
  v_mfma_f32_16x16x32_bf16 v[36:39], v[60:63], v[88:91], v[36:39]
  ds_write_b128 v181, v[182:185] offset:17408
  v_mfma_f32_16x16x32_bf16 v[40:43], v[64:67], v[88:91], v[40:43]
  ds_write_b128 v181, v[186:189] offset:17424
  v_mfma_f32_16x16x32_bf16 v[44:47], v[68:71], v[88:91], v[44:47]
  s_waitcnt lgkmcnt(15)
  v_mfma_f32_16x16x32_bf16 v[28:31], v[48:51], v[92:95], v[28:31]
  ds_read_b128 v[128:131], v176 offset:1920
  v_mfma_f32_16x16x32_bf16 v[32:35], v[52:55], v[92:95], v[32:35]
  ds_read_b128 v[160:163], v177 offset:2208
  v_mfma_f32_16x16x32_bf16 v[36:39], v[56:59], v[92:95], v[36:39]
  ds_read_b128 v[132:135], v176 offset:1408
  v_mfma_f32_16x16x32_bf16 v[40:43], v[60:63], v[92:95], v[40:43]
  ds_read_b128 v[164:167], v177 offset:2720
  v_mfma_f32_16x16x32_bf16 v[44:47], v[64:67], v[92:95], v[44:47]
  ds_read_b128 v[136:139], v176 offset:896
  v_mfma_f32_16x16x32_bf16 v[32:35], v[48:51], v[96:99], v[32:35]
  ds_read_b128 v[168:171], v177 offset:3232
  v_mfma_f32_16x16x32_bf16 v[36:39], v[52:55], v[96:99], v[36:39]
  ds_read_b128 v[140:143], v176 offset:384
  v_mfma_f32_16x16x32_bf16 v[40:43], v[56:59], v[96:99], v[40:43]
  ds_read_b128 v[172:175], v177 offset:3744
  v_mfma_f32_16x16x32_bf16 v[44:47], v[60:63], v[96:99], v[44:47]
  s_waitcnt lgkmcnt(15)
  v_mfma_f32_16x16x32_bf16 v[36:39], v[48:51], v[100:103], v[36:39]
  v_mfma_f32_16x16x32_bf16 v[40:43], v[52:55], v[100:103], v[40:43]
  v_mfma_f32_16x16x32_bf16 v[44:47], v[56:59], v[100:103], v[44:47]
  v_mfma_f32_16x16x32_bf16 v[40:43], v[48:51], v[104:107], v[40:43]
  v_mfma_f32_16x16x32_bf16 v[44:47], v[52:55], v[104:107], v[44:47]
  v_mfma_f32_16x16x32_bf16 v[44:47], v[48:51], v[108:111], v[44:47]
  s_waitcnt lgkmcnt(0)
  s_barrier
  v_mfma_f32_16x16x32_bf16 v[16:19], v[112:115], v[144:147], v[16:19]
  ds_read_b128 v[48:51], v176 offset:3904
  v_mfma_f32_16x16x32_bf16 v[20:23], v[116:119], v[144:147], v[20:23]
  ds_read_b128 v[80:83], v177 offset:96
  v_mfma_f32_16x16x32_bf16 v[24:27], v[120:123], v[144:147], v[24:27]
  ds_read_b128 v[52:55], v176 offset:3392
  v_mfma_f32_16x16x32_bf16 v[28:31], v[124:127], v[144:147], v[28:31]
  ds_read_b128 v[84:87], v177 offset:608
  v_mfma_f32_16x16x32_bf16 v[32:35], v[128:131], v[144:147], v[32:35]
  ds_read_b128 v[56:59], v176 offset:2880
  v_mfma_f32_16x16x32_bf16 v[36:39], v[132:135], v[144:147], v[36:39]
  ds_read_b128 v[88:91], v177 offset:1120
  v_mfma_f32_16x16x32_bf16 v[40:43], v[136:139], v[144:147], v[40:43]
  ds_read_b128 v[60:63], v176 offset:2368
  v_mfma_f32_16x16x32_bf16 v[44:47], v[140:143], v[144:147], v[44:47]
  ds_read_b128 v[92:95], v177 offset:1632
  v_mfma_f32_16x16x32_bf16 v[20:23], v[112:115], v[148:151], v[20:23]
  ds_read_b128 v[64:67], v176 offset:1856
  v_mfma_f32_16x16x32_bf16 v[24:27], v[116:119], v[148:151], v[24:27]
  ds_read_b128 v[96:99], v177 offset:2144
  v_mfma_f32_16x16x32_bf16 v[28:31], v[120:123], v[148:151], v[28:31]
  ds_read_b128 v[68:71], v176 offset:1344
  v_mfma_f32_16x16x32_bf16 v[32:35], v[124:127], v[148:151], v[32:35]
  ds_read_b128 v[100:103], v177 offset:2656
  v_mfma_f32_16x16x32_bf16 v[36:39], v[128:131], v[148:151], v[36:39]
  ds_read_b128 v[72:75], v176 offset:832
  v_mfma_f32_16x16x32_bf16 v[40:43], v[132:135], v[148:151], v[40:43]
  ds_read_b128 v[104:107], v177 offset:3168
  v_mfma_f32_16x16x32_bf16 v[44:47], v[136:139], v[148:151], v[44:47]
  ds_read_b128 v[76:79], v176 offset:320
  v_mfma_f32_16x16x32_bf16 v[24:27], v[112:115], v[152:155], v[24:27]
  ds_read_b128 v[108:111], v177 offset:3680
  v_mfma_f32_16x16x32_bf16 v[28:31], v[116:119], v[152:155], v[28:31]
  v_mfma_f32_16x16x32_bf16 v[32:35], v[120:123], v[152:155], v[32:35]
  v_mfma_f32_16x16x32_bf16 v[36:39], v[124:127], v[152:155], v[36:39]
  v_mfma_f32_16x16x32_bf16 v[40:43], v[128:131], v[152:155], v[40:43]
  v_mfma_f32_16x16x32_bf16 v[44:47], v[132:135], v[152:155], v[44:47]
  v_mfma_f32_16x16x32_bf16 v[28:31], v[112:115], v[156:159], v[28:31]
  v_mfma_f32_16x16x32_bf16 v[32:35], v[116:119], v[156:159], v[32:35]
  v_mfma_f32_16x16x32_bf16 v[36:39], v[120:123], v[156:159], v[36:39]
  v_mfma_f32_16x16x32_bf16 v[40:43], v[124:127], v[156:159], v[40:43]
  v_mfma_f32_16x16x32_bf16 v[44:47], v[128:131], v[156:159], v[44:47]
  v_mfma_f32_16x16x32_bf16 v[32:35], v[112:115], v[160:163], v[32:35]
  v_mfma_f32_16x16x32_bf16 v[36:39], v[116:119], v[160:163], v[36:39]
  v_mfma_f32_16x16x32_bf16 v[40:43], v[120:123], v[160:163], v[40:43]
  v_mfma_f32_16x16x32_bf16 v[44:47], v[124:127], v[160:163], v[44:47]
  v_mfma_f32_16x16x32_bf16 v[36:39], v[112:115], v[164:167], v[36:39]
  v_mfma_f32_16x16x32_bf16 v[40:43], v[116:119], v[164:167], v[40:43]
  v_mfma_f32_16x16x32_bf16 v[44:47], v[120:123], v[164:167], v[44:47]
  v_mfma_f32_16x16x32_bf16 v[40:43], v[112:115], v[168:171], v[40:43]
  v_mfma_f32_16x16x32_bf16 v[44:47], v[116:119], v[168:171], v[44:47]
  v_mfma_f32_16x16x32_bf16 v[44:47], v[112:115], v[172:175], v[44:47]
  s_waitcnt lgkmcnt(0)
  v_mfma_f32_16x16x32_bf16 v[16:19], v[48:51], v[80:83], v[16:19]
  ds_read_b128 v[112:115], v176 offset:3840
  v_mfma_f32_16x16x32_bf16 v[20:23], v[52:55], v[80:83], v[20:23]
  ds_read_b128 v[144:147], v177 offset:32
  v_mfma_f32_16x16x32_bf16 v[24:27], v[56:59], v[80:83], v[24:27]
  ds_read_b128 v[116:119], v176 offset:3328
  v_mfma_f32_16x16x32_bf16 v[28:31], v[60:63], v[80:83], v[28:31]
  ds_read_b128 v[148:151], v177 offset:544
  v_mfma_f32_16x16x32_bf16 v[32:35], v[64:67], v[80:83], v[32:35]
  ds_read_b128 v[120:123], v176 offset:2816
  v_mfma_f32_16x16x32_bf16 v[36:39], v[68:71], v[80:83], v[36:39]
  ds_read_b128 v[152:155], v177 offset:1056
  v_mfma_f32_16x16x32_bf16 v[40:43], v[72:75], v[80:83], v[40:43]
  ds_read_b128 v[124:127], v176 offset:2304
  v_mfma_f32_16x16x32_bf16 v[44:47], v[76:79], v[80:83], v[44:47]
  ds_read_b128 v[156:159], v177 offset:1568
  v_mfma_f32_16x16x32_bf16 v[20:23], v[48:51], v[84:87], v[20:23]
  ds_read_b128 v[128:131], v176 offset:1792
  v_mfma_f32_16x16x32_bf16 v[24:27], v[52:55], v[84:87], v[24:27]
  ds_read_b128 v[160:163], v177 offset:2080
  v_mfma_f32_16x16x32_bf16 v[28:31], v[56:59], v[84:87], v[28:31]
  ds_read_b128 v[132:135], v176 offset:1280
  v_mfma_f32_16x16x32_bf16 v[32:35], v[60:63], v[84:87], v[32:35]
  ds_read_b128 v[164:167], v177 offset:2592
  v_mfma_f32_16x16x32_bf16 v[36:39], v[64:67], v[84:87], v[36:39]
  ds_read_b128 v[136:139], v176 offset:768
  v_mfma_f32_16x16x32_bf16 v[40:43], v[68:71], v[84:87], v[40:43]
  ds_read_b128 v[168:171], v177 offset:3104
  v_mfma_f32_16x16x32_bf16 v[44:47], v[72:75], v[84:87], v[44:47]
  ds_read_b128 v[140:143], v176 offset:256
  v_mfma_f32_16x16x32_bf16 v[24:27], v[48:51], v[88:91], v[24:27]
  ds_read_b128 v[172:175], v177 offset:3616
  v_mfma_f32_16x16x32_bf16 v[28:31], v[52:55], v[88:91], v[28:31]
  v_mfma_f32_16x16x32_bf16 v[32:35], v[56:59], v[88:91], v[32:35]
  v_mfma_f32_16x16x32_bf16 v[36:39], v[60:63], v[88:91], v[36:39]
  v_mfma_f32_16x16x32_bf16 v[40:43], v[64:67], v[88:91], v[40:43]
  v_mfma_f32_16x16x32_bf16 v[44:47], v[68:71], v[88:91], v[44:47]
  v_mfma_f32_16x16x32_bf16 v[28:31], v[48:51], v[92:95], v[28:31]
  v_mfma_f32_16x16x32_bf16 v[32:35], v[52:55], v[92:95], v[32:35]
  v_mfma_f32_16x16x32_bf16 v[36:39], v[56:59], v[92:95], v[36:39]
  v_mfma_f32_16x16x32_bf16 v[40:43], v[60:63], v[92:95], v[40:43]
  v_mfma_f32_16x16x32_bf16 v[44:47], v[64:67], v[92:95], v[44:47]
  v_mfma_f32_16x16x32_bf16 v[32:35], v[48:51], v[96:99], v[32:35]
  v_mfma_f32_16x16x32_bf16 v[36:39], v[52:55], v[96:99], v[36:39]
  v_mfma_f32_16x16x32_bf16 v[40:43], v[56:59], v[96:99], v[40:43]
  v_mfma_f32_16x16x32_bf16 v[44:47], v[60:63], v[96:99], v[44:47]
  v_mfma_f32_16x16x32_bf16 v[36:39], v[48:51], v[100:103], v[36:39]
  v_mfma_f32_16x16x32_bf16 v[40:43], v[52:55], v[100:103], v[40:43]
  v_mfma_f32_16x16x32_bf16 v[44:47], v[56:59], v[100:103], v[44:47]
  v_mfma_f32_16x16x32_bf16 v[40:43], v[48:51], v[104:107], v[40:43]
  v_mfma_f32_16x16x32_bf16 v[44:47], v[52:55], v[104:107], v[44:47]
  v_mfma_f32_16x16x32_bf16 v[44:47], v[48:51], v[108:111], v[44:47]
  s_waitcnt lgkmcnt(0)
  v_mfma_f32_16x16x32_bf16 v[16:19], v[112:115], v[144:147], v[16:19]
  ds_read_b128 v[216:219], v212 offset:0
  v_mfma_f32_16x16x32_bf16 v[20:23], v[116:119], v[144:147], v[20:23]
  ds_read_b128 v[220:223], v212 offset:1024
  v_mfma_f32_16x16x32_bf16 v[24:27], v[120:123], v[144:147], v[24:27]
  ds_read_b128 v[224:227], v212 offset:2048
  v_mfma_f32_16x16x32_bf16 v[28:31], v[124:127], v[144:147], v[28:31]
  ds_read_b128 v[228:231], v212 offset:3072
  v_mfma_f32_16x16x32_bf16 v[32:35], v[128:131], v[144:147], v[32:35]
  v_mfma_f32_16x16x32_bf16 v[36:39], v[132:135], v[144:147], v[36:39]
  v_mfma_f32_16x16x32_bf16 v[40:43], v[136:139], v[144:147], v[40:43]
  v_mfma_f32_16x16x32_bf16 v[44:47], v[140:143], v[144:147], v[44:47]
  v_mfma_f32_16x16x32_bf16 v[20:23], v[112:115], v[148:151], v[20:23]
  v_mfma_f32_16x16x32_bf16 v[24:27], v[116:119], v[148:151], v[24:27]
  v_mfma_f32_16x16x32_bf16 v[28:31], v[120:123], v[148:151], v[28:31]
  v_mfma_f32_16x16x32_bf16 v[32:35], v[124:127], v[148:151], v[32:35]
  v_mfma_f32_16x16x32_bf16 v[36:39], v[128:131], v[148:151], v[36:39]
  v_mfma_f32_16x16x32_bf16 v[40:43], v[132:135], v[148:151], v[40:43]
  v_mfma_f32_16x16x32_bf16 v[44:47], v[136:139], v[148:151], v[44:47]
  v_mfma_f32_16x16x32_bf16 v[24:27], v[112:115], v[152:155], v[24:27]
  v_mfma_f32_16x16x32_bf16 v[28:31], v[116:119], v[152:155], v[28:31]
  v_mfma_f32_16x16x32_bf16 v[32:35], v[120:123], v[152:155], v[32:35]
  v_mfma_f32_16x16x32_bf16 v[36:39], v[124:127], v[152:155], v[36:39]
  v_mfma_f32_16x16x32_bf16 v[40:43], v[128:131], v[152:155], v[40:43]
  v_mfma_f32_16x16x32_bf16 v[44:47], v[132:135], v[152:155], v[44:47]
  v_mfma_f32_16x16x32_bf16 v[28:31], v[112:115], v[156:159], v[28:31]
  v_mfma_f32_16x16x32_bf16 v[32:35], v[116:119], v[156:159], v[32:35]
  v_mfma_f32_16x16x32_bf16 v[36:39], v[120:123], v[156:159], v[36:39]
  v_mfma_f32_16x16x32_bf16 v[40:43], v[124:127], v[156:159], v[40:43]
  v_mfma_f32_16x16x32_bf16 v[44:47], v[128:131], v[156:159], v[44:47]
  v_mfma_f32_16x16x32_bf16 v[32:35], v[112:115], v[160:163], v[32:35]
  v_mfma_f32_16x16x32_bf16 v[36:39], v[116:119], v[160:163], v[36:39]
  v_mfma_f32_16x16x32_bf16 v[40:43], v[120:123], v[160:163], v[40:43]
  v_mfma_f32_16x16x32_bf16 v[44:47], v[124:127], v[160:163], v[44:47]
  v_mfma_f32_16x16x32_bf16 v[36:39], v[112:115], v[164:167], v[36:39]
  v_mfma_f32_16x16x32_bf16 v[40:43], v[116:119], v[164:167], v[40:43]
  v_mfma_f32_16x16x32_bf16 v[44:47], v[120:123], v[164:167], v[44:47]
  v_mfma_f32_16x16x32_bf16 v[40:43], v[112:115], v[168:171], v[40:43]
  v_mfma_f32_16x16x32_bf16 v[44:47], v[116:119], v[168:171], v[44:47]
  v_mfma_f32_16x16x32_bf16 v[44:47], v[112:115], v[172:175], v[44:47]
  s_bitcmp1_b32 s44, 0
  s_waitcnt lgkmcnt(0)
  s_nop 5
  s_cbranch_scc1 L_cvo_45
  ds_write_b128 v210, v[32:35] offset:0
  ds_write_b128 v210, v[36:39] offset:1024
  ds_write_b128 v210, v[40:43] offset:2048
  ds_write_b128 v210, v[44:47] offset:3072
  v_pk_add_f32 v[48:49], v[16:17], v[216:217]
  v_pk_add_f32 v[50:51], v[18:19], v[218:219]
  v_pk_add_f32 v[52:53], v[20:21], v[220:221]
  v_pk_add_f32 v[54:55], v[22:23], v[222:223]
  v_pk_add_f32 v[56:57], v[24:25], v[224:225]
  v_pk_add_f32 v[58:59], v[26:27], v[226:227]
  v_pk_add_f32 v[60:61], v[28:29], v[228:229]
  v_pk_add_f32 v[62:63], v[30:31], v[230:231]
  s_branch L_cvd_46
L_cvo_45:
  ds_write_b128 v210, v[16:19] offset:0
  ds_write_b128 v210, v[20:23] offset:1024
  ds_write_b128 v210, v[24:27] offset:2048
  ds_write_b128 v210, v[28:31] offset:3072
  v_pk_add_f32 v[48:49], v[32:33], v[216:217]
  v_pk_add_f32 v[50:51], v[34:35], v[218:219]
  v_pk_add_f32 v[52:53], v[36:37], v[220:221]
  v_pk_add_f32 v[54:55], v[38:39], v[222:223]
  v_pk_add_f32 v[56:57], v[40:41], v[224:225]
  v_pk_add_f32 v[58:59], v[42:43], v[226:227]
  v_pk_add_f32 v[60:61], v[44:45], v[228:229]
  v_pk_add_f32 v[62:63], v[46:47], v[230:231]
L_cvd_46:
  s_waitcnt lgkmcnt(0)
  s_barrier
  ds_read_b128 v[64:67], v211 offset:0
  ds_read_b128 v[68:71], v211 offset:1024
  ds_read_b128 v[72:75], v211 offset:2048
  ds_read_b128 v[76:79], v211 offset:3072
  s_lshr_b32 s50, s44, 1
  s_lshl_b32 s54, s50, 5
  s_add_u32 s54, s54, s48
  s_lshl_b32 s54, s54, 12
  s_waitcnt lgkmcnt(3)
  v_pk_add_f32 v[48:49], v[48:49], v[64:65]
  v_cvt_pk_bf16_f32 v132, v48, v49
  v_pk_add_f32 v[50:51], v[50:51], v[66:67]
  v_cvt_pk_bf16_f32 v133, v50, v51
  s_waitcnt lgkmcnt(2)
  v_pk_add_f32 v[52:53], v[52:53], v[68:69]
  v_cvt_pk_bf16_f32 v134, v52, v53
  v_pk_add_f32 v[54:55], v[54:55], v[70:71]
  v_cvt_pk_bf16_f32 v135, v54, v55
  s_waitcnt lgkmcnt(1)
  v_pk_add_f32 v[56:57], v[56:57], v[72:73]
  v_cvt_pk_bf16_f32 v136, v56, v57
  v_pk_add_f32 v[58:59], v[58:59], v[74:75]
  v_cvt_pk_bf16_f32 v137, v58, v59
  s_waitcnt lgkmcnt(0)
  v_pk_add_f32 v[60:61], v[60:61], v[76:77]
  v_cvt_pk_bf16_f32 v138, v60, v61
  v_pk_add_f32 v[62:63], v[62:63], v[78:79]
  v_cvt_pk_bf16_f32 v139, v62, v63
  s_cmp_eq_u32 s59, 0
  s_cbranch_scc1 L_fin_slow_47
  s_add_u32 s54, s54, 11534336
  s_nop 0
  v_permlane16_swap_b32 v132, v134
  v_permlane16_swap_b32 v133, v135
  v_permlane16_swap_b32 v136, v138
  v_permlane16_swap_b32 v137, v139
  buffer_store_dwordx4 v[132:135], v213, s[16:19], s54 offen offset:0
  buffer_store_dwordx4 v[136:139], v213, s[16:19], s54 offen offset:1024
  s_and_b32 s50, s2, 7
  s_lshr_b32 s51, s2, 3
  v_lshrrev_b32 v178, 3, v1
  v_and_b32 v179, 7, v1
  v_lshlrev_b32 v60, 12, v178
  v_lshl_add_u32 v60, v179, 4, v60
  s_lshl_b32 s52, s50, 6
  s_lshl_b32 s53, s44, 4
  s_add_u32 s52, s52, s53
  s_lshl_b32 s52, s52, 12
  s_lshl_b32 s53, s51, 7
  s_add_u32 s52, s52, s53
  s_add_u32 s52, s52, 11534336
  v_lshrrev_b32 v178, 2, v2
  v_lshl_add_u32 v178, v3, 4, v178
  v_lshlrev_b32 v178, 7, v178
  v_and_b32 v179, 3, v2
  v_lshl_add_u32 v178, v179, 3, v178
  s_lshl_b32 s53, s44, 5
  s_add_u32 s53, s53, 49152
  v_add_u32 v61, s53, v178
  s_lshl_b32 s53, s51, 6
  s_lshl_b32 s55, s44, 4
  s_add_u32 s53, s53, s55
  v_add_u32 v62, s53, v2
  v_lshlrev_b32 v62, 10, v62
  v_lshl_add_u32 v62, v3, 5, v62
  s_lshl_b32 s55, s50, 7
  s_waitcnt vmcnt(0)
  s_barrier
  s_cmp_lg_u32 s44, 0
  s_cbranch_scc1 L_f6_49
  s_mov_b64 exec, 1
  s_lshl_b32 s56, s2, 6
  s_add_u32 s56, s56, 98304
  v_mov_b32 v252, 0
  v_mov_b32 v253, 1
  buffer_store_dword v253, v252, s[16:19], s56 offen
  s_mov_b32 exec_lo, -1
  s_lshl_b32 s56, s50, 6
  s_add_u32 s56, s56, 98304
  v_lshlrev_b32 v252, 9, v1
  s_mov_b32 s74, 0
L_poll_50:
  buffer_load_dword v253, v252, s[16:19], s56 offen sc1
  s_waitcnt vmcnt(0)
  v_cmp_gt_u32 vcc, 1, v253
  s_cbranch_vccz L_pdone_51
  s_add_u32 s74, s74, 1
  s_cmp_lt_u32 s74, 1048576
  s_cbranch_scc1 L_poll_50
L_pdone_51:
  s_mov_b64 exec, -1
L_f6_49:
  s_barrier
  s_lshl_b32 s56, s44, 11
  s_add_u32 m0, s56, 49152
  s_nop 0
  buffer_load_dwordx4 v60, s[16:19], s52 offen sc1 lds
  s_add_u32 m0, s56, 50176
  s_add_u32 s52, s52, 32768
  buffer_load_dwordx4 v60, s[16:19], s52 offen sc1 lds
  s_waitcnt vmcnt(0)
  s_barrier
  ds_read_b64_tr_b16 v[64:65], v61 offset:0
  ds_read_b64_tr_b16 v[66:67], v61 offset:512
  ds_read_b64_tr_b16 v[68:69], v61 offset:1024
  ds_read_b64_tr_b16 v[70:71], v61 offset:1536
  s_waitcnt lgkmcnt(2)
  buffer_store_dwordx4 v[64:67], v62, s[20:23], s55 offen
  s_waitcnt lgkmcnt(0)
  buffer_store_dwordx4 v[68:71], v62, s[20:23], s55 offen offset:16
  s_branch L_fin_done_48
L_fin_slow_47:
  v_lshlrev_b32 v178, 5, v2
  v_lshl_add_u32 v178, v3, 3, v178
  s_and_b32 s52, s44, 1
  s_lshl_b32 s52, s52, 11
  s_lshl_b32 s53, s50, 12
  s_add_u32 s52, s52, s53
  v_add_u32 v178, s52, v178
  ds_write_b64 v178, v[132:133] offset:41984
  ds_write_b64 v178, v[134:135] offset:42496
  ds_write_b64 v178, v[136:137] offset:43008
  ds_write_b64 v178, v[138:139] offset:43520
  v_lshlrev_b32 v178, 1, v0
  v_lshlrev_b32 v179, 10, v0
  s_lshl_b32 s54, s48, 1
  s_waitcnt lgkmcnt(0)
  s_barrier
  ds_read_u16 v132, v178 offset:41984
  ds_read_u16 v140, v178 offset:46080
  ds_read_u16 v133, v178 offset:42496
  ds_read_u16 v141, v178 offset:46592
  ds_read_u16 v134, v178 offset:43008
  ds_read_u16 v142, v178 offset:47104
  ds_read_u16 v135, v178 offset:43520
  ds_read_u16 v143, v178 offset:47616
  ds_read_u16 v136, v178 offset:44032
  ds_read_u16 v144, v178 offset:48128
  ds_read_u16 v137, v178 offset:44544
  ds_read_u16 v145, v178 offset:48640
  s_waitcnt lgkmcnt(4)
  ds_read_u16 v138, v178 offset:45056
  ds_read_u16 v146, v178 offset:49152
  ds_read_u16 v139, v178 offset:45568
  ds_read_u16 v147, v178 offset:49664
  s_waitcnt lgkmcnt(0)
  buffer_store_short v132, v179, s[20:23], s54 offen
  buffer_store_short v140, v179, s[20:23], s54 offen offset:64
  s_add_u32 s54, s54, 262144
  buffer_store_short v133, v179, s[20:23], s54 offen
  buffer_store_short v141, v179, s[20:23], s54 offen offset:64
  s_add_u32 s54, s54, 262144
  buffer_store_short v134, v179, s[20:23], s54 offen
  buffer_store_short v142, v179, s[20:23], s54 offen offset:64
  s_add_u32 s54, s54, 262144
  buffer_store_short v135, v179, s[20:23], s54 offen
  buffer_store_short v143, v179, s[20:23], s54 offen offset:64
  s_add_u32 s54, s54, 262144
  buffer_store_short v136, v179, s[20:23], s54 offen
  buffer_store_short v144, v179, s[20:23], s54 offen offset:64
  s_add_u32 s54, s54, 262144
  buffer_store_short v137, v179, s[20:23], s54 offen
  buffer_store_short v145, v179, s[20:23], s54 offen offset:64
  s_add_u32 s54, s54, 262144
  buffer_store_short v138, v179, s[20:23], s54 offen
  buffer_store_short v146, v179, s[20:23], s54 offen offset:64
  s_add_u32 s54, s54, 262144
  buffer_store_short v139, v179, s[20:23], s54 offen
  buffer_store_short v147, v179, s[20:23], s54 offen offset:64
L_fin_done_48:
L_exit:
  s_endpgm

.section .rodata,"a"
.p2align 6
.amdhsa_kernel interleave_layers__sliding_local_dilated__ssm_conv_s4d__prompt_kernel
  .amdhsa_next_free_vgpr 512
  .amdhsa_next_free_sgpr 102
  .amdhsa_accum_offset 256
  .amdhsa_group_segment_fixed_size 0
  .amdhsa_kernarg_size 104
  .amdhsa_user_sgpr_count 2
  .amdhsa_user_sgpr_kernarg_segment_ptr 1
  .amdhsa_system_sgpr_workgroup_id_x 1
  .amdhsa_float_denorm_mode_32 3
.end_amdhsa_kernel
```
